```python
import torch

def _softmax(x, axis=-1):
    return torch.softmax(x, dim=axis)
def _gelu(x):
    return torch.nn.functional.gelu(x, approximate="tanh")
def _silu(x):
    return torch.nn.functional.silu(x)
def _sigmoid(x):
    return torch.sigmoid(x)
def _layernorm(x, axis=-1, eps=1e-5):
    m = x.mean(dim=axis, keepdim=True)
    v = x.var(dim=axis, keepdim=True, unbiased=False)
    return (x - m) / torch.sqrt(v + eps)
def _scatter_add(tgt, idx, src, axis=0):
    return tgt.clone().index_add_(axis, idx, src)
def _segment_sum(src, seg, n):
    out = torch.zeros((n,) + src.shape[1:], dtype=src.dtype)
    return out.index_add_(0, seg, src)
def _pad(x, pw):
    flat = tuple(v for pair in reversed(pw) for v in pair)
    return torch.nn.functional.pad(x, flat)

kernel_name = 'sequential_preLN__sliding_local_dilated__dense_activation_squared_relu__prompt'

def setup_inputs():

    _w = (lambda a: (lambda t: t.to(torch.bfloat16) if t.is_floating_point() else t)(torch.as_tensor(a)))
    def _A_setup():
        B, S, D = 1, 2048, 576
        return {
            "x": _w((lambda *s: torch.randn(*s, dtype=torch.bfloat16) * 0.05)(B, S, D)),
            "wqkv": _w((lambda *s: torch.randn(*s, dtype=torch.bfloat16) * 0.05)(D, 3 * D)),
            "wo": _w((lambda *s: torch.randn(*s, dtype=torch.bfloat16) * 0.05)(D, D)),
        }
    _A_in = _A_setup()

    def _B_setup():
        B, S, D, F = 1, 2048, 576, 4608
        return {
            "x": _w((lambda *s: torch.randn(*s, dtype=torch.bfloat16) * 0.05)(B, S, D)),
            "w1": _w((lambda *s: torch.randn(*s, dtype=torch.bfloat16) * 0.05)(D, F)),
            "b1": _w((lambda *s: torch.randn(*s, dtype=torch.bfloat16) * 0.2)(F)),
            "w2": _w((lambda *s: torch.randn(*s, dtype=torch.bfloat16) * 0.05)(F, D)),
            "b2": _w((lambda *s: torch.randn(*s, dtype=torch.bfloat16) * 1.6)(D)),
        }
    _B_in = _B_setup()

    return {
        "A_x": _A_in["x"],
        "A_wqkv": _A_in["wqkv"],
        "A_wo": _A_in["wo"],
        "B_x": _B_in["x"],
        "B_w1": _B_in["w1"],
        "B_b1": _B_in["b1"],
        "B_w2": _B_in["w2"],
        "B_b2": _B_in["b2"],
    }

def reference(A_x, A_wqkv, A_wo, B_x, B_w1, B_b1, B_w2, B_b2):
    def _A_ref(x, wqkv, wo):
        B, S, D = x.shape
        H = 32; Dh = D // H
        W, dil = 8, 2
        qkv = (lambda x, *d: x.permute(*d))((x @ wqkv).reshape(B, S, 3, H, Dh), 2, 0, 3, 1, 4)
        q, k, v = qkv[0], qkv[1], qkv[2]
        scale = Dh ** -0.5
        pos = torch.arange(S)
        off = torch.arange(W) * dil
        idx = pos[:, None] - off[None, :]
        mask = idx >= 0
        idx_c = torch.where(mask, idx, 0).reshape(-1)
        kg = k[:, :, idx_c, :].reshape(B, H, S, W, Dh)
        vg = v[:, :, idx_c, :].reshape(B, H, S, W, Dh)
        logits = torch.einsum("bhsd,bhswd->bhsw", q, kg) * scale
        logits = torch.where(mask[None, None, :, :], logits, -1e9)
        attn = _softmax(logits, axis=-1)
        o = torch.einsum("bhsw,bhswd->bhsd", attn, vg)
        return (lambda x, *d: x.permute(*d))(o, 0, 2, 1, 3).reshape(B, S, D) @ wo

    def _B_ref(x, w1, b1, w2, b2):
        h = torch.einsum("bsd,df->bsf", x, w1) + b1
        zero = torch.zeros_like(h)
        r = torch.where(h > zero, h, zero)
        h = r * r
        out = torch.einsum("bsf,fd->bsd", h, w2) + b2
        return out

    x = A_x
    h = x + _A_ref(_layernorm(x, axis=-1), A_wqkv, A_wo)
    h2 = h + _B_ref(_layernorm(h, axis=-1), B_w1, B_b1, B_w2, B_b2)
    return h2
```

```asm
; @launch grid=(256,1,1) block=(256,1,1) lds=163840
.amdgcn_target "amdgcn-amd-amdhsa--gfx950"
.text
.globl sequential_preLN__sliding_local_dilated__dense_activation_squared_relu__prompt_kernel
.p2align 8
.type sequential_preLN__sliding_local_dilated__dense_activation_squared_relu__prompt_kernel,@function
sequential_preLN__sliding_local_dilated__dense_activation_squared_relu__prompt_kernel:
    s_cmp_ge_u32 s2, 256
    s_cbranch_scc1 L_end
    s_load_dwordx16 s[4:19], s[0:1], 0
    s_load_dwordx4 s[20:23], s[0:1], 64
    s_load_dwordx2 s[24:25], s[0:1], 80
    v_lshrrev_b32 v4, 6, v0
    v_and_b32 v1, 63, v0
    v_readfirstlane_b32 s3, v4
    v_and_b32 v2, 15, v0
    v_bfe_u32 v3, v0, 4, 2
    s_and_b32 s32, s2, 7
    s_lshr_b32 s33, s2, 3
    s_and_b32 s27, s32, 3
    s_lshr_b32 s26, s32, 2
    s_mul_i32 s26, s26, 8
    s_and_b32 s34, s33, 7
    s_add_u32 s26, s26, s34
    s_mul_i32 s27, s27, 4
    s_lshr_b32 s34, s33, 3
    s_add_u32 s27, s27, s34
    s_bfe_u32 s28, s27, 0x10002
    s_lshr_b32 s32, s27, 3
    s_lshl_b32 s32, s32, 2
    s_and_b32 s33, s27, 3
    s_add_u32 s29, s32, s33
    s_and_b32 s30, s26, 1
    s_lshr_b32 s32, s26, 1
    s_lshl_b32 s32, s32, 1
    s_add_u32 s32, s32, s28
    s_lshl_b32 s31, s32, 6
    v_lshlrev_b32 v17, 4, v1
    s_lshl_b32 s32, s26, 1
    s_add_u32 s32, s32, s28
    s_lshl_b32 s33, s29, 2
    s_add_u32 s32, s32, s33
    s_mul_i32 s33, s32, 7282
    s_lshr_b32 s33, s33, 16
    s_mul_i32 s33, s33, 9
    s_sub_u32 s45, s32, s33
    s_lshr_b32 s45, s45, 1
    s_lshl_b32 s45, s45, 1
    s_mul_i32 s47, s3, 9216
    s_add_u32 s47, s47, 1024
    s_cmp_lg_u32 s3, 0
    s_cbranch_scc1 L_p1w_1
    v_lshrrev_b32 v4, 3, v1
    v_and_b32 v5, 7, v1
    s_lshl_b32 s32, s31, 1
    s_add_u32 s32, s32, s30
    s_sub_u32 s32, s32, 16
    v_lshl_add_u32 v4, v4, 1, s32
    v_cmp_gt_i32 vcc, 0, v4
    v_mul_i32_i24 v4, 1152, v4
    v_add_u32 v6, 4, v3
    v_xor_b32 v6, v6, v5
    v_lshl_add_u32 v7, v6, 4, v4
    v_add_u32 v8, 4096, v7
    v_add_u32 v10, 38912, v7
    v_add_u32 v12, 77824, v7
    v_add_u32 v14, 112640, v7
    v_add_u32 v16, 151552, v7
    v_add_u32 v6, 0, v3
    v_xor_b32 v6, v6, v5
    v_lshl_add_u32 v7, v6, 4, v4
    v_add_u32 v9, 21504, v7
    v_add_u32 v11, 56320, v7
    v_add_u32 v13, 95232, v7
    v_add_u32 v15, 130048, v7
    v_mov_b32 v6, 0xf0000000
    v_cndmask_b32 v8, v8, v6, vcc
    s_movk_i32 s44, 128
    s_waitcnt lgkmcnt(0)
    s_sub_u32 s36, s4, 4096
    s_subb_u32 s37, s5, 0
    s_mov_b32 s38, 2363392
    s_branch L_p1j_2
L_p1w_1:
    s_sub_u32 s32, s3, 1
    s_mul_i32 s32, s32, 1152
    s_mul_i32 s33, s29, 144
    s_add_u32 s32, s32, s33
    v_add_u32 v4, s32, v17
    s_movk_i32 s40, 7282
    s_movk_i32 s41, 3312
    s_movk_i32 s42, 10368
    s_movk_i32 s43, -3456
    v_add_u32 v5, 0, v1
    v_mul_u32_u24 v5, s40, v5
    v_lshrrev_b32 v5, 16, v5
    v_mad_u32_u24 v8, v5, s41, v4
    v_and_b32 v6, 1, v5
    v_bfe_u32 v5, v5, 1, 2
    v_mad_u32_u24 v8, v6, s42, v8
    v_mad_i32_i24 v8, v5, s43, v8
    v_add_u32 v8, 4096, v8
    v_add_u32 v5, 64, v1
    v_mul_u32_u24 v5, s40, v5
    v_lshrrev_b32 v5, 16, v5
    v_mad_u32_u24 v9, v5, s41, v4
    v_and_b32 v6, 1, v5
    v_bfe_u32 v5, v5, 1, 2
    v_mad_u32_u24 v9, v6, s42, v9
    v_mad_i32_i24 v9, v5, s43, v9
    v_add_u32 v9, 4096, v9
    v_add_u32 v5, 128, v1
    v_mul_u32_u24 v5, s40, v5
    v_lshrrev_b32 v5, 16, v5
    v_mad_u32_u24 v10, v5, s41, v4
    v_and_b32 v6, 1, v5
    v_bfe_u32 v5, v5, 1, 2
    v_mad_u32_u24 v10, v6, s42, v10
    v_mad_i32_i24 v10, v5, s43, v10
    v_add_u32 v10, 4096, v10
    v_add_u32 v5, 192, v1
    v_mul_u32_u24 v5, s40, v5
    v_lshrrev_b32 v5, 16, v5
    v_mad_u32_u24 v11, v5, s41, v4
    v_and_b32 v6, 1, v5
    v_bfe_u32 v5, v5, 1, 2
    v_mad_u32_u24 v11, v6, s42, v11
    v_mad_i32_i24 v11, v5, s43, v11
    v_add_u32 v11, 4096, v11
    v_add_u32 v5, 256, v1
    v_mul_u32_u24 v5, s40, v5
    v_lshrrev_b32 v5, 16, v5
    v_mad_u32_u24 v12, v5, s41, v4
    v_and_b32 v6, 1, v5
    v_bfe_u32 v5, v5, 1, 2
    v_mad_u32_u24 v12, v6, s42, v12
    v_mad_i32_i24 v12, v5, s43, v12
    v_add_u32 v12, 8192, v12
    v_add_u32 v5, 320, v1
    v_mul_u32_u24 v5, s40, v5
    v_lshrrev_b32 v5, 16, v5
    v_mad_u32_u24 v13, v5, s41, v4
    v_and_b32 v6, 1, v5
    v_bfe_u32 v5, v5, 1, 2
    v_mad_u32_u24 v13, v6, s42, v13
    v_mad_i32_i24 v13, v5, s43, v13
    v_add_u32 v13, 8192, v13
    v_add_u32 v5, 384, v1
    v_mul_u32_u24 v5, s40, v5
    v_lshrrev_b32 v5, 16, v5
    v_mad_u32_u24 v14, v5, s41, v4
    v_and_b32 v6, 1, v5
    v_bfe_u32 v5, v5, 1, 2
    v_mad_u32_u24 v14, v6, s42, v14
    v_mad_i32_i24 v14, v5, s43, v14
    v_add_u32 v14, 8192, v14
    v_add_u32 v5, 448, v1
    v_mul_u32_u24 v5, s40, v5
    v_lshrrev_b32 v5, 16, v5
    v_mad_u32_u24 v15, v5, s41, v4
    v_and_b32 v6, 1, v5
    v_bfe_u32 v5, v5, 1, 2
    v_mad_u32_u24 v15, v6, s42, v15
    v_mad_i32_i24 v15, v5, s43, v15
    v_add_u32 v15, 8192, v15
    v_add_u32 v5, 512, v1
    v_mul_u32_u24 v5, s40, v5
    v_lshrrev_b32 v5, 16, v5
    v_mad_u32_u24 v16, v5, s41, v4
    v_and_b32 v6, 1, v5
    v_bfe_u32 v5, v5, 1, 2
    v_mad_u32_u24 v16, v6, s42, v16
    v_mad_i32_i24 v16, v5, s43, v16
    v_add_u32 v16, 12288, v16
    s_mov_b32 s44, 221184
    s_waitcnt lgkmcnt(0)
    s_sub_u32 s36, s6, 4096
    s_subb_u32 s37, s7, 0
    s_mov_b32 s38, 1994752
L_p1j_2:
    s_mov_b32 s39, 0x20000
    s_mul_i32 s46, s45, s44
    s_add_u32 s45, s45, 1
    s_cmp_eq_u32 s45, 9
    s_cselect_b32 s45, 0, s45
    s_add_u32 m0, s47, 0
    s_nop 0
    buffer_load_dwordx4 v8, s[36:39], s46 offen offset:0  lds
    buffer_load_dwordx4 v9, s[36:39], s46 offen offset:1024  lds
    buffer_load_dwordx4 v10, s[36:39], s46 offen offset:2048  lds
    buffer_load_dwordx4 v11, s[36:39], s46 offen offset:3072  lds
    s_add_u32 m0, s47, 4096
    s_nop 0
    buffer_load_dwordx4 v12, s[36:39], s46 offen offset:0  lds
    buffer_load_dwordx4 v13, s[36:39], s46 offen offset:1024  lds
    buffer_load_dwordx4 v14, s[36:39], s46 offen offset:2048  lds
    buffer_load_dwordx4 v15, s[36:39], s46 offen offset:3072  lds
    s_add_u32 m0, s47, 8192
    s_nop 0
    buffer_load_dwordx4 v16, s[36:39], s46 offen offset:0  lds
    s_mov_b32 s48, s4
    s_mov_b32 s49, s5
    s_mov_b32 s50, 2359296
    s_mov_b32 s51, 0x20000
    s_mov_b32 s52, s24
    s_mov_b32 s53, s25
    s_mov_b32 s54, 50855936
    s_mov_b32 s55, 0x20000
    s_mov_b32 s56, s22
    s_mov_b32 s57, s23
    s_mov_b32 s58, 256
    s_mov_b32 s59, 0x20000
    s_sub_u32 s60, s16, 4096
    s_subb_u32 s61, s17, 0
    s_mov_b32 s62, 5312512
    s_mov_b32 s63, 0x20000
    s_lshl_b32 s32, s26, 4
    s_add_u32 s64, s32, s27
    s_lshl_b32 s65, s64, 7
    s_add_u32 s66, s27, s3
    v_mov_b32 v18, 0
    s_cmp_lg_u32 s66, 0
    s_cbranch_scc1 L_only_3
    v_lshlrev_b32 v4, 6, v1
    s_mov_b32 exec_lo, -1
    s_mov_b32 exec_hi, 0
    buffer_store_dword v18, v4, s[52:55], s65 offen sc1
    s_mov_b64 exec, -1
L_only_3:
    s_cmp_lg_u32 s3, 0
    s_cbranch_scc1 L_only_4
    s_getpc_b64 s[68:69]
L_pc:
    s_lshr_b32 s32, s2, 3
    s_and_b32 s32, s32, 7
    s_lshl_b32 s32, s32, 6
    v_add_u32 v4, s32, v1
    v_lshlrev_b32 v4, 7, v4
    v_min_u32 v4, L_end - L_pc, v4
    v_mov_b32 v21, s69
    v_add_co_u32 v20, vcc, s68, v4
    s_nop 1
    v_addc_co_u32 v21, vcc, 0, v21, vcc
    global_load_dword v20, v[20:21], off
L_only_4:
    s_cmp_lg_u32 s3, 0
    s_cbranch_scc1 L_only_5
    s_mul_i32 s32, s64, 21
    v_add_u32 v4, s32, v1
    v_min_u32 v4, 5183, v4
    v_lshlrev_b32 v4, 7, v4
    v_mov_b32 v22, s8
    v_mov_b32 v23, s9
    s_min_u32 s32, s64, 71
    s_lshl_b32 s32, s32, 7
    v_writelane_b32 v4, s32, 21
    v_writelane_b32 v22, s14, 21
    v_writelane_b32 v23, s15, 21
    s_min_u32 s32, s27, 8
    s_lshl_b32 s32, s32, 7
    v_writelane_b32 v4, s32, 22
    v_writelane_b32 v22, s18, 22
    v_writelane_b32 v23, s19, 22
    v_add_co_u32 v22, vcc, v22, v4
    s_nop 1
    v_addc_co_u32 v23, vcc, 0, v23, vcc
    s_mov_b64 exec, 0x7fffff
    global_load_dword v22, v[22:23], off
    s_mov_b64 exec, -1
L_only_5:
    v_mov_b32 v24, 0x3f803f80
    v_mov_b32 v25, 0x3f803f80
    v_mov_b32 v26, 0x3f803f80
    v_mov_b32 v27, 0x3f803f80
    s_min_u32 s32, s3, 2
    s_mul_i32 s32, s32, 37888
    v_add_u32 v4, s32, v17
    ds_write_b128 v4, v[24:27]
    s_lshr_b32 s67, s3, 1
    s_mul_i32 s67, s67, 72
    s_and_b32 s32, s3, 1
    s_mul_i32 s68, s32, 40
    s_add_u32 s68, s68, s67
    s_cmp_eq_u32 s32, 1
    s_cselect_b64 s[70:71], -1, 0
    s_add_u32 s33, s3, 1
    s_lshl_b32 s33, s33, 11
    v_lshrrev_b32 v4, 1, v2
    v_add_u32 v5, 0, v3
    v_xor_b32 v5, v5, v4
    v_lshlrev_b32 v5, 4, v5
    v_lshl_add_u32 v28, v2, 7, v5
    v_add_u32 v34, s33, v28
    v_add_u32 v5, 4, v3
    v_xor_b32 v5, v5, v4
    v_lshlrev_b32 v5, 4, v5
    v_lshl_add_u32 v29, v2, 7, v5
    v_add_u32 v35, s33, v29
    v_lshrrev_b32 v4, 2, v1
    v_mul_u32_u24 v4, 288, v4
    v_and_b32 v5, 3, v1
    v_lshl_add_u32 v49, v5, 3, v4
    s_add_u32 s34, s68, 10240
    v_add_u32 v40, s34, v49
    v_mul_u32_u24 v6, 9216, v5
    s_add_u32 s34, s67, 10272
    v_add3_u32 v6, v6, v4, s34
    v_cmp_eq_u32 vcc, 3, v5
    v_add_u32 v7, 4608, v6
    s_nop 0
    v_cndmask_b32 v43, v6, 0, vcc
    v_cndmask_b32 v44, v7, 0, vcc
    v_add_u32 v30, 37888, v28
    v_add_u32 v36, 37888, v34
    v_add_u32 v45, 37888, v43
    v_add_u32 v31, 37888, v29
    v_add_u32 v37, 37888, v35
    v_add_u32 v46, 37888, v44
    v_add_u32 v41, 37888, v40
    v_add_u32 v32, 75776, v28
    v_add_u32 v38, 75776, v34
    v_add_u32 v47, 75776, v43
    v_add_u32 v33, 75776, v29
    v_add_u32 v39, 75776, v35
    v_add_u32 v48, 75776, v44
    v_add_u32 v42, 75776, v40
    v_and_b32 v4, 3, v2
    v_cmp_eq_u32 s[72:73], 1, v4
    v_cmp_eq_u32 s[74:75], 2, v4
    v_cmp_eq_u32 s[76:77], 3, v4
    v_lshrrev_b32 v4, 2, v2
    v_cmp_eq_u32 s[78:79], v4, v3
    s_mov_b64 s[80:81], 0xffff
    s_mov_b32 s82, 0
    s_mov_b32 s83, 0xffff0000
    v_lshlrev_b32 v4, 2, v3
    v_sub_u32 v4, v2, v4
    v_mov_b32 v6, 0xf149f2ca
    s_cmp_eq_u32 s31, 0
    s_cselect_b64 s[84:85], -1, 0
    v_mov_b32 v50, 0
    v_mov_b32 v51, 0
    v_mov_b32 v64, 0
    v_mov_b32 v65, 0
    v_add_u32 v5, 16, v4
    v_cmp_gt_u32 vcc, 8, v5
    v_or_b32 v7, 0xffff, v50
    s_nop 0
    v_cndmask_b32 v52, v6, 0, vcc
    v_cndmask_b32 v50, v50, v7, vcc
    v_add_u32 v5, 0, v4
    v_cmp_gt_u32 vcc, 8, v5
    v_or_b32 v7, 0xffff, v64
    s_nop 0
    v_cndmask_b32 v56, v6, 0, vcc
    v_cndmask_b32 v64, v64, v7, vcc
    v_cndmask_b32 v60, v52, v6, s[84:85]
    v_add_u32 v5, 15, v4
    v_cmp_gt_u32 vcc, 8, v5
    v_or_b32 v7, 0xffff0000, v50
    s_nop 0
    v_cndmask_b32 v53, v6, 0, vcc
    v_cndmask_b32 v50, v50, v7, vcc
    v_add_u32 v5, -1, v4
    v_cmp_gt_u32 vcc, 8, v5
    v_or_b32 v7, 0xffff0000, v64
    s_nop 0
    v_cndmask_b32 v57, v6, 0, vcc
    v_cndmask_b32 v64, v64, v7, vcc
    v_cndmask_b32 v61, v53, v6, s[84:85]
    v_add_u32 v5, 14, v4
    v_cmp_gt_u32 vcc, 8, v5
    v_or_b32 v7, 0xffff, v51
    s_nop 0
    v_cndmask_b32 v54, v6, 0, vcc
    v_cndmask_b32 v51, v51, v7, vcc
    v_add_u32 v5, -2, v4
    v_cmp_gt_u32 vcc, 8, v5
    v_or_b32 v7, 0xffff, v65
    s_nop 0
    v_cndmask_b32 v58, v6, 0, vcc
    v_cndmask_b32 v65, v65, v7, vcc
    v_cndmask_b32 v62, v54, v6, s[84:85]
    v_add_u32 v5, 13, v4
    v_cmp_gt_u32 vcc, 8, v5
    v_or_b32 v7, 0xffff0000, v51
    s_nop 0
    v_cndmask_b32 v55, v6, 0, vcc
    v_cndmask_b32 v51, v51, v7, vcc
    v_add_u32 v5, -3, v4
    v_cmp_gt_u32 vcc, 8, v5
    v_or_b32 v7, 0xffff0000, v65
    s_nop 0
    v_cndmask_b32 v59, v6, 0, vcc
    v_cndmask_b32 v65, v65, v7, vcc
    v_cndmask_b32 v63, v55, v6, s[84:85]
    v_lshlrev_b32 v66, 3, v2
    v_add_u32 v66, 159744, v66
    s_add_u32 s33, s3, 1
    s_lshl_b32 s33, s33, 7
    v_add_u32 v67, s33, v66
    s_mul_i32 s32, s3, 3840
    s_add_u32 s32, s32, 37888
    v_mad_u32_u24 v70, v2, 48, s32
    v_lshrrev_b32 v4, 2, v1
    v_mad_u32_u24 v72, v4, 48, s32
    v_lshl_add_u32 v68, v3, 3, v70
    v_lshl_add_u32 v69, v3, 2, v70
    v_and_b32 v4, 3, v1
    v_lshl_add_u32 v71, v4, 3, v72
    v_mul_u32_u24 v4, 144, v2
    s_add_u32 s32, s68, 53248
    v_lshl_add_u32 v73, v3, 3, v4
    v_add_u32 v73, s32, v73
    s_and_b32 s32, s3, 1
    s_lshl_b32 s32, s32, 2
    s_add_u32 s32, s32, s67
    s_add_u32 s32, s32, 53280
    v_add_u32 v74, s32, v4
    s_mul_i32 s32, s3, 2304
    s_add_u32 s32, s32, 53248
    v_lshl_add_u32 v75, v3, 4, v4
    v_add_u32 v75, s32, v75
    s_lshl_b32 s32, s26, 1
    s_add_u32 s32, s32, s28
    s_lshl_b32 s32, s32, 2
    s_add_u32 s32, s32, s3
    s_mul_i32 s69, s32, 18432
    s_mul_i32 s86, s29, 2304
    s_add_u32 s86, s86, s69
    s_add_u32 s86, s86, 1048576
    s_mul_i32 s32, s29, 144
    v_add_u32 v4, s32, v17
    s_movk_i32 s40, 7282
    s_movk_i32 s41, 1008
    s_movk_i32 s42, 3456
    s_movk_i32 s43, -1152
    v_add_u32 v5, 0, v1
    v_mul_u32_u24 v5, s40, v5
    v_lshrrev_b32 v5, 16, v5
    v_mad_u32_u24 v76, v5, s41, v4
    v_and_b32 v6, 1, v5
    v_bfe_u32 v5, v5, 1, 2
    v_mad_u32_u24 v76, v6, s42, v76
    v_mad_i32_i24 v76, v5, s43, v76
    v_add_u32 v76, 4096, v76
    v_add_u32 v5, 64, v1
    v_mul_u32_u24 v5, s40, v5
    v_lshrrev_b32 v5, 16, v5
    v_mad_u32_u24 v77, v5, s41, v4
    v_and_b32 v6, 1, v5
    v_bfe_u32 v5, v5, 1, 2
    v_mad_u32_u24 v77, v6, s42, v77
    v_mad_i32_i24 v77, v5, s43, v77
    v_add_u32 v77, 4096, v77
    v_add_u32 v5, 128, v1
    v_mul_u32_u24 v5, s40, v5
    v_lshrrev_b32 v5, 16, v5
    v_mad_u32_u24 v78, v5, s41, v4
    v_and_b32 v6, 1, v5
    v_bfe_u32 v5, v5, 1, 2
    v_mad_u32_u24 v78, v6, s42, v78
    v_mad_i32_i24 v78, v5, s43, v78
    v_add_u32 v78, 4096, v78
    v_add_u32 v5, 192, v1
    v_mul_u32_u24 v5, s40, v5
    v_lshrrev_b32 v5, 16, v5
    v_mad_u32_u24 v79, v5, s41, v4
    v_and_b32 v6, 1, v5
    v_bfe_u32 v5, v5, 1, 2
    v_mad_u32_u24 v79, v6, s42, v79
    v_mad_i32_i24 v79, v5, s43, v79
    v_add_u32 v79, 4096, v79
    v_add_u32 v5, 256, v1
    v_mul_u32_u24 v5, s40, v5
    v_lshrrev_b32 v5, 16, v5
    v_mad_u32_u24 v80, v5, s41, v4
    v_and_b32 v6, 1, v5
    v_bfe_u32 v5, v5, 1, 2
    v_mad_u32_u24 v80, v6, s42, v80
    v_mad_i32_i24 v80, v5, s43, v80
    v_add_u32 v80, 8192, v80
    v_add_u32 v5, 320, v1
    v_mul_u32_u24 v5, s40, v5
    v_lshrrev_b32 v5, 16, v5
    v_mad_u32_u24 v81, v5, s41, v4
    v_and_b32 v6, 1, v5
    v_bfe_u32 v5, v5, 1, 2
    v_mad_u32_u24 v81, v6, s42, v81
    v_mad_i32_i24 v81, v5, s43, v81
    v_add_u32 v81, 8192, v81
    v_add_u32 v5, 384, v1
    v_mul_u32_u24 v5, s40, v5
    v_lshrrev_b32 v5, 16, v5
    v_mad_u32_u24 v82, v5, s41, v4
    v_and_b32 v6, 1, v5
    v_bfe_u32 v5, v5, 1, 2
    v_mad_u32_u24 v82, v6, s42, v82
    v_mad_i32_i24 v82, v5, s43, v82
    v_add_u32 v82, 8192, v82
    v_add_u32 v5, 448, v1
    v_mul_u32_u24 v5, s40, v5
    v_lshrrev_b32 v5, 16, v5
    v_mad_u32_u24 v83, v5, s41, v4
    v_and_b32 v6, 1, v5
    v_bfe_u32 v5, v5, 1, 2
    v_mad_u32_u24 v83, v6, s42, v83
    v_mad_i32_i24 v83, v5, s43, v83
    v_add_u32 v83, 8192, v83
    v_add_u32 v5, 512, v1
    v_mul_u32_u24 v5, s40, v5
    v_lshrrev_b32 v5, 16, v5
    v_mad_u32_u24 v84, v5, s41, v4
    v_and_b32 v6, 1, v5
    v_bfe_u32 v5, v5, 1, 2
    v_mad_u32_u24 v84, v6, s42, v84
    v_mad_i32_i24 v84, v5, s43, v84
    v_add_u32 v84, 12288, v84
    s_mul_i32 s46, s45, s44
    s_add_u32 s45, s45, 1
    s_cmp_eq_u32 s45, 9
    s_cselect_b32 s45, 0, s45
    s_add_u32 m0, s47, 37888
    s_nop 0
    buffer_load_dwordx4 v8, s[36:39], s46 offen offset:0  lds
    buffer_load_dwordx4 v9, s[36:39], s46 offen offset:1024  lds
    buffer_load_dwordx4 v10, s[36:39], s46 offen offset:2048  lds
    buffer_load_dwordx4 v11, s[36:39], s46 offen offset:3072  lds
    s_add_u32 m0, s47, 41984
    s_nop 0
    buffer_load_dwordx4 v12, s[36:39], s46 offen offset:0  lds
    buffer_load_dwordx4 v13, s[36:39], s46 offen offset:1024  lds
    buffer_load_dwordx4 v14, s[36:39], s46 offen offset:2048  lds
    buffer_load_dwordx4 v15, s[36:39], s46 offen offset:3072  lds
    s_add_u32 m0, s47, 46080
    s_nop 0
    buffer_load_dwordx4 v16, s[36:39], s46 offen offset:0  lds
    s_waitcnt lgkmcnt(0)
    s_waitcnt vmcnt(9)
    s_barrier
    ds_read_b64_tr_b16 v[180:181], v40 offset:9216
    ds_read_b64_tr_b16 v[182:183], v40 offset:9360
    ds_read_b128 a[0:3], v28 offset:0
    ds_read_b128 a[4:7], v28 offset:2048
    ds_read_b128 a[8:11], v28 offset:4096
    ds_read_b128 a[12:15], v28 offset:6144
    ds_read_b128 a[16:19], v28 offset:8192
    ds_read_b64_tr_b16 v[184:185], v40 offset:18432
    ds_read_b64_tr_b16 v[186:187], v40 offset:18576
    ds_read_b64_tr_b16 v[176:177], v40 offset:0
    ds_read_b64_tr_b16 v[178:179], v40 offset:144
    ds_read_b64_tr_b16 v[188:189], v43 offset:0
    ds_read_b64_tr_b16 v[190:191], v43 offset:144
    ds_read_b128 a[20:23], v34
    s_waitcnt lgkmcnt(0)
    v_mfma_f32_16x16x32_bf16 v[108:111], v[180:183], a[0:3], 0
    v_mfma_f32_16x16x32_bf16 v[112:115], v[180:183], a[4:7], 0
    ds_read_b64_tr_b16 v[196:197], v40 offset:13824
    s_mul_i32 s46, s45, s44
    v_mfma_f32_16x16x32_bf16 v[116:119], v[180:183], a[8:11], 0
    ds_read_b64_tr_b16 v[198:199], v40 offset:13968
    s_add_u32 s45, s45, 1
    s_cmp_eq_u32 s45, 9
    s_cselect_b32 s45, 0, s45
    v_mfma_f32_16x16x32_bf16 v[120:123], v[180:183], a[12:15], 0
    ds_read_b128 a[24:27], v29 offset:0
    v_mfma_f32_16x16x32_bf16 v[124:127], v[180:183], a[16:19], 0
    ds_read_b128 a[28:31], v29 offset:2048
    s_add_u32 m0, s47, 75776
    v_mfma_f32_16x16x32_bf16 v[128:131], v[184:187], a[0:3], 0
    ds_read_b128 a[32:35], v29 offset:4096
    buffer_load_dwordx4 v8, s[36:39], s46 offen offset:0  lds
    v_mfma_f32_16x16x32_bf16 v[132:135], v[184:187], a[4:7], 0
    ds_read_b128 a[36:39], v29 offset:6144
    v_mfma_f32_16x16x32_bf16 v[136:139], v[184:187], a[8:11], 0
    ds_read_b128 a[40:43], v29 offset:8192
    buffer_load_dwordx4 v9, s[36:39], s46 offen offset:1024  lds
    v_mfma_f32_16x16x32_bf16 v[140:143], v[184:187], a[12:15], 0
    ds_read_b64_tr_b16 v[200:201], v40 offset:23040
    buffer_load_dwordx4 v10, s[36:39], s46 offen offset:2048  lds
    v_mfma_f32_16x16x32_bf16 v[144:147], v[184:187], a[16:19], 0
    ds_read_b64_tr_b16 v[202:203], v40 offset:23184
    v_mfma_f32_16x16x32_bf16 v[88:91], v[176:179], a[0:3], 0
    ds_read_b64_tr_b16 v[192:193], v40 offset:4608
    buffer_load_dwordx4 v11, s[36:39], s46 offen offset:3072  lds
    v_mfma_f32_16x16x32_bf16 v[92:95], v[176:179], a[4:7], 0
    ds_read_b64_tr_b16 v[194:195], v40 offset:4752
    s_add_u32 m0, s47, 79872
    v_mfma_f32_16x16x32_bf16 v[96:99], v[176:179], a[8:11], 0
    ds_read_b64_tr_b16 v[204:205], v44 offset:0
    v_mfma_f32_16x16x32_bf16 v[100:103], v[176:179], a[12:15], 0
    ds_read_b64_tr_b16 v[206:207], v44 offset:144
    buffer_load_dwordx4 v12, s[36:39], s46 offen offset:0  lds
    v_mfma_f32_16x16x32_bf16 v[104:107], v[176:179], a[16:19], 0
    ds_read_b128 a[44:47], v35
    buffer_load_dwordx4 v13, s[36:39], s46 offen offset:1024  lds
    v_mfma_f32_16x16x32_bf16 v[148:151], v[188:191], a[0:3], 0
    v_mfma_f32_16x16x32_bf16 v[152:155], v[188:191], a[4:7], 0
    buffer_load_dwordx4 v14, s[36:39], s46 offen offset:2048  lds
    v_mfma_f32_16x16x32_bf16 v[156:159], v[188:191], a[8:11], 0
    buffer_load_dwordx4 v15, s[36:39], s46 offen offset:3072  lds
    v_mfma_f32_16x16x32_bf16 v[160:163], v[188:191], a[12:15], 0
    v_mfma_f32_16x16x32_bf16 v[164:167], v[188:191], a[16:19], 0
    s_add_u32 m0, s47, 83968
    v_mfma_f32_16x16x32_bf16 v[168:171], a[0:3], a[0:3], 0
    buffer_load_dwordx4 v16, s[36:39], s46 offen offset:0  lds
    v_mfma_f32_16x16x32_bf16 v[172:175], a[20:23], a[20:23], 0
    s_waitcnt lgkmcnt(0)
    v_mfma_f32_16x16x32_bf16 v[108:111], v[196:199], a[24:27], v[108:111]
    s_waitcnt vmcnt(9)
    s_barrier
    s_cmp_lg_u32 s66, 0
    s_cbranch_scc1 L_only_6
    v_mov_b32 v19, 1
    s_lshl_b32 s35, s26, 2
    s_mov_b64 exec, 1
    buffer_store_dword v19, v18, s[56:59], s35 offen sc1
    s_mov_b64 exec, -1
L_only_6:
    v_mfma_f32_16x16x32_bf16 v[112:115], v[196:199], a[28:31], v[112:115]
    ds_read_b64_tr_b16 v[180:181], v41 offset:9216
    s_mul_i32 s46, s45, s44
    v_mfma_f32_16x16x32_bf16 v[116:119], v[196:199], a[32:35], v[116:119]
    ds_read_b64_tr_b16 v[182:183], v41 offset:9360
    v_mfma_f32_16x16x32_bf16 v[120:123], v[196:199], a[36:39], v[120:123]
    ds_read_b128 a[0:3], v30 offset:0
    v_mfma_f32_16x16x32_bf16 v[124:127], v[196:199], a[40:43], v[124:127]
    ds_read_b128 a[4:7], v30 offset:2048
    s_add_u32 s45, s45, 1
    s_cmp_eq_u32 s45, 9
    s_cselect_b32 s45, 0, s45
    v_mfma_f32_16x16x32_bf16 v[128:131], v[200:203], a[24:27], v[128:131]
    ds_read_b128 a[8:11], v30 offset:4096
    v_mfma_f32_16x16x32_bf16 v[132:135], v[200:203], a[28:31], v[132:135]
    ds_read_b128 a[12:15], v30 offset:6144
    v_mfma_f32_16x16x32_bf16 v[136:139], v[200:203], a[32:35], v[136:139]
    ds_read_b128 a[16:19], v30 offset:8192
    s_add_u32 m0, s47, 0
    v_mfma_f32_16x16x32_bf16 v[140:143], v[200:203], a[36:39], v[140:143]
    ds_read_b64_tr_b16 v[184:185], v41 offset:18432
    v_mfma_f32_16x16x32_bf16 v[144:147], v[200:203], a[40:43], v[144:147]
    ds_read_b64_tr_b16 v[186:187], v41 offset:18576
    v_mfma_f32_16x16x32_bf16 v[88:91], v[192:195], a[24:27], v[88:91]
    ds_read_b64_tr_b16 v[176:177], v41 offset:0
    buffer_load_dwordx4 v8, s[36:39], s46 offen offset:0  lds
    v_mfma_f32_16x16x32_bf16 v[92:95], v[192:195], a[28:31], v[92:95]
    ds_read_b64_tr_b16 v[178:179], v41 offset:144
    v_mfma_f32_16x16x32_bf16 v[96:99], v[192:195], a[32:35], v[96:99]
    ds_read_b64_tr_b16 v[188:189], v45 offset:0
    v_mfma_f32_16x16x32_bf16 v[100:103], v[192:195], a[36:39], v[100:103]
    ds_read_b64_tr_b16 v[190:191], v45 offset:144
    buffer_load_dwordx4 v9, s[36:39], s46 offen offset:1024  lds
    v_mfma_f32_16x16x32_bf16 v[104:107], v[192:195], a[40:43], v[104:107]
    ds_read_b128 a[20:23], v36
    v_mfma_f32_16x16x32_bf16 v[148:151], v[204:207], a[24:27], v[148:151]
    v_mfma_f32_16x16x32_bf16 v[152:155], v[204:207], a[28:31], v[152:155]
    buffer_load_dwordx4 v10, s[36:39], s46 offen offset:2048  lds
    v_mfma_f32_16x16x32_bf16 v[156:159], v[204:207], a[32:35], v[156:159]
    v_mfma_f32_16x16x32_bf16 v[160:163], v[204:207], a[36:39], v[160:163]
    v_mfma_f32_16x16x32_bf16 v[164:167], v[204:207], a[40:43], v[164:167]
    buffer_load_dwordx4 v11, s[36:39], s46 offen offset:3072  lds
    v_mfma_f32_16x16x32_bf16 v[168:171], a[24:27], a[24:27], v[168:171]
    v_mfma_f32_16x16x32_bf16 v[172:175], a[44:47], a[44:47], v[172:175]
    s_waitcnt lgkmcnt(0)
    v_mfma_f32_16x16x32_bf16 v[108:111], v[180:183], a[0:3], v[108:111]
    v_mfma_f32_16x16x32_bf16 v[112:115], v[180:183], a[4:7], v[112:115]
    ds_read_b64_tr_b16 v[196:197], v41 offset:13824
    s_add_u32 m0, s47, 4096
    v_mfma_f32_16x16x32_bf16 v[116:119], v[180:183], a[8:11], v[116:119]
    ds_read_b64_tr_b16 v[198:199], v41 offset:13968
    v_mfma_f32_16x16x32_bf16 v[120:123], v[180:183], a[12:15], v[120:123]
    ds_read_b128 a[24:27], v31 offset:0
    v_mfma_f32_16x16x32_bf16 v[124:127], v[180:183], a[16:19], v[124:127]
    ds_read_b128 a[28:31], v31 offset:2048
    buffer_load_dwordx4 v12, s[36:39], s46 offen offset:0  lds
    v_mfma_f32_16x16x32_bf16 v[128:131], v[184:187], a[0:3], v[128:131]
    ds_read_b128 a[32:35], v31 offset:4096
    v_mfma_f32_16x16x32_bf16 v[132:135], v[184:187], a[4:7], v[132:135]
    ds_read_b128 a[36:39], v31 offset:6144
    v_mfma_f32_16x16x32_bf16 v[136:139], v[184:187], a[8:11], v[136:139]
    ds_read_b128 a[40:43], v31 offset:8192
    buffer_load_dwordx4 v13, s[36:39], s46 offen offset:1024  lds
    v_mfma_f32_16x16x32_bf16 v[140:143], v[184:187], a[12:15], v[140:143]
    ds_read_b64_tr_b16 v[200:201], v41 offset:23040
    v_mfma_f32_16x16x32_bf16 v[144:147], v[184:187], a[16:19], v[144:147]
    ds_read_b64_tr_b16 v[202:203], v41 offset:23184
    v_mfma_f32_16x16x32_bf16 v[88:91], v[176:179], a[0:3], v[88:91]
    ds_read_b64_tr_b16 v[192:193], v41 offset:4608
    buffer_load_dwordx4 v14, s[36:39], s46 offen offset:2048  lds
    v_mfma_f32_16x16x32_bf16 v[92:95], v[176:179], a[4:7], v[92:95]
    ds_read_b64_tr_b16 v[194:195], v41 offset:4752
    v_mfma_f32_16x16x32_bf16 v[96:99], v[176:179], a[8:11], v[96:99]
    ds_read_b64_tr_b16 v[204:205], v46 offset:0
    v_mfma_f32_16x16x32_bf16 v[100:103], v[176:179], a[12:15], v[100:103]
    ds_read_b64_tr_b16 v[206:207], v46 offset:144
    buffer_load_dwordx4 v15, s[36:39], s46 offen offset:3072  lds
    v_mfma_f32_16x16x32_bf16 v[104:107], v[176:179], a[16:19], v[104:107]
    ds_read_b128 a[44:47], v37
    v_mfma_f32_16x16x32_bf16 v[148:151], v[188:191], a[0:3], v[148:151]
    v_mfma_f32_16x16x32_bf16 v[152:155], v[188:191], a[4:7], v[152:155]
    s_add_u32 m0, s47, 8192
    v_mfma_f32_16x16x32_bf16 v[156:159], v[188:191], a[8:11], v[156:159]
    v_mfma_f32_16x16x32_bf16 v[160:163], v[188:191], a[12:15], v[160:163]
    v_mfma_f32_16x16x32_bf16 v[164:167], v[188:191], a[16:19], v[164:167]
    buffer_load_dwordx4 v16, s[36:39], s46 offen offset:0  lds
    v_mfma_f32_16x16x32_bf16 v[168:171], a[0:3], a[0:3], v[168:171]
    v_mfma_f32_16x16x32_bf16 v[172:175], a[20:23], a[20:23], v[172:175]
    s_waitcnt lgkmcnt(0)
    v_mfma_f32_16x16x32_bf16 v[108:111], v[196:199], a[24:27], v[108:111]
    s_waitcnt vmcnt(9)
    s_barrier
    v_mfma_f32_16x16x32_bf16 v[112:115], v[196:199], a[28:31], v[112:115]
    ds_read_b64_tr_b16 v[180:181], v42 offset:9216
    s_mul_i32 s46, s45, s44
    v_mfma_f32_16x16x32_bf16 v[116:119], v[196:199], a[32:35], v[116:119]
    ds_read_b64_tr_b16 v[182:183], v42 offset:9360
    v_mfma_f32_16x16x32_bf16 v[120:123], v[196:199], a[36:39], v[120:123]
    ds_read_b128 a[0:3], v32 offset:0
    v_mfma_f32_16x16x32_bf16 v[124:127], v[196:199], a[40:43], v[124:127]
    ds_read_b128 a[4:7], v32 offset:2048
    s_add_u32 s45, s45, 1
    s_cmp_eq_u32 s45, 9
    s_cselect_b32 s45, 0, s45
    v_mfma_f32_16x16x32_bf16 v[128:131], v[200:203], a[24:27], v[128:131]
    ds_read_b128 a[8:11], v32 offset:4096
    v_mfma_f32_16x16x32_bf16 v[132:135], v[200:203], a[28:31], v[132:135]
    ds_read_b128 a[12:15], v32 offset:6144
    v_mfma_f32_16x16x32_bf16 v[136:139], v[200:203], a[32:35], v[136:139]
    ds_read_b128 a[16:19], v32 offset:8192
    s_add_u32 m0, s47, 37888
    v_mfma_f32_16x16x32_bf16 v[140:143], v[200:203], a[36:39], v[140:143]
    ds_read_b64_tr_b16 v[184:185], v42 offset:18432
    v_mfma_f32_16x16x32_bf16 v[144:147], v[200:203], a[40:43], v[144:147]
    ds_read_b64_tr_b16 v[186:187], v42 offset:18576
    v_mfma_f32_16x16x32_bf16 v[88:91], v[192:195], a[24:27], v[88:91]
    ds_read_b64_tr_b16 v[176:177], v42 offset:0
    buffer_load_dwordx4 v8, s[36:39], s46 offen offset:0  lds
    v_mfma_f32_16x16x32_bf16 v[92:95], v[192:195], a[28:31], v[92:95]
    ds_read_b64_tr_b16 v[178:179], v42 offset:144
    v_mfma_f32_16x16x32_bf16 v[96:99], v[192:195], a[32:35], v[96:99]
    ds_read_b64_tr_b16 v[188:189], v47 offset:0
    v_mfma_f32_16x16x32_bf16 v[100:103], v[192:195], a[36:39], v[100:103]
    ds_read_b64_tr_b16 v[190:191], v47 offset:144
    buffer_load_dwordx4 v9, s[36:39], s46 offen offset:1024  lds
    v_mfma_f32_16x16x32_bf16 v[104:107], v[192:195], a[40:43], v[104:107]
    ds_read_b128 a[20:23], v38
    v_mfma_f32_16x16x32_bf16 v[148:151], v[204:207], a[24:27], v[148:151]
    v_mfma_f32_16x16x32_bf16 v[152:155], v[204:207], a[28:31], v[152:155]
    buffer_load_dwordx4 v10, s[36:39], s46 offen offset:2048  lds
    v_mfma_f32_16x16x32_bf16 v[156:159], v[204:207], a[32:35], v[156:159]
    v_mfma_f32_16x16x32_bf16 v[160:163], v[204:207], a[36:39], v[160:163]
    v_mfma_f32_16x16x32_bf16 v[164:167], v[204:207], a[40:43], v[164:167]
    buffer_load_dwordx4 v11, s[36:39], s46 offen offset:3072  lds
    v_mfma_f32_16x16x32_bf16 v[168:171], a[24:27], a[24:27], v[168:171]
    v_mfma_f32_16x16x32_bf16 v[172:175], a[44:47], a[44:47], v[172:175]
    s_waitcnt lgkmcnt(0)
    v_mfma_f32_16x16x32_bf16 v[108:111], v[180:183], a[0:3], v[108:111]
    v_mfma_f32_16x16x32_bf16 v[112:115], v[180:183], a[4:7], v[112:115]
    ds_read_b64_tr_b16 v[196:197], v42 offset:13824
    s_add_u32 m0, s47, 41984
    v_mfma_f32_16x16x32_bf16 v[116:119], v[180:183], a[8:11], v[116:119]
    ds_read_b64_tr_b16 v[198:199], v42 offset:13968
    v_mfma_f32_16x16x32_bf16 v[120:123], v[180:183], a[12:15], v[120:123]
    ds_read_b128 a[24:27], v33 offset:0
    v_mfma_f32_16x16x32_bf16 v[124:127], v[180:183], a[16:19], v[124:127]
    ds_read_b128 a[28:31], v33 offset:2048
    buffer_load_dwordx4 v12, s[36:39], s46 offen offset:0  lds
    v_mfma_f32_16x16x32_bf16 v[128:131], v[184:187], a[0:3], v[128:131]
    ds_read_b128 a[32:35], v33 offset:4096
    v_mfma_f32_16x16x32_bf16 v[132:135], v[184:187], a[4:7], v[132:135]
    ds_read_b128 a[36:39], v33 offset:6144
    v_mfma_f32_16x16x32_bf16 v[136:139], v[184:187], a[8:11], v[136:139]
    ds_read_b128 a[40:43], v33 offset:8192
    buffer_load_dwordx4 v13, s[36:39], s46 offen offset:1024  lds
    v_mfma_f32_16x16x32_bf16 v[140:143], v[184:187], a[12:15], v[140:143]
    ds_read_b64_tr_b16 v[200:201], v42 offset:23040
    v_mfma_f32_16x16x32_bf16 v[144:147], v[184:187], a[16:19], v[144:147]
    ds_read_b64_tr_b16 v[202:203], v42 offset:23184
    v_mfma_f32_16x16x32_bf16 v[88:91], v[176:179], a[0:3], v[88:91]
    ds_read_b64_tr_b16 v[192:193], v42 offset:4608
    buffer_load_dwordx4 v14, s[36:39], s46 offen offset:2048  lds
    v_mfma_f32_16x16x32_bf16 v[92:95], v[176:179], a[4:7], v[92:95]
    ds_read_b64_tr_b16 v[194:195], v42 offset:4752
    v_mfma_f32_16x16x32_bf16 v[96:99], v[176:179], a[8:11], v[96:99]
    ds_read_b64_tr_b16 v[204:205], v48 offset:0
    v_mfma_f32_16x16x32_bf16 v[100:103], v[176:179], a[12:15], v[100:103]
    ds_read_b64_tr_b16 v[206:207], v48 offset:144
    buffer_load_dwordx4 v15, s[36:39], s46 offen offset:3072  lds
    v_mfma_f32_16x16x32_bf16 v[104:107], v[176:179], a[16:19], v[104:107]
    ds_read_b128 a[44:47], v39
    v_mfma_f32_16x16x32_bf16 v[148:151], v[188:191], a[0:3], v[148:151]
    v_mfma_f32_16x16x32_bf16 v[152:155], v[188:191], a[4:7], v[152:155]
    s_add_u32 m0, s47, 46080
    v_mfma_f32_16x16x32_bf16 v[156:159], v[188:191], a[8:11], v[156:159]
    v_mfma_f32_16x16x32_bf16 v[160:163], v[188:191], a[12:15], v[160:163]
    v_mfma_f32_16x16x32_bf16 v[164:167], v[188:191], a[16:19], v[164:167]
    buffer_load_dwordx4 v16, s[36:39], s46 offen offset:0  lds
    v_mfma_f32_16x16x32_bf16 v[168:171], a[0:3], a[0:3], v[168:171]
    v_mfma_f32_16x16x32_bf16 v[172:175], a[20:23], a[20:23], v[172:175]
    s_waitcnt lgkmcnt(0)
    v_mfma_f32_16x16x32_bf16 v[108:111], v[196:199], a[24:27], v[108:111]
    s_waitcnt vmcnt(9)
    s_barrier
    v_mfma_f32_16x16x32_bf16 v[112:115], v[196:199], a[28:31], v[112:115]
    ds_read_b64_tr_b16 v[180:181], v40 offset:9216
    s_mul_i32 s46, s45, s44
    v_mfma_f32_16x16x32_bf16 v[116:119], v[196:199], a[32:35], v[116:119]
    ds_read_b64_tr_b16 v[182:183], v40 offset:9360
    v_mfma_f32_16x16x32_bf16 v[120:123], v[196:199], a[36:39], v[120:123]
    ds_read_b128 a[0:3], v28 offset:0
    v_mfma_f32_16x16x32_bf16 v[124:127], v[196:199], a[40:43], v[124:127]
    ds_read_b128 a[4:7], v28 offset:2048
    s_add_u32 s45, s45, 1
    s_cmp_eq_u32 s45, 9
    s_cselect_b32 s45, 0, s45
    v_mfma_f32_16x16x32_bf16 v[128:131], v[200:203], a[24:27], v[128:131]
    ds_read_b128 a[8:11], v28 offset:4096
    v_mfma_f32_16x16x32_bf16 v[132:135], v[200:203], a[28:31], v[132:135]
    ds_read_b128 a[12:15], v28 offset:6144
    v_mfma_f32_16x16x32_bf16 v[136:139], v[200:203], a[32:35], v[136:139]
    ds_read_b128 a[16:19], v28 offset:8192
    s_add_u32 m0, s47, 75776
    v_mfma_f32_16x16x32_bf16 v[140:143], v[200:203], a[36:39], v[140:143]
    ds_read_b64_tr_b16 v[184:185], v40 offset:18432
    v_mfma_f32_16x16x32_bf16 v[144:147], v[200:203], a[40:43], v[144:147]
    ds_read_b64_tr_b16 v[186:187], v40 offset:18576
    v_mfma_f32_16x16x32_bf16 v[88:91], v[192:195], a[24:27], v[88:91]
    ds_read_b64_tr_b16 v[176:177], v40 offset:0
    buffer_load_dwordx4 v8, s[36:39], s46 offen offset:0  lds
    v_mfma_f32_16x16x32_bf16 v[92:95], v[192:195], a[28:31], v[92:95]
    ds_read_b64_tr_b16 v[178:179], v40 offset:144
    v_mfma_f32_16x16x32_bf16 v[96:99], v[192:195], a[32:35], v[96:99]
    ds_read_b64_tr_b16 v[188:189], v43 offset:0
    v_mfma_f32_16x16x32_bf16 v[100:103], v[192:195], a[36:39], v[100:103]
    ds_read_b64_tr_b16 v[190:191], v43 offset:144
    buffer_load_dwordx4 v9, s[36:39], s46 offen offset:1024  lds
    v_mfma_f32_16x16x32_bf16 v[104:107], v[192:195], a[40:43], v[104:107]
    ds_read_b128 a[20:23], v34
    v_mfma_f32_16x16x32_bf16 v[148:151], v[204:207], a[24:27], v[148:151]
    v_mfma_f32_16x16x32_bf16 v[152:155], v[204:207], a[28:31], v[152:155]
    buffer_load_dwordx4 v10, s[36:39], s46 offen offset:2048  lds
    v_mfma_f32_16x16x32_bf16 v[156:159], v[204:207], a[32:35], v[156:159]
    v_mfma_f32_16x16x32_bf16 v[160:163], v[204:207], a[36:39], v[160:163]
    v_mfma_f32_16x16x32_bf16 v[164:167], v[204:207], a[40:43], v[164:167]
    buffer_load_dwordx4 v11, s[36:39], s46 offen offset:3072  lds
    v_mfma_f32_16x16x32_bf16 v[168:171], a[24:27], a[24:27], v[168:171]
    v_mfma_f32_16x16x32_bf16 v[172:175], a[44:47], a[44:47], v[172:175]
    s_waitcnt lgkmcnt(0)
    v_mfma_f32_16x16x32_bf16 v[108:111], v[180:183], a[0:3], v[108:111]
    v_mfma_f32_16x16x32_bf16 v[112:115], v[180:183], a[4:7], v[112:115]
    ds_read_b64_tr_b16 v[196:197], v40 offset:13824
    s_add_u32 m0, s47, 79872
    v_mfma_f32_16x16x32_bf16 v[116:119], v[180:183], a[8:11], v[116:119]
    ds_read_b64_tr_b16 v[198:199], v40 offset:13968
    v_mfma_f32_16x16x32_bf16 v[120:123], v[180:183], a[12:15], v[120:123]
    ds_read_b128 a[24:27], v29 offset:0
    v_mfma_f32_16x16x32_bf16 v[124:127], v[180:183], a[16:19], v[124:127]
    ds_read_b128 a[28:31], v29 offset:2048
    buffer_load_dwordx4 v12, s[36:39], s46 offen offset:0  lds
    v_mfma_f32_16x16x32_bf16 v[128:131], v[184:187], a[0:3], v[128:131]
    ds_read_b128 a[32:35], v29 offset:4096
    v_mfma_f32_16x16x32_bf16 v[132:135], v[184:187], a[4:7], v[132:135]
    ds_read_b128 a[36:39], v29 offset:6144
    v_mfma_f32_16x16x32_bf16 v[136:139], v[184:187], a[8:11], v[136:139]
    ds_read_b128 a[40:43], v29 offset:8192
    buffer_load_dwordx4 v13, s[36:39], s46 offen offset:1024  lds
    v_mfma_f32_16x16x32_bf16 v[140:143], v[184:187], a[12:15], v[140:143]
    ds_read_b64_tr_b16 v[200:201], v40 offset:23040
    v_mfma_f32_16x16x32_bf16 v[144:147], v[184:187], a[16:19], v[144:147]
    ds_read_b64_tr_b16 v[202:203], v40 offset:23184
    v_mfma_f32_16x16x32_bf16 v[88:91], v[176:179], a[0:3], v[88:91]
    ds_read_b64_tr_b16 v[192:193], v40 offset:4608
    buffer_load_dwordx4 v14, s[36:39], s46 offen offset:2048  lds
    v_mfma_f32_16x16x32_bf16 v[92:95], v[176:179], a[4:7], v[92:95]
    ds_read_b64_tr_b16 v[194:195], v40 offset:4752
    v_mfma_f32_16x16x32_bf16 v[96:99], v[176:179], a[8:11], v[96:99]
    ds_read_b64_tr_b16 v[204:205], v44 offset:0
    v_mfma_f32_16x16x32_bf16 v[100:103], v[176:179], a[12:15], v[100:103]
    ds_read_b64_tr_b16 v[206:207], v44 offset:144
    buffer_load_dwordx4 v15, s[36:39], s46 offen offset:3072  lds
    v_mfma_f32_16x16x32_bf16 v[104:107], v[176:179], a[16:19], v[104:107]
    ds_read_b128 a[44:47], v35
    v_mfma_f32_16x16x32_bf16 v[148:151], v[188:191], a[0:3], v[148:151]
    v_mfma_f32_16x16x32_bf16 v[152:155], v[188:191], a[4:7], v[152:155]
    s_add_u32 m0, s47, 83968
    v_mfma_f32_16x16x32_bf16 v[156:159], v[188:191], a[8:11], v[156:159]
    v_mfma_f32_16x16x32_bf16 v[160:163], v[188:191], a[12:15], v[160:163]
    v_mfma_f32_16x16x32_bf16 v[164:167], v[188:191], a[16:19], v[164:167]
    buffer_load_dwordx4 v16, s[36:39], s46 offen offset:0  lds
    v_mfma_f32_16x16x32_bf16 v[168:171], a[0:3], a[0:3], v[168:171]
    v_mfma_f32_16x16x32_bf16 v[172:175], a[20:23], a[20:23], v[172:175]
    s_waitcnt lgkmcnt(0)
    v_mfma_f32_16x16x32_bf16 v[108:111], v[196:199], a[24:27], v[108:111]
    s_waitcnt vmcnt(9)
    s_barrier
    v_mfma_f32_16x16x32_bf16 v[112:115], v[196:199], a[28:31], v[112:115]
    ds_read_b64_tr_b16 v[180:181], v41 offset:9216
    s_mul_i32 s46, s45, s44
    v_mfma_f32_16x16x32_bf16 v[116:119], v[196:199], a[32:35], v[116:119]
    ds_read_b64_tr_b16 v[182:183], v41 offset:9360
    v_mfma_f32_16x16x32_bf16 v[120:123], v[196:199], a[36:39], v[120:123]
    ds_read_b128 a[0:3], v30 offset:0
    v_mfma_f32_16x16x32_bf16 v[124:127], v[196:199], a[40:43], v[124:127]
    ds_read_b128 a[4:7], v30 offset:2048
    s_add_u32 s45, s45, 1
    s_cmp_eq_u32 s45, 9
    s_cselect_b32 s45, 0, s45
    v_mfma_f32_16x16x32_bf16 v[128:131], v[200:203], a[24:27], v[128:131]
    ds_read_b128 a[8:11], v30 offset:4096
    v_mfma_f32_16x16x32_bf16 v[132:135], v[200:203], a[28:31], v[132:135]
    ds_read_b128 a[12:15], v30 offset:6144
    v_mfma_f32_16x16x32_bf16 v[136:139], v[200:203], a[32:35], v[136:139]
    ds_read_b128 a[16:19], v30 offset:8192
    s_add_u32 m0, s47, 0
    v_mfma_f32_16x16x32_bf16 v[140:143], v[200:203], a[36:39], v[140:143]
    ds_read_b64_tr_b16 v[184:185], v41 offset:18432
    v_mfma_f32_16x16x32_bf16 v[144:147], v[200:203], a[40:43], v[144:147]
    ds_read_b64_tr_b16 v[186:187], v41 offset:18576
    v_mfma_f32_16x16x32_bf16 v[88:91], v[192:195], a[24:27], v[88:91]
    ds_read_b64_tr_b16 v[176:177], v41 offset:0
    buffer_load_dwordx4 v8, s[36:39], s46 offen offset:0  lds
    v_mfma_f32_16x16x32_bf16 v[92:95], v[192:195], a[28:31], v[92:95]
    ds_read_b64_tr_b16 v[178:179], v41 offset:144
    v_mfma_f32_16x16x32_bf16 v[96:99], v[192:195], a[32:35], v[96:99]
    ds_read_b64_tr_b16 v[188:189], v45 offset:0
    v_mfma_f32_16x16x32_bf16 v[100:103], v[192:195], a[36:39], v[100:103]
    ds_read_b64_tr_b16 v[190:191], v45 offset:144
    buffer_load_dwordx4 v9, s[36:39], s46 offen offset:1024  lds
    v_mfma_f32_16x16x32_bf16 v[104:107], v[192:195], a[40:43], v[104:107]
    ds_read_b128 a[20:23], v36
    v_mfma_f32_16x16x32_bf16 v[148:151], v[204:207], a[24:27], v[148:151]
    v_mfma_f32_16x16x32_bf16 v[152:155], v[204:207], a[28:31], v[152:155]
    buffer_load_dwordx4 v10, s[36:39], s46 offen offset:2048  lds
    v_mfma_f32_16x16x32_bf16 v[156:159], v[204:207], a[32:35], v[156:159]
    v_mfma_f32_16x16x32_bf16 v[160:163], v[204:207], a[36:39], v[160:163]
    v_mfma_f32_16x16x32_bf16 v[164:167], v[204:207], a[40:43], v[164:167]
    buffer_load_dwordx4 v11, s[36:39], s46 offen offset:3072  lds
    v_mfma_f32_16x16x32_bf16 v[168:171], a[24:27], a[24:27], v[168:171]
    v_mfma_f32_16x16x32_bf16 v[172:175], a[44:47], a[44:47], v[172:175]
    s_waitcnt lgkmcnt(0)
    v_mfma_f32_16x16x32_bf16 v[108:111], v[180:183], a[0:3], v[108:111]
    v_mfma_f32_16x16x32_bf16 v[112:115], v[180:183], a[4:7], v[112:115]
    ds_read_b64_tr_b16 v[196:197], v41 offset:13824
    s_add_u32 m0, s47, 4096
    v_mfma_f32_16x16x32_bf16 v[116:119], v[180:183], a[8:11], v[116:119]
    ds_read_b64_tr_b16 v[198:199], v41 offset:13968
    v_mfma_f32_16x16x32_bf16 v[120:123], v[180:183], a[12:15], v[120:123]
    ds_read_b128 a[24:27], v31 offset:0
    v_mfma_f32_16x16x32_bf16 v[124:127], v[180:183], a[16:19], v[124:127]
    ds_read_b128 a[28:31], v31 offset:2048
    buffer_load_dwordx4 v12, s[36:39], s46 offen offset:0  lds
    v_mfma_f32_16x16x32_bf16 v[128:131], v[184:187], a[0:3], v[128:131]
    ds_read_b128 a[32:35], v31 offset:4096
    v_mfma_f32_16x16x32_bf16 v[132:135], v[184:187], a[4:7], v[132:135]
    ds_read_b128 a[36:39], v31 offset:6144
    v_mfma_f32_16x16x32_bf16 v[136:139], v[184:187], a[8:11], v[136:139]
    ds_read_b128 a[40:43], v31 offset:8192
    buffer_load_dwordx4 v13, s[36:39], s46 offen offset:1024  lds
    v_mfma_f32_16x16x32_bf16 v[140:143], v[184:187], a[12:15], v[140:143]
    ds_read_b64_tr_b16 v[200:201], v41 offset:23040
    v_mfma_f32_16x16x32_bf16 v[144:147], v[184:187], a[16:19], v[144:147]
    ds_read_b64_tr_b16 v[202:203], v41 offset:23184
    v_mfma_f32_16x16x32_bf16 v[88:91], v[176:179], a[0:3], v[88:91]
    ds_read_b64_tr_b16 v[192:193], v41 offset:4608
    buffer_load_dwordx4 v14, s[36:39], s46 offen offset:2048  lds
    v_mfma_f32_16x16x32_bf16 v[92:95], v[176:179], a[4:7], v[92:95]
    ds_read_b64_tr_b16 v[194:195], v41 offset:4752
    v_mfma_f32_16x16x32_bf16 v[96:99], v[176:179], a[8:11], v[96:99]
    ds_read_b64_tr_b16 v[204:205], v46 offset:0
    v_mfma_f32_16x16x32_bf16 v[100:103], v[176:179], a[12:15], v[100:103]
    ds_read_b64_tr_b16 v[206:207], v46 offset:144
    buffer_load_dwordx4 v15, s[36:39], s46 offen offset:3072  lds
    v_mfma_f32_16x16x32_bf16 v[104:107], v[176:179], a[16:19], v[104:107]
    ds_read_b128 a[44:47], v37
    v_mfma_f32_16x16x32_bf16 v[148:151], v[188:191], a[0:3], v[148:151]
    v_mfma_f32_16x16x32_bf16 v[152:155], v[188:191], a[4:7], v[152:155]
    s_add_u32 m0, s47, 8192
    v_mfma_f32_16x16x32_bf16 v[156:159], v[188:191], a[8:11], v[156:159]
    v_mfma_f32_16x16x32_bf16 v[160:163], v[188:191], a[12:15], v[160:163]
    v_mfma_f32_16x16x32_bf16 v[164:167], v[188:191], a[16:19], v[164:167]
    buffer_load_dwordx4 v16, s[36:39], s46 offen offset:0  lds
    v_mfma_f32_16x16x32_bf16 v[168:171], a[0:3], a[0:3], v[168:171]
    v_mfma_f32_16x16x32_bf16 v[172:175], a[20:23], a[20:23], v[172:175]
    s_waitcnt lgkmcnt(0)
    v_mfma_f32_16x16x32_bf16 v[108:111], v[196:199], a[24:27], v[108:111]
    s_waitcnt vmcnt(9)
    s_barrier
    v_mfma_f32_16x16x32_bf16 v[112:115], v[196:199], a[28:31], v[112:115]
    ds_read_b64_tr_b16 v[180:181], v42 offset:9216
    s_mul_i32 s46, s45, s44
    v_mfma_f32_16x16x32_bf16 v[116:119], v[196:199], a[32:35], v[116:119]
    ds_read_b64_tr_b16 v[182:183], v42 offset:9360
    v_mfma_f32_16x16x32_bf16 v[120:123], v[196:199], a[36:39], v[120:123]
    ds_read_b128 a[0:3], v32 offset:0
    v_mfma_f32_16x16x32_bf16 v[124:127], v[196:199], a[40:43], v[124:127]
    ds_read_b128 a[4:7], v32 offset:2048
    s_add_u32 s45, s45, 1
    s_cmp_eq_u32 s45, 9
    s_cselect_b32 s45, 0, s45
    v_mfma_f32_16x16x32_bf16 v[128:131], v[200:203], a[24:27], v[128:131]
    ds_read_b128 a[8:11], v32 offset:4096
    v_mfma_f32_16x16x32_bf16 v[132:135], v[200:203], a[28:31], v[132:135]
    ds_read_b128 a[12:15], v32 offset:6144
    v_mfma_f32_16x16x32_bf16 v[136:139], v[200:203], a[32:35], v[136:139]
    ds_read_b128 a[16:19], v32 offset:8192
    s_add_u32 m0, s47, 37888
    v_mfma_f32_16x16x32_bf16 v[140:143], v[200:203], a[36:39], v[140:143]
    ds_read_b64_tr_b16 v[184:185], v42 offset:18432
    v_mfma_f32_16x16x32_bf16 v[144:147], v[200:203], a[40:43], v[144:147]
    ds_read_b64_tr_b16 v[186:187], v42 offset:18576
    v_mfma_f32_16x16x32_bf16 v[88:91], v[192:195], a[24:27], v[88:91]
    ds_read_b64_tr_b16 v[176:177], v42 offset:0
    buffer_load_dwordx4 v8, s[36:39], s46 offen offset:0  lds
    v_mfma_f32_16x16x32_bf16 v[92:95], v[192:195], a[28:31], v[92:95]
    ds_read_b64_tr_b16 v[178:179], v42 offset:144
    v_mfma_f32_16x16x32_bf16 v[96:99], v[192:195], a[32:35], v[96:99]
    ds_read_b64_tr_b16 v[188:189], v47 offset:0
    v_mfma_f32_16x16x32_bf16 v[100:103], v[192:195], a[36:39], v[100:103]
    ds_read_b64_tr_b16 v[190:191], v47 offset:144
    buffer_load_dwordx4 v9, s[36:39], s46 offen offset:1024  lds
    v_mfma_f32_16x16x32_bf16 v[104:107], v[192:195], a[40:43], v[104:107]
    ds_read_b128 a[20:23], v38
    v_mfma_f32_16x16x32_bf16 v[148:151], v[204:207], a[24:27], v[148:151]
    v_mfma_f32_16x16x32_bf16 v[152:155], v[204:207], a[28:31], v[152:155]
    buffer_load_dwordx4 v10, s[36:39], s46 offen offset:2048  lds
    v_mfma_f32_16x16x32_bf16 v[156:159], v[204:207], a[32:35], v[156:159]
    v_mfma_f32_16x16x32_bf16 v[160:163], v[204:207], a[36:39], v[160:163]
    v_mfma_f32_16x16x32_bf16 v[164:167], v[204:207], a[40:43], v[164:167]
    buffer_load_dwordx4 v11, s[36:39], s46 offen offset:3072  lds
    v_mfma_f32_16x16x32_bf16 v[168:171], a[24:27], a[24:27], v[168:171]
    v_mfma_f32_16x16x32_bf16 v[172:175], a[44:47], a[44:47], v[172:175]
    s_waitcnt lgkmcnt(0)
    v_mfma_f32_16x16x32_bf16 v[108:111], v[180:183], a[0:3], v[108:111]
    v_mfma_f32_16x16x32_bf16 v[112:115], v[180:183], a[4:7], v[112:115]
    ds_read_b64_tr_b16 v[196:197], v42 offset:13824
    s_add_u32 m0, s47, 41984
    v_mfma_f32_16x16x32_bf16 v[116:119], v[180:183], a[8:11], v[116:119]
    ds_read_b64_tr_b16 v[198:199], v42 offset:13968
    v_mfma_f32_16x16x32_bf16 v[120:123], v[180:183], a[12:15], v[120:123]
    ds_read_b128 a[24:27], v33 offset:0
    v_mfma_f32_16x16x32_bf16 v[124:127], v[180:183], a[16:19], v[124:127]
    ds_read_b128 a[28:31], v33 offset:2048
    buffer_load_dwordx4 v12, s[36:39], s46 offen offset:0  lds
    v_mfma_f32_16x16x32_bf16 v[128:131], v[184:187], a[0:3], v[128:131]
    ds_read_b128 a[32:35], v33 offset:4096
    v_mfma_f32_16x16x32_bf16 v[132:135], v[184:187], a[4:7], v[132:135]
    ds_read_b128 a[36:39], v33 offset:6144
    v_mfma_f32_16x16x32_bf16 v[136:139], v[184:187], a[8:11], v[136:139]
    ds_read_b128 a[40:43], v33 offset:8192
    buffer_load_dwordx4 v13, s[36:39], s46 offen offset:1024  lds
    v_mfma_f32_16x16x32_bf16 v[140:143], v[184:187], a[12:15], v[140:143]
    ds_read_b64_tr_b16 v[200:201], v42 offset:23040
    v_mfma_f32_16x16x32_bf16 v[144:147], v[184:187], a[16:19], v[144:147]
    ds_read_b64_tr_b16 v[202:203], v42 offset:23184
    v_mfma_f32_16x16x32_bf16 v[88:91], v[176:179], a[0:3], v[88:91]
    ds_read_b64_tr_b16 v[192:193], v42 offset:4608
    buffer_load_dwordx4 v14, s[36:39], s46 offen offset:2048  lds
    v_mfma_f32_16x16x32_bf16 v[92:95], v[176:179], a[4:7], v[92:95]
    ds_read_b64_tr_b16 v[194:195], v42 offset:4752
    v_mfma_f32_16x16x32_bf16 v[96:99], v[176:179], a[8:11], v[96:99]
    ds_read_b64_tr_b16 v[204:205], v48 offset:0
    v_mfma_f32_16x16x32_bf16 v[100:103], v[176:179], a[12:15], v[100:103]
    ds_read_b64_tr_b16 v[206:207], v48 offset:144
    buffer_load_dwordx4 v15, s[36:39], s46 offen offset:3072  lds
    v_mfma_f32_16x16x32_bf16 v[104:107], v[176:179], a[16:19], v[104:107]
    ds_read_b128 a[44:47], v39
    v_mfma_f32_16x16x32_bf16 v[148:151], v[188:191], a[0:3], v[148:151]
    v_mfma_f32_16x16x32_bf16 v[152:155], v[188:191], a[4:7], v[152:155]
    s_add_u32 m0, s47, 46080
    v_mfma_f32_16x16x32_bf16 v[156:159], v[188:191], a[8:11], v[156:159]
    v_mfma_f32_16x16x32_bf16 v[160:163], v[188:191], a[12:15], v[160:163]
    v_mfma_f32_16x16x32_bf16 v[164:167], v[188:191], a[16:19], v[164:167]
    buffer_load_dwordx4 v16, s[36:39], s46 offen offset:0  lds
    v_mfma_f32_16x16x32_bf16 v[168:171], a[0:3], a[0:3], v[168:171]
    v_mfma_f32_16x16x32_bf16 v[172:175], a[20:23], a[20:23], v[172:175]
    s_waitcnt lgkmcnt(0)
    v_mfma_f32_16x16x32_bf16 v[108:111], v[196:199], a[24:27], v[108:111]
    s_waitcnt vmcnt(9)
    s_barrier
    v_mfma_f32_16x16x32_bf16 v[112:115], v[196:199], a[28:31], v[112:115]
    ds_read_b64_tr_b16 v[180:181], v40 offset:9216
    s_mul_i32 s46, s45, s44
    v_mfma_f32_16x16x32_bf16 v[116:119], v[196:199], a[32:35], v[116:119]
    ds_read_b64_tr_b16 v[182:183], v40 offset:9360
    v_mfma_f32_16x16x32_bf16 v[120:123], v[196:199], a[36:39], v[120:123]
    ds_read_b128 a[0:3], v28 offset:0
    s_add_u32 s45, s45, 1
    s_cmp_eq_u32 s45, 9
    s_cselect_b32 s45, 0, s45
    v_mfma_f32_16x16x32_bf16 v[124:127], v[196:199], a[40:43], v[124:127]
    ds_read_b128 a[4:7], v28 offset:2048
    v_mfma_f32_16x16x32_bf16 v[128:131], v[200:203], a[24:27], v[128:131]
    ds_read_b128 a[8:11], v28 offset:4096
    v_mfma_f32_16x16x32_bf16 v[132:135], v[200:203], a[28:31], v[132:135]
    ds_read_b128 a[12:15], v28 offset:6144
    s_add_u32 m0, s47, 75776
    v_mfma_f32_16x16x32_bf16 v[136:139], v[200:203], a[32:35], v[136:139]
    ds_read_b128 a[16:19], v28 offset:8192
    v_mfma_f32_16x16x32_bf16 v[140:143], v[200:203], a[36:39], v[140:143]
    ds_read_b64_tr_b16 v[184:185], v40 offset:18432
    buffer_load_dwordx4 v8, s[36:39], s46 offen offset:0  lds
    v_mfma_f32_16x16x32_bf16 v[144:147], v[200:203], a[40:43], v[144:147]
    ds_read_b64_tr_b16 v[186:187], v40 offset:18576
    v_mfma_f32_16x16x32_bf16 v[88:91], v[192:195], a[24:27], v[88:91]
    ds_read_b64_tr_b16 v[176:177], v40 offset:0
    v_mfma_f32_16x16x32_bf16 v[92:95], v[192:195], a[28:31], v[92:95]
    ds_read_b64_tr_b16 v[178:179], v40 offset:144
    buffer_load_dwordx4 v9, s[36:39], s46 offen offset:1024  lds
    v_mfma_f32_16x16x32_bf16 v[96:99], v[192:195], a[32:35], v[96:99]
    ds_read_b64_tr_b16 v[188:189], v43 offset:0
    v_mfma_f32_16x16x32_bf16 v[100:103], v[192:195], a[36:39], v[100:103]
    ds_read_b64_tr_b16 v[190:191], v43 offset:144
    v_mfma_f32_16x16x32_bf16 v[104:107], v[192:195], a[40:43], v[104:107]
    ds_read_b128 a[20:23], v34
    buffer_load_dwordx4 v10, s[36:39], s46 offen offset:2048  lds
    v_mfma_f32_16x16x32_bf16 v[148:151], v[204:207], a[24:27], v[148:151]
    v_mfma_f32_16x16x32_bf16 v[152:155], v[204:207], a[28:31], v[152:155]
    buffer_load_dwordx4 v11, s[36:39], s46 offen offset:3072  lds
    v_mfma_f32_16x16x32_bf16 v[156:159], v[204:207], a[32:35], v[156:159]
    v_mfma_f32_16x16x32_bf16 v[160:163], v[204:207], a[36:39], v[160:163]
    v_mfma_f32_16x16x32_bf16 v[164:167], v[204:207], a[40:43], v[164:167]
    s_add_u32 m0, s47, 79872
    v_mfma_f32_16x16x32_bf16 v[168:171], a[24:27], a[24:27], v[168:171]
    v_mfma_f32_16x16x32_bf16 v[172:175], a[44:47], a[44:47], v[172:175]
    s_waitcnt lgkmcnt(0)
    v_mfma_f32_16x16x32_bf16 v[108:111], v[180:183], a[0:3], v[108:111]
    v_mfma_f32_16x16x32_bf16 v[112:115], v[180:183], a[4:7], v[112:115]
    ds_read_b64_tr_b16 v[196:197], v40 offset:13824
    buffer_load_dwordx4 v12, s[36:39], s46 offen offset:0  lds
    v_mfma_f32_16x16x32_bf16 v[116:119], v[180:183], a[8:11], v[116:119]
    ds_read_b64_tr_b16 v[198:199], v40 offset:13968
    v_mfma_f32_16x16x32_bf16 v[120:123], v[180:183], a[12:15], v[120:123]
    ds_read_b128 a[24:27], v29 offset:0
    buffer_load_dwordx4 v13, s[36:39], s46 offen offset:1024  lds
    v_mfma_f32_16x16x32_bf16 v[124:127], v[180:183], a[16:19], v[124:127]
    ds_read_b128 a[28:31], v29 offset:2048
    v_mfma_f32_16x16x32_bf16 v[128:131], v[184:187], a[0:3], v[128:131]
    ds_read_b128 a[32:35], v29 offset:4096
    v_mfma_f32_16x16x32_bf16 v[132:135], v[184:187], a[4:7], v[132:135]
    ds_read_b128 a[36:39], v29 offset:6144
    buffer_load_dwordx4 v14, s[36:39], s46 offen offset:2048  lds
    v_mfma_f32_16x16x32_bf16 v[136:139], v[184:187], a[8:11], v[136:139]
    ds_read_b128 a[40:43], v29 offset:8192
    v_mfma_f32_16x16x32_bf16 v[140:143], v[184:187], a[12:15], v[140:143]
    ds_read_b64_tr_b16 v[200:201], v40 offset:23040
    buffer_load_dwordx4 v15, s[36:39], s46 offen offset:3072  lds
    v_mfma_f32_16x16x32_bf16 v[144:147], v[184:187], a[16:19], v[144:147]
    ds_read_b64_tr_b16 v[202:203], v40 offset:23184
    v_mfma_f32_16x16x32_bf16 v[88:91], v[176:179], a[0:3], v[88:91]
    ds_read_b64_tr_b16 v[192:193], v40 offset:4608
    v_mfma_f32_16x16x32_bf16 v[92:95], v[176:179], a[4:7], v[92:95]
    ds_read_b64_tr_b16 v[194:195], v40 offset:4752
    s_add_u32 m0, s47, 83968
    v_mfma_f32_16x16x32_bf16 v[96:99], v[176:179], a[8:11], v[96:99]
    ds_read_b64_tr_b16 v[204:205], v44 offset:0
    v_mfma_f32_16x16x32_bf16 v[100:103], v[176:179], a[12:15], v[100:103]
    ds_read_b64_tr_b16 v[206:207], v44 offset:144
    v_mfma_f32_16x16x32_bf16 v[104:107], v[176:179], a[16:19], v[104:107]
    ds_read_b128 a[44:47], v35
    buffer_load_dwordx4 v16, s[36:39], s46 offen offset:0  lds
    v_mfma_f32_16x16x32_bf16 v[148:151], v[188:191], a[0:3], v[148:151]
    v_mfma_f32_16x16x32_bf16 v[152:155], v[188:191], a[4:7], v[152:155]
    v_lshlrev_b32 v86, 2, v2
    v_mfma_f32_16x16x32_bf16 v[156:159], v[188:191], a[8:11], v[156:159]
    v_mfma_f32_16x16x32_bf16 v[160:163], v[188:191], a[12:15], v[160:163]
    v_mfma_f32_16x16x32_bf16 v[164:167], v[188:191], a[16:19], v[164:167]
    buffer_load_dword v85, v86, s[56:59], 0 offen sc1
    v_mfma_f32_16x16x32_bf16 v[168:171], a[0:3], a[0:3], v[168:171]
    v_mfma_f32_16x16x32_bf16 v[172:175], a[20:23], a[20:23], v[172:175]
    s_waitcnt lgkmcnt(0)
    s_sub_u32 s92, s12, 4096
    s_subb_u32 s93, s13, 0
    s_mov_b32 s94, 5312512
    s_mov_b32 s95, 0x20000
    v_mfma_f32_16x16x32_bf16 v[108:111], v[196:199], a[24:27], v[108:111]
    s_waitcnt vmcnt(10)
    s_barrier
    v_mfma_f32_16x16x32_bf16 v[112:115], v[196:199], a[28:31], v[112:115]
    ds_read_b64_tr_b16 v[180:181], v41 offset:9216
    s_mul_i32 s32, s64, 911
    s_lshr_b32 s32, s32, 16
    s_mul_i32 s33, s32, 72
    s_sub_u32 s33, s64, s33
    s_lshl_b32 s32, s32, 2
    s_add_u32 s32, s32, s3
    s_mul_i32 s96, s32, 18432
    s_lshl_b32 s34, s33, 8
    s_add_u32 s96, s96, s34
    s_add_u32 s96, s96, 7864320
    s_mul_i32 s32, s32, 442368
    s_lshl_b32 s33, s33, 7
    s_add_u32 s32, s32, s33
    s_add_u32 s32, s32, 4096
    v_lshrrev_b32 v218, 3, v1
    v_mul_u32_u24 v218, 9216, v218
    v_and_b32 v19, 7, v1
    v_lshl_add_u32 v218, v19, 4, v218
    v_add_u32 v218, s32, v218
    v_mfma_f32_16x16x32_bf16 v[116:119], v[196:199], a[32:35], v[116:119]
    ds_read_b64_tr_b16 v[182:183], v41 offset:9360
    v_mfma_f32_16x16x32_bf16 v[120:123], v[196:199], a[36:39], v[120:123]
    ds_read_b128 a[0:3], v30 offset:0
    v_mfma_f32_16x16x32_bf16 v[124:127], v[196:199], a[40:43], v[124:127]
    ds_read_b128 a[4:7], v30 offset:2048
    v_mfma_f32_16x16x32_bf16 v[128:131], v[200:203], a[24:27], v[128:131]
    ds_read_b128 a[8:11], v30 offset:4096
    v_mfma_f32_16x16x32_bf16 v[132:135], v[200:203], a[28:31], v[132:135]
    ds_read_b128 a[12:15], v30 offset:6144
    v_mfma_f32_16x16x32_bf16 v[136:139], v[200:203], a[32:35], v[136:139]
    ds_read_b128 a[16:19], v30 offset:8192
    v_mfma_f32_16x16x32_bf16 v[140:143], v[200:203], a[36:39], v[140:143]
    ds_read_b64_tr_b16 v[184:185], v41 offset:18432
    buffer_load_dwordx4 a[48:51], v218, s[92:95], 0 offen
    v_add_u32 v218, 73728, v218
    v_mfma_f32_16x16x32_bf16 v[144:147], v[200:203], a[40:43], v[144:147]
    ds_read_b64_tr_b16 v[186:187], v41 offset:18576
    v_mfma_f32_16x16x32_bf16 v[88:91], v[192:195], a[24:27], v[88:91]
    ds_read_b64_tr_b16 v[176:177], v41 offset:0
    v_mfma_f32_16x16x32_bf16 v[92:95], v[192:195], a[28:31], v[92:95]
    ds_read_b64_tr_b16 v[178:179], v41 offset:144
    v_mfma_f32_16x16x32_bf16 v[96:99], v[192:195], a[32:35], v[96:99]
    ds_read_b64_tr_b16 v[188:189], v45 offset:0
    v_mfma_f32_16x16x32_bf16 v[100:103], v[192:195], a[36:39], v[100:103]
    ds_read_b64_tr_b16 v[190:191], v45 offset:144
    v_mfma_f32_16x16x32_bf16 v[104:107], v[192:195], a[40:43], v[104:107]
    ds_read_b128 a[20:23], v36
    v_mfma_f32_16x16x32_bf16 v[148:151], v[204:207], a[24:27], v[148:151]
    buffer_load_dwordx4 a[52:55], v218, s[92:95], 0 offen
    v_add_u32 v218, 73728, v218
    v_mfma_f32_16x16x32_bf16 v[152:155], v[204:207], a[28:31], v[152:155]
    v_mfma_f32_16x16x32_bf16 v[156:159], v[204:207], a[32:35], v[156:159]
    v_mfma_f32_16x16x32_bf16 v[160:163], v[204:207], a[36:39], v[160:163]
    v_mfma_f32_16x16x32_bf16 v[164:167], v[204:207], a[40:43], v[164:167]
    v_mfma_f32_16x16x32_bf16 v[168:171], a[24:27], a[24:27], v[168:171]
    v_mfma_f32_16x16x32_bf16 v[172:175], a[44:47], a[44:47], v[172:175]
    s_waitcnt lgkmcnt(0)
    v_mfma_f32_16x16x32_bf16 v[108:111], v[180:183], a[0:3], v[108:111]
    v_mfma_f32_16x16x32_bf16 v[112:115], v[180:183], a[4:7], v[112:115]
    ds_read_b64_tr_b16 v[196:197], v41 offset:13824
    buffer_load_dwordx4 a[56:59], v218, s[92:95], 0 offen
    v_add_u32 v218, 73728, v218
    v_mfma_f32_16x16x32_bf16 v[116:119], v[180:183], a[8:11], v[116:119]
    ds_read_b64_tr_b16 v[198:199], v41 offset:13968
    v_mfma_f32_16x16x32_bf16 v[120:123], v[180:183], a[12:15], v[120:123]
    ds_read_b128 a[24:27], v31 offset:0
    v_mfma_f32_16x16x32_bf16 v[124:127], v[180:183], a[16:19], v[124:127]
    ds_read_b128 a[28:31], v31 offset:2048
    v_mfma_f32_16x16x32_bf16 v[128:131], v[184:187], a[0:3], v[128:131]
    ds_read_b128 a[32:35], v31 offset:4096
    v_mfma_f32_16x16x32_bf16 v[132:135], v[184:187], a[4:7], v[132:135]
    ds_read_b128 a[36:39], v31 offset:6144
    v_mfma_f32_16x16x32_bf16 v[136:139], v[184:187], a[8:11], v[136:139]
    ds_read_b128 a[40:43], v31 offset:8192
    v_mfma_f32_16x16x32_bf16 v[140:143], v[184:187], a[12:15], v[140:143]
    ds_read_b64_tr_b16 v[200:201], v41 offset:23040
    buffer_load_dwordx4 a[60:63], v218, s[92:95], 0 offen
    v_add_u32 v218, 73728, v218
    v_mfma_f32_16x16x32_bf16 v[144:147], v[184:187], a[16:19], v[144:147]
    ds_read_b64_tr_b16 v[202:203], v41 offset:23184
    v_mfma_f32_16x16x32_bf16 v[88:91], v[176:179], a[0:3], v[88:91]
    ds_read_b64_tr_b16 v[192:193], v41 offset:4608
    v_mfma_f32_16x16x32_bf16 v[92:95], v[176:179], a[4:7], v[92:95]
    ds_read_b64_tr_b16 v[194:195], v41 offset:4752
    v_mfma_f32_16x16x32_bf16 v[96:99], v[176:179], a[8:11], v[96:99]
    ds_read_b64_tr_b16 v[204:205], v46 offset:0
    v_mfma_f32_16x16x32_bf16 v[100:103], v[176:179], a[12:15], v[100:103]
    ds_read_b64_tr_b16 v[206:207], v46 offset:144
    v_mfma_f32_16x16x32_bf16 v[104:107], v[176:179], a[16:19], v[104:107]
    ds_read_b128 a[44:47], v37
    v_mfma_f32_16x16x32_bf16 v[148:151], v[188:191], a[0:3], v[148:151]
    buffer_load_dwordx4 a[64:67], v218, s[92:95], 0 offen
    v_add_u32 v218, 73728, v218
    v_mfma_f32_16x16x32_bf16 v[152:155], v[188:191], a[4:7], v[152:155]
    v_mfma_f32_16x16x32_bf16 v[156:159], v[188:191], a[8:11], v[156:159]
    v_mfma_f32_16x16x32_bf16 v[160:163], v[188:191], a[12:15], v[160:163]
    v_mfma_f32_16x16x32_bf16 v[164:167], v[188:191], a[16:19], v[164:167]
    v_mfma_f32_16x16x32_bf16 v[168:171], a[0:3], a[0:3], v[168:171]
    v_mfma_f32_16x16x32_bf16 v[172:175], a[20:23], a[20:23], v[172:175]
    s_waitcnt lgkmcnt(0)
    v_mfma_f32_16x16x32_bf16 v[108:111], v[196:199], a[24:27], v[108:111]
    s_waitcnt vmcnt(6)
    s_barrier
    v_mfma_f32_16x16x32_bf16 v[112:115], v[196:199], a[28:31], v[112:115]
    ds_read_b64_tr_b16 v[180:181], v42 offset:9216
    buffer_load_dwordx4 a[68:71], v218, s[92:95], 0 offen
    v_mfma_f32_16x16x32_bf16 v[116:119], v[196:199], a[32:35], v[116:119]
    ds_read_b64_tr_b16 v[182:183], v42 offset:9360
    v_mfma_f32_16x16x32_bf16 v[120:123], v[196:199], a[36:39], v[120:123]
    ds_read_b128 a[0:3], v32 offset:0
    v_mfma_f32_16x16x32_bf16 v[124:127], v[196:199], a[40:43], v[124:127]
    ds_read_b128 a[4:7], v32 offset:2048
    v_mfma_f32_16x16x32_bf16 v[128:131], v[200:203], a[24:27], v[128:131]
    ds_read_b128 a[8:11], v32 offset:4096
    v_mfma_f32_16x16x32_bf16 v[132:135], v[200:203], a[28:31], v[132:135]
    ds_read_b128 a[12:15], v32 offset:6144
    v_mfma_f32_16x16x32_bf16 v[136:139], v[200:203], a[32:35], v[136:139]
    ds_read_b128 a[16:19], v32 offset:8192
    v_mfma_f32_16x16x32_bf16 v[140:143], v[200:203], a[36:39], v[140:143]
    ds_read_b64_tr_b16 v[184:185], v42 offset:18432
    v_mfma_f32_16x16x32_bf16 v[144:147], v[200:203], a[40:43], v[144:147]
    ds_read_b64_tr_b16 v[186:187], v42 offset:18576
    v_mfma_f32_16x16x32_bf16 v[88:91], v[192:195], a[24:27], v[88:91]
    ds_read_b64_tr_b16 v[176:177], v42 offset:0
    v_mfma_f32_16x16x32_bf16 v[92:95], v[192:195], a[28:31], v[92:95]
    ds_read_b64_tr_b16 v[178:179], v42 offset:144
    s_lshl_b32 s32, s3, 4
    s_add_u32 s32, s32, s31
    s_lshl_b32 s32, s32, 1
    s_add_u32 s32, s32, s30
    s_mul_i32 s32, s32, 1152
    s_mul_i32 s33, s29, 144
    s_add_u32 s32, s32, s33
    v_mul_u32_u24 v87, 2304, v2
    v_lshl_add_u32 v87, v3, 3, v87
    v_add_u32 v87, s32, v87
    v_mfma_f32_16x16x32_bf16 v[96:99], v[192:195], a[32:35], v[96:99]
    ds_read_b64_tr_b16 v[188:189], v47 offset:0
    v_mfma_f32_16x16x32_bf16 v[100:103], v[192:195], a[36:39], v[100:103]
    ds_read_b64_tr_b16 v[190:191], v47 offset:144
    v_mfma_f32_16x16x32_bf16 v[104:107], v[192:195], a[40:43], v[104:107]
    ds_read_b128 a[20:23], v38
    v_mfma_f32_16x16x32_bf16 v[148:151], v[204:207], a[24:27], v[148:151]
    v_mfma_f32_16x16x32_bf16 v[152:155], v[204:207], a[28:31], v[152:155]
    v_mfma_f32_16x16x32_bf16 v[156:159], v[204:207], a[32:35], v[156:159]
    v_mfma_f32_16x16x32_bf16 v[160:163], v[204:207], a[36:39], v[160:163]
    v_mfma_f32_16x16x32_bf16 v[164:167], v[204:207], a[40:43], v[164:167]
    v_mfma_f32_16x16x32_bf16 v[168:171], a[24:27], a[24:27], v[168:171]
    v_mfma_f32_16x16x32_bf16 v[172:175], a[44:47], a[44:47], v[172:175]
    s_waitcnt lgkmcnt(0)
    v_mfma_f32_16x16x32_bf16 v[108:111], v[180:183], a[0:3], v[108:111]
    v_mfma_f32_16x16x32_bf16 v[112:115], v[180:183], a[4:7], v[112:115]
    ds_read_b64_tr_b16 v[196:197], v42 offset:13824
    buffer_load_dwordx2 v[208:209], v87, s[48:51], 0 offen offset:0
    v_mfma_f32_16x16x32_bf16 v[116:119], v[180:183], a[8:11], v[116:119]
    ds_read_b64_tr_b16 v[198:199], v42 offset:13968
    v_mfma_f32_16x16x32_bf16 v[120:123], v[180:183], a[12:15], v[120:123]
    ds_read_b128 a[24:27], v33 offset:0
    v_mfma_f32_16x16x32_bf16 v[124:127], v[180:183], a[16:19], v[124:127]
    ds_read_b128 a[28:31], v33 offset:2048
    v_mfma_f32_16x16x32_bf16 v[128:131], v[184:187], a[0:3], v[128:131]
    ds_read_b128 a[32:35], v33 offset:4096
    v_mfma_f32_16x16x32_bf16 v[132:135], v[184:187], a[4:7], v[132:135]
    ds_read_b128 a[36:39], v33 offset:6144
    v_mfma_f32_16x16x32_bf16 v[136:139], v[184:187], a[8:11], v[136:139]
    ds_read_b128 a[40:43], v33 offset:8192
    v_mfma_f32_16x16x32_bf16 v[140:143], v[184:187], a[12:15], v[140:143]
    ds_read_b64_tr_b16 v[200:201], v42 offset:23040
    v_mfma_f32_16x16x32_bf16 v[144:147], v[184:187], a[16:19], v[144:147]
    ds_read_b64_tr_b16 v[202:203], v42 offset:23184
    v_mfma_f32_16x16x32_bf16 v[88:91], v[176:179], a[0:3], v[88:91]
    ds_read_b64_tr_b16 v[192:193], v42 offset:4608
    v_mfma_f32_16x16x32_bf16 v[92:95], v[176:179], a[4:7], v[92:95]
    ds_read_b64_tr_b16 v[194:195], v42 offset:4752
    buffer_load_dwordx2 v[210:211], v87, s[48:51], 0 offen offset:32
    v_mfma_f32_16x16x32_bf16 v[96:99], v[176:179], a[8:11], v[96:99]
    ds_read_b64_tr_b16 v[204:205], v48 offset:0
    v_mfma_f32_16x16x32_bf16 v[100:103], v[176:179], a[12:15], v[100:103]
    ds_read_b64_tr_b16 v[206:207], v48 offset:144
    v_mfma_f32_16x16x32_bf16 v[104:107], v[176:179], a[16:19], v[104:107]
    ds_read_b128 a[44:47], v39
    v_mfma_f32_16x16x32_bf16 v[148:151], v[188:191], a[0:3], v[148:151]
    v_mfma_f32_16x16x32_bf16 v[152:155], v[188:191], a[4:7], v[152:155]
    v_mfma_f32_16x16x32_bf16 v[156:159], v[188:191], a[8:11], v[156:159]
    v_mfma_f32_16x16x32_bf16 v[160:163], v[188:191], a[12:15], v[160:163]
    v_mfma_f32_16x16x32_bf16 v[164:167], v[188:191], a[16:19], v[164:167]
    v_mfma_f32_16x16x32_bf16 v[168:171], a[0:3], a[0:3], v[168:171]
    v_mfma_f32_16x16x32_bf16 v[172:175], a[20:23], a[20:23], v[172:175]
    s_waitcnt lgkmcnt(0)
    v_mfma_f32_16x16x32_bf16 v[168:171], a[24:27], a[24:27], v[168:171]
    v_mfma_f32_16x16x32_bf16 v[172:175], a[44:47], a[44:47], v[172:175]
    buffer_load_dwordx2 v[212:213], v87, s[48:51], 0 offen offset:64
    v_mfma_f32_16x16x32_bf16 v[148:151], v[204:207], a[24:27], v[148:151]
    v_mfma_f32_16x16x32_bf16 v[152:155], v[204:207], a[28:31], v[152:155]
    v_mfma_f32_16x16x32_bf16 v[156:159], v[204:207], a[32:35], v[156:159]
    v_mfma_f32_16x16x32_bf16 v[160:163], v[204:207], a[36:39], v[160:163]
    v_mfma_f32_16x16x32_bf16 v[164:167], v[204:207], a[40:43], v[164:167]
    v_mfma_f32_16x16x32_bf16 v[128:131], v[200:203], a[24:27], v[128:131]
    v_mfma_f32_16x16x32_bf16 v[132:135], v[200:203], a[28:31], v[132:135]
    v_mfma_f32_16x16x32_bf16 v[136:139], v[200:203], a[32:35], v[136:139]
    v_mfma_f32_16x16x32_bf16 v[140:143], v[200:203], a[36:39], v[140:143]
    v_mfma_f32_16x16x32_bf16 v[144:147], v[200:203], a[40:43], v[144:147]
    buffer_load_dwordx2 v[214:215], v87, s[48:51], 0 offen offset:96
    v_mfma_f32_16x16x32_bf16 v[108:111], v[196:199], a[24:27], v[108:111]
    v_mfma_f32_16x16x32_bf16 v[112:115], v[196:199], a[28:31], v[112:115]
    v_mfma_f32_16x16x32_bf16 v[116:119], v[196:199], a[32:35], v[116:119]
    v_mfma_f32_16x16x32_bf16 v[120:123], v[196:199], a[36:39], v[120:123]
    v_mfma_f32_16x16x32_bf16 v[124:127], v[196:199], a[40:43], v[124:127]
    v_mfma_f32_16x16x32_bf16 v[88:91], v[192:195], a[24:27], v[88:91]
    v_mfma_f32_16x16x32_bf16 v[92:95], v[192:195], a[28:31], v[92:95]
    v_mfma_f32_16x16x32_bf16 v[96:99], v[192:195], a[32:35], v[96:99]
    v_mfma_f32_16x16x32_bf16 v[100:103], v[192:195], a[36:39], v[100:103]
    v_mfma_f32_16x16x32_bf16 v[104:107], v[192:195], a[40:43], v[104:107]
    v_cndmask_b32 v4, v168, v169, s[72:73]
    v_cndmask_b32 v4, v4, v170, s[74:75]
    v_cndmask_b32 v4, v4, v171, s[76:77]
    v_cndmask_b32 v5, v172, v173, s[72:73]
    v_cndmask_b32 v5, v5, v174, s[74:75]
    v_cndmask_b32 v5, v5, v175, s[76:77]
    s_mov_b64 exec, s[78:79]
    ds_write_b32 v66, v4 offset:4
    ds_write_b32 v67, v5 offset:4
    s_mov_b64 exec, s[82:83]
    ds_write_b32 v66, v148 offset:0
    ds_write_b32 v66, v152 offset:128
    ds_write_b32 v66, v156 offset:256
    ds_write_b32 v66, v160 offset:384
    ds_write_b32 v66, v164 offset:512
    s_mov_b64 exec, -1
    v_cndmask_b32 v8, v148, v150, s[70:71]
    v_cndmask_b32 v9, v149, v151, s[70:71]
    v_cndmask_b32 v10, v152, v154, s[70:71]
    v_cndmask_b32 v11, v153, v155, s[70:71]
    v_cndmask_b32 v12, v156, v158, s[70:71]
    v_cndmask_b32 v13, v157, v159, s[70:71]
    v_cndmask_b32 v14, v160, v162, s[70:71]
    v_cndmask_b32 v15, v161, v163, s[70:71]
    v_cndmask_b32 v20, v164, v166, s[70:71]
    v_cndmask_b32 v21, v165, v167, s[70:71]
    s_waitcnt lgkmcnt(0)
    s_barrier
    ds_read_b64 v[22:23], v66 offset:0
    ds_read_b64 v[28:29], v66 offset:128
    ds_read_b64 v[30:31], v66 offset:256
    ds_read_b64 v[32:33], v66 offset:384
    ds_read_b64 v[34:35], v66 offset:512
    buffer_load_dwordx2 v[216:217], v87, s[48:51], 0 offen offset:128
    v_mov_b32_dpp v44, v128 row_newbcast:0 row_mask:0xf bank_mask:0xf
    v_mov_b32_dpp v45, v129 row_newbcast:0 row_mask:0xf bank_mask:0xf
    v_mov_b32_dpp v46, v130 row_newbcast:0 row_mask:0xf bank_mask:0xf
    v_mov_b32_dpp v47, v131 row_newbcast:0 row_mask:0xf bank_mask:0xf
    v_mov_b32_dpp v40, v108 row_newbcast:0 row_mask:0xf bank_mask:0xf
    v_mov_b32_dpp v41, v109 row_newbcast:0 row_mask:0xf bank_mask:0xf
    v_mov_b32_dpp v42, v110 row_newbcast:0 row_mask:0xf bank_mask:0xf
    v_mov_b32_dpp v43, v111 row_newbcast:0 row_mask:0xf bank_mask:0xf
    v_mov_b32_dpp v36, v88 row_newbcast:0 row_mask:0xf bank_mask:0xf
    v_mov_b32_dpp v37, v89 row_newbcast:0 row_mask:0xf bank_mask:0xf
    v_mov_b32_dpp v38, v90 row_newbcast:0 row_mask:0xf bank_mask:0xf
    v_mov_b32_dpp v39, v91 row_newbcast:0 row_mask:0xf bank_mask:0xf
    v_mov_b32_dpp v66, v8 row_newbcast:0 row_mask:0xf bank_mask:0xf
    v_mov_b32_dpp v67, v9 row_newbcast:0 row_mask:0xf bank_mask:0xf
    s_mov_b32 s36, 0x3ae38e39
    s_mov_b32 s37, 0x3727c5ac
    v_mov_b32 v7, s37
    s_sub_u32 s88, s8, 4096
    s_subb_u32 s89, s9, 0
    s_mov_b32 s90, 667648
    s_mov_b32 s91, 0x20000
    s_waitcnt lgkmcnt(4)
    v_fma_f32 v4, v23, s36, v7
    v_mul_f32 v23, s36, -v22
    v_fma_f32 v4, -v23, v23, v4
    v_max_f32 v4, v4, v7
    v_rsq_f32 v22, v4
    s_waitcnt lgkmcnt(3)
    v_fma_f32 v4, v29, s36, v7
    v_mul_f32 v29, s36, -v28
    v_fma_f32 v4, -v29, v29, v4
    v_max_f32 v4, v4, v7
    v_rsq_f32 v28, v4
    s_waitcnt lgkmcnt(2)
    v_fma_f32 v4, v31, s36, v7
    v_mul_f32 v31, s36, -v30
    v_fma_f32 v4, -v31, v31, v4
    v_max_f32 v4, v4, v7
    v_rsq_f32 v30, v4
    s_waitcnt lgkmcnt(1)
    v_fma_f32 v4, v33, s36, v7
    v_mul_f32 v33, s36, -v32
    v_fma_f32 v4, -v33, v33, v4
    v_max_f32 v4, v4, v7
    v_rsq_f32 v32, v4
    s_waitcnt lgkmcnt(0)
    v_fma_f32 v4, v35, s36, v7
    v_mul_f32 v35, s36, -v34
    v_fma_f32 v4, -v35, v35, v4
    v_max_f32 v4, v4, v7
    v_rsq_f32 v34, v4
    s_mul_i32 s66, s3, 73728
    s_mul_i32 s87, s3, 9216
    s_add_u32 s87, s87, 113664
    s_add_u32 m0, s87, 0
    s_nop 0
    buffer_load_dwordx4 v76, s[88:91], s66 offen offset:0 lds
    v_pk_fma_f32 v[8:9], v[66:67], v[22:23], v[8:9] op_sel:[0,1,0] op_sel_hi:[1,1,1]
    v_pk_fma_f32 v[128:129], v[44:45], v[22:23], v[128:129] op_sel:[0,1,0] op_sel_hi:[1,1,1]
    v_pk_fma_f32 v[130:131], v[46:47], v[22:23], v[130:131] op_sel:[0,1,0] op_sel_hi:[1,1,1]
    v_pk_fma_f32 v[108:109], v[40:41], v[22:23], v[108:109] op_sel:[0,1,0] op_sel_hi:[1,1,1]
    v_pk_fma_f32 v[110:111], v[42:43], v[22:23], v[110:111] op_sel:[0,1,0] op_sel_hi:[1,1,1]
    v_pk_mul_f32 v[8:9], v[8:9], v[22:23] op_sel_hi:[1,0]
    v_pk_mul_f32 v[128:129], v[128:129], v[22:23] op_sel_hi:[1,0]
    v_pk_mul_f32 v[130:131], v[130:131], v[22:23] op_sel_hi:[1,0]
    v_pk_mul_f32 v[108:109], v[108:109], v[22:23] op_sel_hi:[1,0]
    v_pk_mul_f32 v[110:111], v[110:111], v[22:23] op_sel_hi:[1,0]
    v_cvt_pk_bf16_f32 v4, v8, v9
    v_cvt_pk_bf16_f32 v128, v128, v129
    v_cvt_pk_bf16_f32 v129, v130, v131
    v_cndmask_b32 v5, v4, v24, s[82:83]
    ds_write_b64 v68, v[128:129] offset:0
    ds_write_b32 v69, v5 offset:32
    v_cvt_pk_bf16_f32 v164, v108, v109
    v_cvt_pk_bf16_f32 v165, v110, v111
    v_mov_b32 v167, 0
    ds_read_b32 v166, v70 offset:36
    buffer_load_dwordx4 v77, s[88:91], s66 offen offset:1024 lds
    v_pk_fma_f32 v[10:11], v[66:67], v[28:29], v[10:11] op_sel:[0,1,0] op_sel_hi:[1,1,1]
    v_pk_fma_f32 v[132:133], v[44:45], v[28:29], v[132:133] op_sel:[0,1,0] op_sel_hi:[1,1,1]
    v_pk_fma_f32 v[134:135], v[46:47], v[28:29], v[134:135] op_sel:[0,1,0] op_sel_hi:[1,1,1]
    v_pk_fma_f32 v[112:113], v[40:41], v[28:29], v[112:113] op_sel:[0,1,0] op_sel_hi:[1,1,1]
    v_pk_fma_f32 v[114:115], v[42:43], v[28:29], v[114:115] op_sel:[0,1,0] op_sel_hi:[1,1,1]
    v_pk_fma_f32 v[92:93], v[36:37], v[28:29], v[92:93] op_sel:[0,1,0] op_sel_hi:[1,1,1]
    v_pk_fma_f32 v[94:95], v[38:39], v[28:29], v[94:95] op_sel:[0,1,0] op_sel_hi:[1,1,1]
    v_pk_mul_f32 v[10:11], v[10:11], v[28:29] op_sel_hi:[1,0]
    v_pk_mul_f32 v[132:133], v[132:133], v[28:29] op_sel_hi:[1,0]
    v_pk_mul_f32 v[134:135], v[134:135], v[28:29] op_sel_hi:[1,0]
    v_pk_mul_f32 v[112:113], v[112:113], v[28:29] op_sel_hi:[1,0]
    v_pk_mul_f32 v[114:115], v[114:115], v[28:29] op_sel_hi:[1,0]
    v_pk_mul_f32 v[92:93], v[92:93], v[28:29] op_sel_hi:[1,0]
    v_pk_mul_f32 v[94:95], v[94:95], v[28:29] op_sel_hi:[1,0]
    v_cvt_pk_bf16_f32 v4, v10, v11
    v_cvt_pk_bf16_f32 v132, v132, v133
    v_cvt_pk_bf16_f32 v133, v134, v135
    v_cndmask_b32 v5, v4, v24, s[82:83]
    ds_write_b64 v68, v[132:133] offset:768
    ds_write_b32 v69, v5 offset:800
    v_cvt_pk_bf16_f32 v168, v112, v113
    v_cvt_pk_bf16_f32 v169, v114, v115
    v_mov_b32 v171, 0
    ds_read_b32 v170, v70 offset:804
    v_cvt_pk_bf16_f32 v148, v92, v93
    v_cvt_pk_bf16_f32 v149, v94, v95
    v_cndmask_b32 v150, 0, v4, s[80:81]
    v_mov_b32 v151, 0
    buffer_load_dwordx4 v78, s[88:91], s66 offen offset:2048 lds
    v_pk_fma_f32 v[12:13], v[66:67], v[30:31], v[12:13] op_sel:[0,1,0] op_sel_hi:[1,1,1]
    v_pk_fma_f32 v[136:137], v[44:45], v[30:31], v[136:137] op_sel:[0,1,0] op_sel_hi:[1,1,1]
    v_pk_fma_f32 v[138:139], v[46:47], v[30:31], v[138:139] op_sel:[0,1,0] op_sel_hi:[1,1,1]
    v_pk_fma_f32 v[116:117], v[40:41], v[30:31], v[116:117] op_sel:[0,1,0] op_sel_hi:[1,1,1]
    v_pk_fma_f32 v[118:119], v[42:43], v[30:31], v[118:119] op_sel:[0,1,0] op_sel_hi:[1,1,1]
    v_pk_fma_f32 v[96:97], v[36:37], v[30:31], v[96:97] op_sel:[0,1,0] op_sel_hi:[1,1,1]
    v_pk_fma_f32 v[98:99], v[38:39], v[30:31], v[98:99] op_sel:[0,1,0] op_sel_hi:[1,1,1]
    v_pk_mul_f32 v[12:13], v[12:13], v[30:31] op_sel_hi:[1,0]
    v_pk_mul_f32 v[136:137], v[136:137], v[30:31] op_sel_hi:[1,0]
    v_pk_mul_f32 v[138:139], v[138:139], v[30:31] op_sel_hi:[1,0]
    v_pk_mul_f32 v[116:117], v[116:117], v[30:31] op_sel_hi:[1,0]
    v_pk_mul_f32 v[118:119], v[118:119], v[30:31] op_sel_hi:[1,0]
    v_pk_mul_f32 v[96:97], v[96:97], v[30:31] op_sel_hi:[1,0]
    v_pk_mul_f32 v[98:99], v[98:99], v[30:31] op_sel_hi:[1,0]
    v_cvt_pk_bf16_f32 v4, v12, v13
    v_cvt_pk_bf16_f32 v136, v136, v137
    v_cvt_pk_bf16_f32 v137, v138, v139
    v_cndmask_b32 v5, v4, v24, s[82:83]
    ds_write_b64 v68, v[136:137] offset:1536
    ds_write_b32 v69, v5 offset:1568
    v_cvt_pk_bf16_f32 v172, v116, v117
    v_cvt_pk_bf16_f32 v173, v118, v119
    v_mov_b32 v175, 0
    ds_read_b32 v174, v70 offset:1572
    v_cvt_pk_bf16_f32 v152, v96, v97
    v_cvt_pk_bf16_f32 v153, v98, v99
    v_cndmask_b32 v154, 0, v4, s[80:81]
    v_mov_b32 v155, 0
    buffer_load_dwordx4 v79, s[88:91], s66 offen offset:3072 lds
    v_pk_fma_f32 v[14:15], v[66:67], v[32:33], v[14:15] op_sel:[0,1,0] op_sel_hi:[1,1,1]
    v_pk_fma_f32 v[140:141], v[44:45], v[32:33], v[140:141] op_sel:[0,1,0] op_sel_hi:[1,1,1]
    v_pk_fma_f32 v[142:143], v[46:47], v[32:33], v[142:143] op_sel:[0,1,0] op_sel_hi:[1,1,1]
    v_pk_fma_f32 v[120:121], v[40:41], v[32:33], v[120:121] op_sel:[0,1,0] op_sel_hi:[1,1,1]
    v_pk_fma_f32 v[122:123], v[42:43], v[32:33], v[122:123] op_sel:[0,1,0] op_sel_hi:[1,1,1]
    v_pk_fma_f32 v[100:101], v[36:37], v[32:33], v[100:101] op_sel:[0,1,0] op_sel_hi:[1,1,1]
    v_pk_fma_f32 v[102:103], v[38:39], v[32:33], v[102:103] op_sel:[0,1,0] op_sel_hi:[1,1,1]
    v_pk_mul_f32 v[14:15], v[14:15], v[32:33] op_sel_hi:[1,0]
    v_pk_mul_f32 v[140:141], v[140:141], v[32:33] op_sel_hi:[1,0]
    v_pk_mul_f32 v[142:143], v[142:143], v[32:33] op_sel_hi:[1,0]
    v_pk_mul_f32 v[120:121], v[120:121], v[32:33] op_sel_hi:[1,0]
    v_pk_mul_f32 v[122:123], v[122:123], v[32:33] op_sel_hi:[1,0]
    v_pk_mul_f32 v[100:101], v[100:101], v[32:33] op_sel_hi:[1,0]
    v_pk_mul_f32 v[102:103], v[102:103], v[32:33] op_sel_hi:[1,0]
    v_cvt_pk_bf16_f32 v4, v14, v15
    v_cvt_pk_bf16_f32 v140, v140, v141
    v_cvt_pk_bf16_f32 v141, v142, v143
    v_cndmask_b32 v5, v4, v24, s[82:83]
    ds_write_b64 v68, v[140:141] offset:2304
    ds_write_b32 v69, v5 offset:2336
    v_cvt_pk_bf16_f32 v176, v120, v121
    v_cvt_pk_bf16_f32 v177, v122, v123
    v_mov_b32 v179, 0
    ds_read_b32 v178, v70 offset:2340
    v_cvt_pk_bf16_f32 v156, v100, v101
    v_cvt_pk_bf16_f32 v157, v102, v103
    v_cndmask_b32 v158, 0, v4, s[80:81]
    v_mov_b32 v159, 0
    s_add_u32 m0, s87, 4096
    s_nop 0
    buffer_load_dwordx4 v80, s[88:91], s66 offen offset:0 lds
    v_pk_fma_f32 v[20:21], v[66:67], v[34:35], v[20:21] op_sel:[0,1,0] op_sel_hi:[1,1,1]
    v_pk_fma_f32 v[144:145], v[44:45], v[34:35], v[144:145] op_sel:[0,1,0] op_sel_hi:[1,1,1]
    v_pk_fma_f32 v[146:147], v[46:47], v[34:35], v[146:147] op_sel:[0,1,0] op_sel_hi:[1,1,1]
    v_pk_fma_f32 v[124:125], v[40:41], v[34:35], v[124:125] op_sel:[0,1,0] op_sel_hi:[1,1,1]
    v_pk_fma_f32 v[126:127], v[42:43], v[34:35], v[126:127] op_sel:[0,1,0] op_sel_hi:[1,1,1]
    v_pk_fma_f32 v[104:105], v[36:37], v[34:35], v[104:105] op_sel:[0,1,0] op_sel_hi:[1,1,1]
    v_pk_fma_f32 v[106:107], v[38:39], v[34:35], v[106:107] op_sel:[0,1,0] op_sel_hi:[1,1,1]
    v_pk_mul_f32 v[20:21], v[20:21], v[34:35] op_sel_hi:[1,0]
    v_pk_mul_f32 v[144:145], v[144:145], v[34:35] op_sel_hi:[1,0]
    v_pk_mul_f32 v[146:147], v[146:147], v[34:35] op_sel_hi:[1,0]
    v_pk_mul_f32 v[124:125], v[124:125], v[34:35] op_sel_hi:[1,0]
    v_pk_mul_f32 v[126:127], v[126:127], v[34:35] op_sel_hi:[1,0]
    v_pk_mul_f32 v[104:105], v[104:105], v[34:35] op_sel_hi:[1,0]
    v_pk_mul_f32 v[106:107], v[106:107], v[34:35] op_sel_hi:[1,0]
    v_cvt_pk_bf16_f32 v4, v20, v21
    v_cvt_pk_bf16_f32 v144, v144, v145
    v_cvt_pk_bf16_f32 v145, v146, v147
    v_cndmask_b32 v5, v4, v24, s[82:83]
    ds_write_b64 v68, v[144:145] offset:3072
    ds_write_b32 v69, v5 offset:3104
    v_cvt_pk_bf16_f32 v180, v124, v125
    v_cvt_pk_bf16_f32 v181, v126, v127
    v_mov_b32 v183, 0
    ds_read_b32 v182, v70 offset:3108
    v_cvt_pk_bf16_f32 v160, v104, v105
    v_cvt_pk_bf16_f32 v161, v106, v107
    v_cndmask_b32 v162, 0, v4, s[80:81]
    v_mov_b32 v163, 0
    buffer_load_dwordx4 v81, s[88:91], s66 offen offset:1024 lds
    s_waitcnt lgkmcnt(9)
    v_mfma_f32_16x16x32_bf16 v[8:11], v[164:167], v[148:151], v[60:63]
    v_mfma_f32_16x16x32_bf16 v[12:15], v[168:171], v[148:151], v[56:59]
    s_waitcnt lgkmcnt(6)
    v_mfma_f32_16x16x32_bf16 v[40:43], v[168:171], v[152:155], v[52:55]
    v_mfma_f32_16x16x32_bf16 v[44:47], v[172:175], v[152:155], v[56:59]
    s_waitcnt lgkmcnt(3)
    v_mfma_f32_16x16x32_bf16 v[88:91], v[172:175], v[156:159], v[52:55]
    v_mfma_f32_16x16x32_bf16 v[92:95], v[176:179], v[156:159], v[56:59]
    s_waitcnt lgkmcnt(0)
    v_mfma_f32_16x16x32_bf16 v[96:99], v[176:179], v[160:163], v[52:55]
    v_mfma_f32_16x16x32_bf16 v[100:103], v[180:183], v[160:163], v[56:59]
    ds_read_b64_tr_b16 v[20:21], v71 offset:0
    ds_read_b64_tr_b16 v[30:31], v72 offset:40
    ds_read_b64_tr_b16 v[22:23], v71 offset:768
    ds_read_b64_tr_b16 v[32:33], v72 offset:808
    ds_read_b64_tr_b16 v[24:25], v71 offset:1536
    ds_read_b64_tr_b16 v[34:35], v72 offset:1576
    ds_read_b64_tr_b16 v[26:27], v71 offset:2304
    ds_read_b64_tr_b16 v[36:37], v72 offset:2344
    ds_read_b64_tr_b16 v[28:29], v71 offset:3072
    ds_read_b64_tr_b16 v[38:39], v72 offset:3112
    s_mov_b32 s36, 0x3eae1a93
    v_max_f32 v8, v8, v12
    v_max_f32 v9, v9, v13
    v_max_f32 v10, v10, v14
    v_max_f32 v11, v11, v15
    v_max3_f32 v66, v8, v9, v10
    v_max_f32 v66, v66, v11
    v_max_f32 v40, v40, v44
    v_max_f32 v41, v41, v45
    v_max_f32 v42, v42, v46
    v_max_f32 v43, v43, v47
    v_max3_f32 v68, v40, v41, v42
    v_max_f32 v68, v68, v43
    v_max_f32 v88, v88, v92
    v_max_f32 v89, v89, v93
    v_max_f32 v90, v90, v94
    v_max_f32 v91, v91, v95
    v_max3_f32 v70, v88, v89, v90
    v_max_f32 v70, v70, v91
    v_max_f32 v96, v96, v100
    v_max_f32 v97, v97, v101
    v_max_f32 v98, v98, v102
    v_max_f32 v99, v99, v103
    v_max3_f32 v104, v96, v97, v98
    v_max_f32 v104, v104, v99
    buffer_load_dwordx4 v82, s[88:91], s66 offen offset:2048 lds
    v_permlane32_swap_b32 v66, v68
    v_permlane32_swap_b32 v70, v104
    v_max_f32 v66, v66, v68
    v_max_f32 v70, v70, v104
    s_nop 1
    v_permlane16_swap_b32 v66, v70
    v_max_f32 v66, v66, v70
    v_mul_f32 v70, s36, v66
    v_mul_f32 v66, s36, v66
    s_nop 1
    v_permlane16_swap_b32 v66, v70
    v_mov_b32 v68, v66
    v_mov_b32 v104, v70
    s_nop 0
    v_permlane32_swap_b32 v66, v68
    v_permlane32_swap_b32 v70, v104
    s_waitcnt lgkmcnt(0)
    v_fma_f32 v8, v8, s36, -v66
    v_fma_f32 v9, v9, s36, -v66
    v_fma_f32 v10, v10, s36, -v66
    v_fma_f32 v11, v11, s36, -v66
    v_exp_f32 v8, v8
    v_exp_f32 v9, v9
    v_exp_f32 v10, v10
    v_exp_f32 v11, v11
    buffer_load_dwordx4 v83, s[88:91], s66 offen offset:3072 lds
    v_cvt_pk_bf16_f32 v8, v8, v9
    v_cvt_pk_bf16_f32 v9, v10, v11
    v_and_b32 v12, v8, v50
    v_and_b32 v14, v8, v64
    v_and_b32 v13, v9, v51
    v_and_b32 v15, v9, v65
    s_nop 1
    v_mfma_f32_16x16x32_bf16 v[124:127], v[30:33], v[12:15], 0
    v_mfma_f32_16x16x32_bf16 v[108:111], v[20:23], v[12:15], 0
    v_fma_f32 v40, v40, s36, -v68
    v_fma_f32 v41, v41, s36, -v68
    v_fma_f32 v42, v42, s36, -v68
    v_fma_f32 v43, v43, s36, -v68
    v_exp_f32 v40, v40
    v_exp_f32 v41, v41
    v_exp_f32 v42, v42
    v_exp_f32 v43, v43
    s_add_u32 m0, s87, 8192
    s_nop 0
    buffer_load_dwordx4 v84, s[88:91], s66 offen offset:0 lds
    v_cvt_pk_bf16_f32 v40, v40, v41
    v_cvt_pk_bf16_f32 v41, v42, v43
    v_and_b32 v44, v40, v50
    v_and_b32 v46, v40, v64
    v_and_b32 v45, v41, v51
    v_and_b32 v47, v41, v65
    s_nop 1
    v_mfma_f32_16x16x32_bf16 v[128:131], v[32:35], v[44:47], 0
    v_mfma_f32_16x16x32_bf16 v[112:115], v[22:25], v[44:47], 0
    v_fma_f32 v88, v88, s36, -v70
    v_fma_f32 v89, v89, s36, -v70
    v_fma_f32 v90, v90, s36, -v70
    v_fma_f32 v91, v91, s36, -v70
    v_exp_f32 v88, v88
    v_exp_f32 v89, v89
    v_exp_f32 v90, v90
    v_exp_f32 v91, v91
    v_cvt_pk_bf16_f32 v88, v88, v89
    v_cvt_pk_bf16_f32 v89, v90, v91
    v_and_b32 v92, v88, v50
    v_and_b32 v94, v88, v64
    v_and_b32 v93, v89, v51
    v_and_b32 v95, v89, v65
    s_nop 1
    v_mfma_f32_16x16x32_bf16 v[132:135], v[34:37], v[92:95], 0
    v_mfma_f32_16x16x32_bf16 v[116:119], v[24:27], v[92:95], 0
    v_fma_f32 v96, v96, s36, -v104
    v_fma_f32 v97, v97, s36, -v104
    v_fma_f32 v98, v98, s36, -v104
    v_fma_f32 v99, v99, s36, -v104
    v_exp_f32 v96, v96
    v_exp_f32 v97, v97
    v_exp_f32 v98, v98
    v_exp_f32 v99, v99
    v_cvt_pk_bf16_f32 v96, v96, v97
    v_cvt_pk_bf16_f32 v97, v98, v99
    v_and_b32 v100, v96, v50
    v_and_b32 v102, v96, v64
    v_and_b32 v101, v97, v51
    v_and_b32 v103, v97, v65
    s_nop 1
    v_mfma_f32_16x16x32_bf16 v[136:139], v[36:39], v[100:103], 0
    v_mfma_f32_16x16x32_bf16 v[120:123], v[26:29], v[100:103], 0
    v_rcp_f32 v66, v126
    s_nop 0
    v_pk_mul_f32 v[108:109], v[108:109], v[66:67] op_sel_hi:[1,0]
    v_pk_mul_f32 v[110:111], v[110:111], v[66:67] op_sel_hi:[1,0]
    v_pk_mul_f32 v[124:125], v[124:125], v[66:67] op_sel_hi:[1,0]
    v_cvt_pk_bf16_f32 v108, v108, v109
    v_cvt_pk_bf16_f32 v109, v110, v111
    v_cvt_pk_bf16_f32 v124, v124, v125
    ds_write_b64 v73, v[108:109] offset:0
    ds_write_b32 v74, v124 offset:0
    v_rcp_f32 v68, v130
    s_nop 0
    v_pk_mul_f32 v[112:113], v[112:113], v[68:69] op_sel_hi:[1,0]
    v_pk_mul_f32 v[114:115], v[114:115], v[68:69] op_sel_hi:[1,0]
    v_pk_mul_f32 v[128:129], v[128:129], v[68:69] op_sel_hi:[1,0]
    v_cvt_pk_bf16_f32 v112, v112, v113
    v_cvt_pk_bf16_f32 v113, v114, v115
    v_cvt_pk_bf16_f32 v128, v128, v129
    ds_write_b64 v73, v[112:113] offset:2304
    ds_write_b32 v74, v128 offset:2304
    v_rcp_f32 v70, v134
    s_nop 0
    v_pk_mul_f32 v[116:117], v[116:117], v[70:71] op_sel_hi:[1,0]
    v_pk_mul_f32 v[118:119], v[118:119], v[70:71] op_sel_hi:[1,0]
    v_pk_mul_f32 v[132:133], v[132:133], v[70:71] op_sel_hi:[1,0]
    v_cvt_pk_bf16_f32 v116, v116, v117
    v_cvt_pk_bf16_f32 v117, v118, v119
    v_cvt_pk_bf16_f32 v132, v132, v133
    ds_write_b64 v73, v[116:117] offset:4608
    ds_write_b32 v74, v132 offset:4608
    v_rcp_f32 v104, v138
    s_nop 0
    v_pk_mul_f32 v[120:121], v[120:121], v[104:105] op_sel_hi:[1,0]
    v_pk_mul_f32 v[122:123], v[122:123], v[104:105] op_sel_hi:[1,0]
    v_pk_mul_f32 v[136:137], v[136:137], v[104:105] op_sel_hi:[1,0]
    v_cvt_pk_bf16_f32 v120, v120, v121
    v_cvt_pk_bf16_f32 v121, v122, v123
    v_cvt_pk_bf16_f32 v136, v136, v137
    ds_write_b64 v73, v[120:121] offset:6912
    ds_write_b32 v74, v136 offset:6912
    s_waitcnt lgkmcnt(0)
    s_barrier
    ds_read_b128 v[20:23], v75 offset:0
    ds_read_b128 v[24:27], v75 offset:64
    ds_read_b128 v[28:31], v75 offset:128
    s_waitcnt lgkmcnt(2)
    buffer_store_dwordx4 v[20:23], v17, s[52:55], s86 offen offset:0 sc1
    s_waitcnt lgkmcnt(1)
    buffer_store_dwordx4 v[24:27], v17, s[52:55], s86 offen offset:1024 sc1
    s_waitcnt lgkmcnt(0)
    s_mov_b64 exec, 0xffff
    buffer_store_dwordx4 v[28:31], v17, s[52:55], s86 offen offset:2048 sc1
    s_mov_b64 exec, -1
    s_lshl_b32 s32, s26, 2
    s_add_u32 s32, s32, s28
    s_lshl_b32 s32, s32, 9
    v_and_b32 v4, 7, v1
    v_cmp_eq_u32 vcc, s29, v4
    v_xor_b32 v5, 1, v4
    s_nop 0
    v_cndmask_b32 v4, v4, v5, vcc
    v_and_b32 v5, 4, v4
    v_add_u32 v4, v4, v5
    v_lshl_add_u32 v8, v4, 7, s32
    s_waitcnt vmcnt(12)
    v_lshlrev_b32 v12, 16, v208
    v_and_b32 v13, 0xffff0000, v208
    v_lshlrev_b32 v14, 16, v209
    v_and_b32 v15, 0xffff0000, v209
    v_lshlrev_b32 v32, 16, v210
    v_and_b32 v33, 0xffff0000, v210
    v_lshlrev_b32 v34, 16, v211
    v_and_b32 v35, 0xffff0000, v211
    v_lshlrev_b32 v36, 16, v212
    v_and_b32 v37, 0xffff0000, v212
    v_lshlrev_b32 v38, 16, v213
    v_and_b32 v39, 0xffff0000, v213
    v_lshlrev_b32 v40, 16, v214
    v_and_b32 v41, 0xffff0000, v214
    v_lshlrev_b32 v42, 16, v215
    v_and_b32 v43, 0xffff0000, v215
    v_lshlrev_b32 v44, 16, v216
    v_and_b32 v45, 0xffff0000, v216
    v_lshlrev_b32 v46, 16, v217
    v_and_b32 v47, 0xffff0000, v217
    v_add_u32 v10, 113664, v49
    v_mov_b32 v60, 0x3f80
    v_mov_b32 v61, 0x3f800000
    v_accvgpr_read_b32 v50, a48
    v_lshlrev_b32 v52, 16, v50
    v_and_b32 v53, 0xffff0000, v50
    v_accvgpr_read_b32 v51, a49
    v_lshlrev_b32 v54, 16, v51
    v_and_b32 v55, 0xffff0000, v51
    v_accvgpr_read_b32 v50, a50
    v_lshlrev_b32 v56, 16, v50
    v_and_b32 v57, 0xffff0000, v50
    v_accvgpr_read_b32 v51, a51
    v_lshlrev_b32 v58, 16, v51
    v_and_b32 v59, 0xffff0000, v51
    v_accvgpr_read_b32 v50, a52
    v_dot2c_f32_bf16 v52, v50, v60
    v_dot2c_f32_bf16 v53, v50, v61
    v_accvgpr_read_b32 v51, a53
    v_dot2c_f32_bf16 v54, v51, v60
    v_dot2c_f32_bf16 v55, v51, v61
    v_accvgpr_read_b32 v50, a54
    v_dot2c_f32_bf16 v56, v50, v60
    v_dot2c_f32_bf16 v57, v50, v61
    v_accvgpr_read_b32 v51, a55
    v_dot2c_f32_bf16 v58, v51, v60
    v_dot2c_f32_bf16 v59, v51, v61
    v_accvgpr_read_b32 v50, a56
    v_dot2c_f32_bf16 v52, v50, v60
    v_dot2c_f32_bf16 v53, v50, v61
    v_accvgpr_read_b32 v51, a57
    v_dot2c_f32_bf16 v54, v51, v60
    v_dot2c_f32_bf16 v55, v51, v61
    v_accvgpr_read_b32 v50, a58
    v_dot2c_f32_bf16 v56, v50, v60
    v_dot2c_f32_bf16 v57, v50, v61
    v_accvgpr_read_b32 v51, a59
    v_dot2c_f32_bf16 v58, v51, v60
    v_dot2c_f32_bf16 v59, v51, v61
    v_accvgpr_read_b32 v50, a60
    v_dot2c_f32_bf16 v52, v50, v60
    v_dot2c_f32_bf16 v53, v50, v61
    v_accvgpr_read_b32 v51, a61
    v_dot2c_f32_bf16 v54, v51, v60
    v_dot2c_f32_bf16 v55, v51, v61
    v_accvgpr_read_b32 v50, a62
    v_dot2c_f32_bf16 v56, v50, v60
    v_dot2c_f32_bf16 v57, v50, v61
    v_accvgpr_read_b32 v51, a63
    v_dot2c_f32_bf16 v58, v51, v60
    v_dot2c_f32_bf16 v59, v51, v61
    v_accvgpr_read_b32 v50, a64
    v_dot2c_f32_bf16 v52, v50, v60
    v_dot2c_f32_bf16 v53, v50, v61
    v_accvgpr_read_b32 v51, a65
    v_dot2c_f32_bf16 v54, v51, v60
    v_dot2c_f32_bf16 v55, v51, v61
    v_accvgpr_read_b32 v50, a66
    v_dot2c_f32_bf16 v56, v50, v60
    v_dot2c_f32_bf16 v57, v50, v61
    v_accvgpr_read_b32 v51, a67
    v_dot2c_f32_bf16 v58, v51, v60
    v_dot2c_f32_bf16 v59, v51, v61
    v_accvgpr_read_b32 v50, a68
    v_dot2c_f32_bf16 v52, v50, v60
    v_dot2c_f32_bf16 v53, v50, v61
    v_accvgpr_read_b32 v51, a69
    v_dot2c_f32_bf16 v54, v51, v60
    v_dot2c_f32_bf16 v55, v51, v61
    v_accvgpr_read_b32 v50, a70
    v_dot2c_f32_bf16 v56, v50, v60
    v_dot2c_f32_bf16 v57, v50, v61
    v_accvgpr_read_b32 v51, a71
    v_dot2c_f32_bf16 v58, v51, v60
    v_dot2c_f32_bf16 v59, v51, v61
    v_permlane32_swap_b32 v52, v56
    v_permlane32_swap_b32 v53, v57
    v_permlane32_swap_b32 v54, v58
    v_permlane32_swap_b32 v55, v59
    v_add_f32 v52, v52, v56
    v_add_f32 v53, v53, v57
    v_add_f32 v54, v54, v58
    v_add_f32 v55, v55, v59
    s_nop 0
    v_permlane16_swap_b32 v52, v54
    v_permlane16_swap_b32 v53, v55
    v_add_f32 v52, v52, v54
    v_add_f32 v53, v53, v55
    v_and_b32 v50, 7, v1
    v_lshlrev_b32 v50, 5, v50
    v_lshl_add_u32 v50, v3, 3, v50
    v_add_f32_dpp v54, v52, v52 row_ror:8 row_mask:0xf bank_mask:0xf
    v_add_f32_dpp v55, v53, v53 row_ror:8 row_mask:0xf bank_mask:0xf
    buffer_store_dwordx2 v[54:55], v50, s[52:55], s96 offen sc1
    s_and_b32 s32, s27, 1
    s_lshl_b32 s36, s32, 5
    s_xor_b32 s32, s32, 1
    s_lshl_b32 s37, s32, 8
    s_and_b32 s38, s26, 3
    s_mul_i32 s41, s3, 9216
    s_and_b32 s42, s3, 1
    s_lshr_b32 s43, s3, 1
    v_lshrrev_b32 v4, 3, v1
    v_mul_u32_u24 v4, 9216, v4
    s_mul_i32 s32, s3, 663552
    s_mul_i32 s33, s27, 576
    s_add_u32 s32, s32, s33
    v_add_u32 v4, s32, v4
    v_and_b32 v5, 7, v1
    v_bfe_u32 v6, v1, 4, 1
    v_lshlrev_b32 v6, 1, v6
    v_xor_b32 v5, v5, v6
    s_and_b32 s32, s3, 1
    s_lshl_b32 s32, s32, 2
    v_xor_b32 v5, s32, v5
    v_xor_b32 v6, 4, v5
    v_lshl_add_u32 v5, v5, 4, v4
    v_lshl_add_u32 v6, v6, 4, v4
    v_add_u32 v50, 4096, v5
    v_add_u32 v51, 76800, v6
    v_add_u32 v52, 149504, v5
    v_add_u32 v53, 222208, v6
    v_add_u32 v54, 299008, v5
    v_add_u32 v55, 371712, v6
    v_add_u32 v56, 444416, v5
    v_add_u32 v57, 517120, v6
    v_add_u32 v58, 593920, v5
    s_cmp_lg_u32 s3, 0
    s_cbranch_scc1 L_w0_7
    v_cmp_gt_u32 vcc, 1, v85
    s_cbranch_vccz L_pollx_9
    s_mov_b32 s35, 0
L_poll_8:
    s_add_u32 s35, s35, 1
    s_cmp_gt_u32 s35, 400000
    s_cbranch_scc1 L_pollx_9
    buffer_load_dword v85, v86, s[56:59], 0 offen sc1
    s_waitcnt vmcnt(0)
    v_cmp_gt_u32 vcc, 1, v85
    s_cbranch_vccnz L_poll_8
L_pollx_9:
L_w0_7:
    s_waitcnt vmcnt(0)
    s_barrier
    s_cmp_lg_u32 s3, 0
    s_cbranch_scc1 L_w0_10
    v_mov_b32 v19, 1
    s_mov_b64 exec, 1
    buffer_store_dword v19, v18, s[52:55], s65 offen offset:0 sc1
    s_mov_b64 exec, -1
L_w0_10:
    s_add_u32 s66, s66, 294912
    s_sub_u32 s87, s3, 1
    s_mul_i32 s87, s87, 9216
    s_cmp_eq_u32 s3, 0
    s_cselect_b32 s87, 150528, s87
    s_add_u32 m0, s87, 0
    s_nop 0
    buffer_load_dwordx4 v76, s[88:91], s66 offen offset:0 lds
    buffer_load_dwordx4 v77, s[88:91], s66 offen offset:1024 lds
    buffer_load_dwordx4 v78, s[88:91], s66 offen offset:2048 lds
    buffer_load_dwordx4 v79, s[88:91], s66 offen offset:3072 lds
    s_add_u32 m0, s87, 4096
    s_nop 0
    buffer_load_dwordx4 v80, s[88:91], s66 offen offset:0 lds
    buffer_load_dwordx4 v81, s[88:91], s66 offen offset:1024 lds
    buffer_load_dwordx4 v82, s[88:91], s66 offen offset:2048 lds
    buffer_load_dwordx4 v83, s[88:91], s66 offen offset:3072 lds
    s_add_u32 m0, s87, 8192
    s_nop 0
    buffer_load_dwordx4 v84, s[88:91], s66 offen offset:0 lds
    s_cmp_lg_u32 s3, 0
    s_cbranch_scc1 L_w0_11
    s_mov_b32 s66, 589824
    s_mov_b32 s87, 27648
    s_add_u32 m0, s87, 0
    s_nop 0
    buffer_load_dwordx4 v76, s[88:91], s66 offen offset:0 lds
    buffer_load_dwordx4 v77, s[88:91], s66 offen offset:1024 lds
    buffer_load_dwordx4 v78, s[88:91], s66 offen offset:2048 lds
    buffer_load_dwordx4 v79, s[88:91], s66 offen offset:3072 lds
    s_add_u32 m0, s87, 4096
    s_nop 0
    buffer_load_dwordx4 v80, s[88:91], s66 offen offset:0 lds
    buffer_load_dwordx4 v81, s[88:91], s66 offen offset:1024 lds
    buffer_load_dwordx4 v82, s[88:91], s66 offen offset:2048 lds
    buffer_load_dwordx4 v83, s[88:91], s66 offen offset:3072 lds
    s_add_u32 m0, s87, 8192
    s_nop 0
    buffer_load_dwordx4 v84, s[88:91], s66 offen offset:0 lds
L_w0_11:
    ds_read_b64_tr_b16 a[0:1], v10 offset:0
    ds_read_b64_tr_b16 a[2:3], v10 offset:144
    ds_read_b64_tr_b16 a[4:5], v10 offset:32
    ds_read_b64_tr_b16 a[6:7], v10 offset:176
    ds_read_b64_tr_b16 a[8:9], v10 offset:64
    ds_read_b64_tr_b16 a[10:11], v10 offset:208
    ds_read_b64_tr_b16 a[12:13], v10 offset:96
    ds_read_b64_tr_b16 a[14:15], v10 offset:240
    ds_read_b64_tr_b16 a[16:17], v10 offset:128
    ds_read_b64_tr_b16 a[18:19], v10 offset:272
    ds_read_b64_tr_b16 a[20:21], v10 offset:4608
    ds_read_b64_tr_b16 a[22:23], v10 offset:4752
    ds_read_b64_tr_b16 a[24:25], v10 offset:4640
    ds_read_b64_tr_b16 a[26:27], v10 offset:4784
    ds_read_b64_tr_b16 a[28:29], v10 offset:4672
    ds_read_b64_tr_b16 a[30:31], v10 offset:4816
    ds_read_b64_tr_b16 a[32:33], v10 offset:4704
    ds_read_b64_tr_b16 a[34:35], v10 offset:4848
    ds_read_b64_tr_b16 a[36:37], v10 offset:4736
    ds_read_b64_tr_b16 a[38:39], v10 offset:4880
    ds_read_b64_tr_b16 a[40:41], v10 offset:9216
    ds_read_b64_tr_b16 a[42:43], v10 offset:9360
    ds_read_b64_tr_b16 a[44:45], v10 offset:9248
    ds_read_b64_tr_b16 a[46:47], v10 offset:9392
    ds_read_b64_tr_b16 a[48:49], v10 offset:9280
    ds_read_b64_tr_b16 a[50:51], v10 offset:9424
    ds_read_b64_tr_b16 a[52:53], v10 offset:9312
    ds_read_b64_tr_b16 a[54:55], v10 offset:9456
    ds_read_b64_tr_b16 a[56:57], v10 offset:9344
    ds_read_b64_tr_b16 a[58:59], v10 offset:9488
    ds_read_b64_tr_b16 a[60:61], v10 offset:13824
    ds_read_b64_tr_b16 a[62:63], v10 offset:13968
    ds_read_b64_tr_b16 a[64:65], v10 offset:13856
    ds_read_b64_tr_b16 a[66:67], v10 offset:14000
    ds_read_b64_tr_b16 a[68:69], v10 offset:13888
    ds_read_b64_tr_b16 a[70:71], v10 offset:14032
    ds_read_b64_tr_b16 a[72:73], v10 offset:13920
    ds_read_b64_tr_b16 a[74:75], v10 offset:14064
    ds_read_b64_tr_b16 a[76:77], v10 offset:13952
    ds_read_b64_tr_b16 a[78:79], v10 offset:14096
    ds_read_b64_tr_b16 a[80:81], v10 offset:18432
    ds_read_b64_tr_b16 a[82:83], v10 offset:18576
    ds_read_b64_tr_b16 a[84:85], v10 offset:18464
    ds_read_b64_tr_b16 a[86:87], v10 offset:18608
    ds_read_b64_tr_b16 a[88:89], v10 offset:18496
    ds_read_b64_tr_b16 a[90:91], v10 offset:18640
    ds_read_b64_tr_b16 a[92:93], v10 offset:18528
    ds_read_b64_tr_b16 a[94:95], v10 offset:18672
    ds_read_b64_tr_b16 a[96:97], v10 offset:18560
    ds_read_b64_tr_b16 a[98:99], v10 offset:18704
    buffer_load_dword v9, v8, s[52:55], 0 offen sc1
    ds_read_b64_tr_b16 a[100:101], v10 offset:23040
    ds_read_b64_tr_b16 a[102:103], v10 offset:23184
    ds_read_b64_tr_b16 a[104:105], v10 offset:23072
    ds_read_b64_tr_b16 a[106:107], v10 offset:23216
    ds_read_b64_tr_b16 a[108:109], v10 offset:23104
    ds_read_b64_tr_b16 a[110:111], v10 offset:23248
    ds_read_b64_tr_b16 a[112:113], v10 offset:23136
    ds_read_b64_tr_b16 a[114:115], v10 offset:23280
    ds_read_b64_tr_b16 a[116:117], v10 offset:23168
    ds_read_b64_tr_b16 a[118:119], v10 offset:23312
    ds_read_b64_tr_b16 a[120:121], v10 offset:27648
    ds_read_b64_tr_b16 a[122:123], v10 offset:27792
    ds_read_b64_tr_b16 a[124:125], v10 offset:27680
    ds_read_b64_tr_b16 a[126:127], v10 offset:27824
    ds_read_b64_tr_b16 a[128:129], v10 offset:27712
    ds_read_b64_tr_b16 a[130:131], v10 offset:27856
    ds_read_b64_tr_b16 a[132:133], v10 offset:27744
    ds_read_b64_tr_b16 a[134:135], v10 offset:27888
    ds_read_b64_tr_b16 a[136:137], v10 offset:27776
    ds_read_b64_tr_b16 a[138:139], v10 offset:27920
    ds_read_b64_tr_b16 a[140:141], v10 offset:32256
    ds_read_b64_tr_b16 a[142:143], v10 offset:32400
    ds_read_b64_tr_b16 a[144:145], v10 offset:32288
    ds_read_b64_tr_b16 a[146:147], v10 offset:32432
    ds_read_b64_tr_b16 a[148:149], v10 offset:32320
    ds_read_b64_tr_b16 a[150:151], v10 offset:32464
    ds_read_b64_tr_b16 a[152:153], v10 offset:32352
    ds_read_b64_tr_b16 a[154:155], v10 offset:32496
    ds_read_b64_tr_b16 a[156:157], v10 offset:32384
    ds_read_b64_tr_b16 a[158:159], v10 offset:32528
    v_lshrrev_b32 v4, 1, v3
    v_and_b32 v5, 1, v3
    v_lshl_add_u32 v11, v5, 1, v4
    v_lshlrev_b32 v4, 4, v2
    v_lshl_add_u32 v16, v11, 8, v4
    s_mul_i32 s45, s29, 2304
    s_add_u32 s45, s45, s69
    s_add_u32 s45, s45, 4194304
    s_lshl_b32 s32, s26, 1
    s_add_u32 s32, s32, s28
    s_lshl_b32 s32, s32, 3
    s_add_u32 s32, s32, s29
    s_lshl_b32 s32, s32, 2
    s_add_u32 s32, s32, s3
    s_lshl_b32 s32, s32, 7
    s_add_u32 s46, s32, 7340032
    v_min_u32 v5, 14, v1
    v_mul_u32_u24 v4, 52, v5
    v_lshrrev_b32 v4, 8, v4
    v_mul_u32_u24 v4, 67, v4
    s_mul_i32 s32, s27, 9
    s_lshr_b32 s32, s32, 1
    v_add3_u32 v4, v4, v5, s32
    v_lshlrev_b32 v48, 7, v4
    s_add_u32 s32, s69, 1048576
    s_waitcnt vmcnt(0)
    v_cmp_gt_u32 vcc, 1, v9
    s_cbranch_vccz L_pollx_13
    s_mov_b32 s35, 0
L_poll_12:
    s_add_u32 s35, s35, 1
    s_cmp_gt_u32 s35, 400000
    s_cbranch_scc1 L_pollx_13
    buffer_load_dword v9, v8, s[52:55], 0 offen sc1
    s_waitcnt vmcnt(0)
    v_cmp_gt_u32 vcc, 1, v9
    s_cbranch_vccnz L_poll_12
L_pollx_13:
    buffer_load_dwordx4 v[152:155], v17, s[52:55], s32 offen offset:0 sc1
    buffer_load_dwordx4 v[156:159], v17, s[52:55], s32 offen offset:1024 sc1
    buffer_load_dwordx4 v[160:163], v17, s[52:55], s32 offen offset:2048 sc1
    buffer_load_dwordx4 v[164:167], v17, s[52:55], s32 offen offset:3072 sc1
    s_add_u32 s32, s32, 4096
    buffer_load_dwordx4 v[168:171], v17, s[52:55], s32 offen offset:0 sc1
    buffer_load_dwordx4 v[172:175], v17, s[52:55], s32 offen offset:1024 sc1
    buffer_load_dwordx4 v[176:179], v17, s[52:55], s32 offen offset:2048 sc1
    buffer_load_dwordx4 v[180:183], v17, s[52:55], s32 offen offset:3072 sc1
    s_add_u32 s32, s32, 4096
    buffer_load_dwordx4 v[184:187], v17, s[52:55], s32 offen offset:0 sc1
    buffer_load_dwordx4 v[188:191], v17, s[52:55], s32 offen offset:1024 sc1
    buffer_load_dwordx4 v[192:195], v17, s[52:55], s32 offen offset:2048 sc1
    buffer_load_dwordx4 v[196:199], v17, s[52:55], s32 offen offset:3072 sc1
    s_add_u32 s32, s32, 4096
    buffer_load_dwordx4 v[200:203], v17, s[52:55], s32 offen offset:0 sc1
    buffer_load_dwordx4 v[204:207], v17, s[52:55], s32 offen offset:1024 sc1
    buffer_load_dwordx4 v[208:211], v17, s[52:55], s32 offen offset:2048 sc1
    buffer_load_dwordx4 v[212:215], v17, s[52:55], s32 offen offset:3072 sc1
    s_add_u32 s32, s32, 4096
    buffer_load_dwordx4 v[216:219], v17, s[52:55], s32 offen offset:0 sc1
    buffer_load_dwordx4 v[220:223], v17, s[52:55], s32 offen offset:1024 sc1
    buffer_load_dword v9, v48, s[52:55], 0 offen sc1
    s_barrier
    ds_read_b64_tr_b16 a[160:161], v10 offset:36864
    ds_read_b64_tr_b16 a[162:163], v10 offset:37008
    ds_read_b64_tr_b16 a[164:165], v10 offset:36896
    ds_read_b64_tr_b16 a[166:167], v10 offset:37040
    ds_read_b64_tr_b16 a[168:169], v10 offset:36928
    ds_read_b64_tr_b16 a[170:171], v10 offset:37072
    ds_read_b64_tr_b16 a[172:173], v10 offset:36960
    ds_read_b64_tr_b16 a[174:175], v10 offset:37104
    ds_read_b64_tr_b16 a[176:177], v10 offset:36992
    ds_read_b64_tr_b16 a[178:179], v10 offset:37136
    ds_read_b64_tr_b16 a[180:181], v10 offset:41472
    ds_read_b64_tr_b16 a[182:183], v10 offset:41616
    ds_read_b64_tr_b16 a[184:185], v10 offset:41504
    ds_read_b64_tr_b16 a[186:187], v10 offset:41648
    ds_read_b64_tr_b16 a[188:189], v10 offset:41536
    ds_read_b64_tr_b16 a[190:191], v10 offset:41680
    ds_read_b64_tr_b16 a[192:193], v10 offset:41568
    ds_read_b64_tr_b16 a[194:195], v10 offset:41712
    ds_read_b64_tr_b16 a[196:197], v10 offset:41600
    ds_read_b64_tr_b16 a[198:199], v10 offset:41744
    ds_read_b64_tr_b16 a[200:201], v49 offset:0
    ds_read_b64_tr_b16 a[202:203], v49 offset:144
    ds_read_b64_tr_b16 a[204:205], v49 offset:32
    ds_read_b64_tr_b16 a[206:207], v49 offset:176
    ds_read_b64_tr_b16 a[208:209], v49 offset:64
    ds_read_b64_tr_b16 a[210:211], v49 offset:208
    ds_read_b64_tr_b16 a[212:213], v49 offset:96
    ds_read_b64_tr_b16 a[214:215], v49 offset:240
    ds_read_b64_tr_b16 a[216:217], v49 offset:128
    ds_read_b64_tr_b16 a[218:219], v49 offset:272
    v_lshlrev_b32 v7, 3, v2
    s_mov_b32 vcc_lo, -1
    s_mov_b32 vcc_hi, 0
    s_waitcnt vmcnt(18)
    s_waitcnt lgkmcnt(15)
    v_mfma_f32_16x16x32_bf16 v[12:15], a[0:3], v[152:155], v[12:15]
    ds_read_b64_tr_b16 a[220:221], v49 offset:4608
    ds_read_b64_tr_b16 a[222:223], v49 offset:4752
    v_mfma_f32_16x16x32_bf16 v[32:35], a[4:7], v[152:155], v[32:35]
    ds_read_b64_tr_b16 a[224:225], v49 offset:4640
    ds_read_b64_tr_b16 a[226:227], v49 offset:4784
    v_mfma_f32_16x16x32_bf16 v[36:39], a[8:11], v[152:155], v[36:39]
    ds_read_b64_tr_b16 a[228:229], v49 offset:4672
    ds_read_b64_tr_b16 a[230:231], v49 offset:4816
    v_mfma_f32_16x16x32_bf16 v[40:43], a[12:15], v[152:155], v[40:43]
    ds_read_b64_tr_b16 a[232:233], v49 offset:4704
    ds_read_b64_tr_b16 a[234:235], v49 offset:4848
    v_mfma_f32_16x16x32_bf16 v[44:47], a[16:19], v[152:155], v[44:47]
    ds_read_b64_tr_b16 a[236:237], v49 offset:4736
    ds_read_b64_tr_b16 a[238:239], v49 offset:4880
    s_waitcnt vmcnt(17)
    s_waitcnt lgkmcnt(15)
    v_mfma_f32_16x16x32_bf16 v[12:15], a[20:23], v[156:159], v[12:15]
    ds_read_b64_tr_b16 a[240:241], v49 offset:9216
    ds_read_b64_tr_b16 a[242:243], v49 offset:9360
    v_mfma_f32_16x16x32_bf16 v[32:35], a[24:27], v[156:159], v[32:35]
    ds_read_b64_tr_b16 a[244:245], v49 offset:9248
    ds_read_b64_tr_b16 a[246:247], v49 offset:9392
    v_mfma_f32_16x16x32_bf16 v[36:39], a[28:31], v[156:159], v[36:39]
    ds_read_b64_tr_b16 a[248:249], v49 offset:9280
    ds_read_b64_tr_b16 a[250:251], v49 offset:9424
    v_mfma_f32_16x16x32_bf16 v[40:43], a[32:35], v[156:159], v[40:43]
    ds_read_b64_tr_b16 a[252:253], v49 offset:9312
    ds_read_b64_tr_b16 a[254:255], v49 offset:9456
    v_mfma_f32_16x16x32_bf16 v[44:47], a[36:39], v[156:159], v[44:47]
    ds_read_b64_tr_b16 v[20:21], v49 offset:9344
    ds_read_b64_tr_b16 v[22:23], v49 offset:9488
    s_waitcnt vmcnt(16)
    s_waitcnt lgkmcnt(15)
    v_mfma_f32_16x16x32_bf16 v[12:15], a[40:43], v[160:163], v[12:15]
    ds_read_b64_tr_b16 v[24:25], v49 offset:13824
    ds_read_b64_tr_b16 v[26:27], v49 offset:13968
    v_mfma_f32_16x16x32_bf16 v[32:35], a[44:47], v[160:163], v[32:35]
    ds_read_b64_tr_b16 v[28:29], v49 offset:13856
    ds_read_b64_tr_b16 v[30:31], v49 offset:14000
    v_mfma_f32_16x16x32_bf16 v[36:39], a[48:51], v[160:163], v[36:39]
    ds_read_b64_tr_b16 v[60:61], v49 offset:13888
    ds_read_b64_tr_b16 v[62:63], v49 offset:14032
    v_mfma_f32_16x16x32_bf16 v[40:43], a[52:55], v[160:163], v[40:43]
    ds_read_b64_tr_b16 v[64:65], v49 offset:13920
    ds_read_b64_tr_b16 v[66:67], v49 offset:14064
    v_mfma_f32_16x16x32_bf16 v[44:47], a[56:59], v[160:163], v[44:47]
    ds_read_b64_tr_b16 v[68:69], v49 offset:13952
    ds_read_b64_tr_b16 v[70:71], v49 offset:14096
    s_waitcnt vmcnt(15)
    s_waitcnt lgkmcnt(15)
    v_mfma_f32_16x16x32_bf16 v[12:15], a[60:63], v[164:167], v[12:15]
    ds_read_b64_tr_b16 v[72:73], v49 offset:18432
    ds_read_b64_tr_b16 v[74:75], v49 offset:18576
    v_mfma_f32_16x16x32_bf16 v[32:35], a[64:67], v[164:167], v[32:35]
    ds_read_b64_tr_b16 v[76:77], v49 offset:18464
    ds_read_b64_tr_b16 v[78:79], v49 offset:18608
    v_mfma_f32_16x16x32_bf16 v[36:39], a[68:71], v[164:167], v[36:39]
    ds_read_b64_tr_b16 v[80:81], v49 offset:18496
    ds_read_b64_tr_b16 v[82:83], v49 offset:18640
    v_mfma_f32_16x16x32_bf16 v[40:43], a[72:75], v[164:167], v[40:43]
    ds_read_b64_tr_b16 v[84:85], v49 offset:18528
    ds_read_b64_tr_b16 v[86:87], v49 offset:18672
    v_mfma_f32_16x16x32_bf16 v[44:47], a[76:79], v[164:167], v[44:47]
    ds_read_b64_tr_b16 v[88:89], v49 offset:18560
    ds_read_b64_tr_b16 v[90:91], v49 offset:18704
    s_waitcnt vmcnt(14)
    s_waitcnt lgkmcnt(15)
    v_mfma_f32_16x16x32_bf16 v[12:15], a[80:83], v[168:171], v[12:15]
    ds_read_b64_tr_b16 v[92:93], v49 offset:23040
    ds_read_b64_tr_b16 v[94:95], v49 offset:23184
    v_mfma_f32_16x16x32_bf16 v[32:35], a[84:87], v[168:171], v[32:35]
    ds_read_b64_tr_b16 v[96:97], v49 offset:23072
    ds_read_b64_tr_b16 v[98:99], v49 offset:23216
    v_mfma_f32_16x16x32_bf16 v[36:39], a[88:91], v[168:171], v[36:39]
    ds_read_b64_tr_b16 v[100:101], v49 offset:23104
    ds_read_b64_tr_b16 v[102:103], v49 offset:23248
    v_mfma_f32_16x16x32_bf16 v[40:43], a[92:95], v[168:171], v[40:43]
    ds_read_b64_tr_b16 v[104:105], v49 offset:23136
    ds_read_b64_tr_b16 v[106:107], v49 offset:23280
    v_mfma_f32_16x16x32_bf16 v[44:47], a[96:99], v[168:171], v[44:47]
    ds_read_b64_tr_b16 v[108:109], v49 offset:23168
    ds_read_b64_tr_b16 v[110:111], v49 offset:23312
    s_waitcnt vmcnt(13)
    s_waitcnt lgkmcnt(15)
    v_mfma_f32_16x16x32_bf16 v[12:15], a[100:103], v[172:175], v[12:15]
    ds_read_b64_tr_b16 v[112:113], v49 offset:27648
    ds_read_b64_tr_b16 v[114:115], v49 offset:27792
    v_mfma_f32_16x16x32_bf16 v[32:35], a[104:107], v[172:175], v[32:35]
    ds_read_b64_tr_b16 v[116:117], v49 offset:27680
    ds_read_b64_tr_b16 v[118:119], v49 offset:27824
    v_mfma_f32_16x16x32_bf16 v[36:39], a[108:111], v[172:175], v[36:39]
    ds_read_b64_tr_b16 v[120:121], v49 offset:27712
    ds_read_b64_tr_b16 v[122:123], v49 offset:27856
    v_mfma_f32_16x16x32_bf16 v[40:43], a[112:115], v[172:175], v[40:43]
    ds_read_b64_tr_b16 v[124:125], v49 offset:27744
    ds_read_b64_tr_b16 v[126:127], v49 offset:27888
    v_mfma_f32_16x16x32_bf16 v[44:47], a[116:119], v[172:175], v[44:47]
    ds_read_b64_tr_b16 v[128:129], v49 offset:27776
    ds_read_b64_tr_b16 v[130:131], v49 offset:27920
    s_waitcnt vmcnt(12)
    s_waitcnt lgkmcnt(15)
    v_mfma_f32_16x16x32_bf16 v[12:15], a[120:123], v[176:179], v[12:15]
    ds_read_b64_tr_b16 v[132:133], v49 offset:32256
    ds_read_b64_tr_b16 v[134:135], v49 offset:32400
    v_mfma_f32_16x16x32_bf16 v[32:35], a[124:127], v[176:179], v[32:35]
    ds_read_b64_tr_b16 v[136:137], v49 offset:32288
    ds_read_b64_tr_b16 v[138:139], v49 offset:32432
    v_mfma_f32_16x16x32_bf16 v[36:39], a[128:131], v[176:179], v[36:39]
    ds_read_b64_tr_b16 v[140:141], v49 offset:32320
    ds_read_b64_tr_b16 v[142:143], v49 offset:32464
    v_mfma_f32_16x16x32_bf16 v[40:43], a[132:135], v[176:179], v[40:43]
    ds_read_b64_tr_b16 v[144:145], v49 offset:32352
    ds_read_b64_tr_b16 v[146:147], v49 offset:32496
    v_mfma_f32_16x16x32_bf16 v[44:47], a[136:139], v[176:179], v[44:47]
    ds_read_b64_tr_b16 v[148:149], v49 offset:32384
    ds_read_b64_tr_b16 v[150:151], v49 offset:32528
    s_waitcnt vmcnt(11)
    s_waitcnt lgkmcnt(15)
    v_mfma_f32_16x16x32_bf16 v[12:15], a[140:143], v[180:183], v[12:15]
    v_mfma_f32_16x16x32_bf16 v[32:35], a[144:147], v[180:183], v[32:35]
    v_mfma_f32_16x16x32_bf16 v[36:39], a[148:151], v[180:183], v[36:39]
    v_mfma_f32_16x16x32_bf16 v[40:43], a[152:155], v[180:183], v[40:43]
    v_mfma_f32_16x16x32_bf16 v[44:47], a[156:159], v[180:183], v[44:47]
    s_waitcnt vmcnt(10)
    s_waitcnt lgkmcnt(15)
    v_mfma_f32_16x16x32_bf16 v[12:15], a[160:163], v[184:187], v[12:15]
    v_mfma_f32_16x16x32_bf16 v[32:35], a[164:167], v[184:187], v[32:35]
    v_mfma_f32_16x16x32_bf16 v[36:39], a[168:171], v[184:187], v[36:39]
    v_mfma_f32_16x16x32_bf16 v[40:43], a[172:175], v[184:187], v[40:43]
    v_mfma_f32_16x16x32_bf16 v[44:47], a[176:179], v[184:187], v[44:47]
    s_waitcnt vmcnt(9)
    s_waitcnt lgkmcnt(15)
    v_mfma_f32_16x16x32_bf16 v[12:15], a[180:183], v[188:191], v[12:15]
    v_mfma_f32_16x16x32_bf16 v[32:35], a[184:187], v[188:191], v[32:35]
    v_mfma_f32_16x16x32_bf16 v[36:39], a[188:191], v[188:191], v[36:39]
    v_mfma_f32_16x16x32_bf16 v[40:43], a[192:195], v[188:191], v[40:43]
    v_mfma_f32_16x16x32_bf16 v[44:47], a[196:199], v[188:191], v[44:47]
    s_waitcnt vmcnt(8)
    s_waitcnt lgkmcnt(15)
    v_mfma_f32_16x16x32_bf16 v[12:15], a[200:203], v[192:195], v[12:15]
    s_waitcnt lgkmcnt(0)
    s_barrier
    v_mfma_f32_16x16x32_bf16 v[32:35], a[204:207], v[192:195], v[32:35]
    v_mfma_f32_16x16x32_bf16 v[36:39], a[208:211], v[192:195], v[36:39]
    s_add_u32 s40, s38, 0
    s_and_b32 s40, s40, 3
    s_lshl_b32 s40, s40, 6
    v_mfma_f32_16x16x32_bf16 v[40:43], a[212:215], v[192:195], v[40:43]
    v_mfma_f32_16x16x32_bf16 v[44:47], a[216:219], v[192:195], v[44:47]
    s_add_u32 s40, s40, s36
    s_lshl_b32 s40, s40, 1
    s_add_u32 s40, s40, 0
    s_waitcnt vmcnt(7)
    v_mfma_f32_16x16x32_bf16 v[12:15], a[220:223], v[196:199], v[12:15]
    s_add_u32 m0, s41, 0
    v_mfma_f32_16x16x32_bf16 v[32:35], a[224:227], v[196:199], v[32:35]
    v_mfma_f32_16x16x32_bf16 v[36:39], a[228:231], v[196:199], v[36:39]
    buffer_load_dwordx4 v50, s[92:95], s40 offen offset:0  lds
    v_mfma_f32_16x16x32_bf16 v[40:43], a[232:235], v[196:199], v[40:43]
    v_mfma_f32_16x16x32_bf16 v[44:47], a[236:239], v[196:199], v[44:47]
    buffer_load_dwordx4 v51, s[92:95], s40 offen offset:1024  lds
    s_waitcnt vmcnt(8)
    v_mfma_f32_16x16x32_bf16 v[12:15], a[240:243], v[200:203], v[12:15]
    buffer_load_dwordx4 v52, s[92:95], s40 offen offset:2048  lds
    v_mfma_f32_16x16x32_bf16 v[32:35], a[244:247], v[200:203], v[32:35]
    v_mfma_f32_16x16x32_bf16 v[36:39], a[248:251], v[200:203], v[36:39]
    buffer_load_dwordx4 v53, s[92:95], s40 offen offset:3072  lds
    v_mfma_f32_16x16x32_bf16 v[40:43], a[252:255], v[200:203], v[40:43]
    v_mfma_f32_16x16x32_bf16 v[44:47], v[20:23], v[200:203], v[44:47]
    s_add_u32 m0, s41, 4096
    s_waitcnt vmcnt(9)
    v_mfma_f32_16x16x32_bf16 v[12:15], v[24:27], v[204:207], v[12:15]
    buffer_load_dwordx4 v54, s[92:95], s40 offen offset:0  lds
    v_mfma_f32_16x16x32_bf16 v[32:35], v[28:31], v[204:207], v[32:35]
    v_mfma_f32_16x16x32_bf16 v[36:39], v[60:63], v[204:207], v[36:39]
    buffer_load_dwordx4 v55, s[92:95], s40 offen offset:1024  lds
    v_mfma_f32_16x16x32_bf16 v[40:43], v[64:67], v[204:207], v[40:43]
    v_mfma_f32_16x16x32_bf16 v[44:47], v[68:71], v[204:207], v[44:47]
    buffer_load_dwordx4 v56, s[92:95], s40 offen offset:2048  lds
    s_waitcnt vmcnt(11)
    v_mfma_f32_16x16x32_bf16 v[12:15], v[72:75], v[208:211], v[12:15]
    buffer_load_dwordx4 v57, s[92:95], s40 offen offset:3072  lds
    v_mfma_f32_16x16x32_bf16 v[32:35], v[76:79], v[208:211], v[32:35]
    v_mfma_f32_16x16x32_bf16 v[36:39], v[80:83], v[208:211], v[36:39]
    s_add_u32 m0, s41, 8192
    v_mfma_f32_16x16x32_bf16 v[40:43], v[84:87], v[208:211], v[40:43]
    v_mfma_f32_16x16x32_bf16 v[44:47], v[88:91], v[208:211], v[44:47]
    buffer_load_dwordx4 v58, s[92:95], s40 offen offset:0  lds
    s_waitcnt vmcnt(12)
    v_mfma_f32_16x16x32_bf16 v[12:15], v[92:95], v[212:215], v[12:15]
    v_mfma_f32_16x16x32_bf16 v[32:35], v[96:99], v[212:215], v[32:35]
    v_mfma_f32_16x16x32_bf16 v[36:39], v[100:103], v[212:215], v[36:39]
    v_mfma_f32_16x16x32_bf16 v[40:43], v[104:107], v[212:215], v[40:43]
    v_mfma_f32_16x16x32_bf16 v[44:47], v[108:111], v[212:215], v[44:47]
    s_waitcnt vmcnt(11)
    v_mfma_f32_16x16x32_bf16 v[12:15], v[112:115], v[216:219], v[12:15]
    v_mfma_f32_16x16x32_bf16 v[32:35], v[116:119], v[216:219], v[32:35]
    v_mfma_f32_16x16x32_bf16 v[36:39], v[120:123], v[216:219], v[36:39]
    v_mfma_f32_16x16x32_bf16 v[40:43], v[124:127], v[216:219], v[40:43]
    v_mfma_f32_16x16x32_bf16 v[44:47], v[128:131], v[216:219], v[44:47]
    s_waitcnt vmcnt(10)
    v_mfma_f32_16x16x32_bf16 v[12:15], v[132:135], v[220:223], v[12:15]
    v_mfma_f32_16x16x32_bf16 v[32:35], v[136:139], v[220:223], v[32:35]
    v_mfma_f32_16x16x32_bf16 v[36:39], v[140:143], v[220:223], v[36:39]
    v_mfma_f32_16x16x32_bf16 v[40:43], v[144:147], v[220:223], v[40:43]
    v_mfma_f32_16x16x32_bf16 v[44:47], v[148:151], v[220:223], v[44:47]
    s_nop 3
    v_cvt_pk_bf16_f32 v20, v12, v13
    v_cvt_pk_bf16_f32 v21, v14, v15
    v_cvt_pk_bf16_f32 v22, v32, v33
    v_cvt_pk_bf16_f32 v23, v34, v35
    v_cvt_pk_bf16_f32 v24, v36, v37
    v_cvt_pk_bf16_f32 v25, v38, v39
    v_cvt_pk_bf16_f32 v26, v40, v41
    v_cvt_pk_bf16_f32 v27, v42, v43
    v_cvt_pk_bf16_f32 v28, v44, v45
    v_cvt_pk_bf16_f32 v29, v46, v47
    v_mov_b32 v30, v28
    v_mov_b32 v31, v29
    v_cndmask_b32 v44, 0, v44, vcc
    v_cndmask_b32 v45, 0, v45, vcc
    v_cndmask_b32 v46, 0, v46, vcc
    v_cndmask_b32 v47, 0, v47, vcc
    v_permlane16_swap_b32 v20, v22
    v_permlane16_swap_b32 v21, v23
    v_permlane16_swap_b32 v24, v26
    v_permlane16_swap_b32 v25, v27
    v_permlane16_swap_b32 v28, v30
    v_permlane16_swap_b32 v29, v31
    buffer_store_dwordx4 v[20:23], v16, s[52:55], s45 offen offset:0 sc1
    buffer_store_dwordx4 v[24:27], v16, s[52:55], s45 offen offset:1024 sc1
    s_mov_b64 exec, 0xffff
    buffer_store_dwordx4 v[28:31], v16, s[52:55], s45 offen offset:2048 sc1
    s_mov_b64 exec, -1
    v_pk_add_f32 v[60:61], v[12:13], v[14:15]
    v_pk_mul_f32 v[62:63], v[12:13], v[12:13]
    v_pk_fma_f32 v[62:63], v[14:15], v[14:15], v[62:63]
    v_pk_add_f32 v[60:61], v[60:61], v[32:33]
    v_pk_fma_f32 v[62:63], v[32:33], v[32:33], v[62:63]
    v_pk_add_f32 v[60:61], v[60:61], v[34:35]
    v_pk_fma_f32 v[62:63], v[34:35], v[34:35], v[62:63]
    v_pk_add_f32 v[60:61], v[60:61], v[36:37]
    v_pk_fma_f32 v[62:63], v[36:37], v[36:37], v[62:63]
    v_pk_add_f32 v[60:61], v[60:61], v[38:39]
    v_pk_fma_f32 v[62:63], v[38:39], v[38:39], v[62:63]
    v_pk_add_f32 v[60:61], v[60:61], v[40:41]
    v_pk_fma_f32 v[62:63], v[40:41], v[40:41], v[62:63]
    v_pk_add_f32 v[60:61], v[60:61], v[42:43]
    v_pk_fma_f32 v[62:63], v[42:43], v[42:43], v[62:63]
    v_pk_add_f32 v[60:61], v[60:61], v[44:45]
    v_pk_fma_f32 v[62:63], v[44:45], v[44:45], v[62:63]
    v_pk_add_f32 v[60:61], v[60:61], v[46:47]
    v_pk_fma_f32 v[62:63], v[46:47], v[46:47], v[62:63]
    v_add_f32 v60, v60, v61
    v_add_f32 v61, v62, v63
    s_nop 1
    v_permlane32_swap_b32 v60, v61
    v_add_f32 v60, v60, v61
    v_mov_b32 v61, v60
    s_nop 1
    v_permlane16_swap_b32 v60, v61
    v_add_f32 v60, v60, v61
    v_mov_b32 v61, v60
    s_nop 1
    v_permlane32_swap_b32 v60, v61
    s_mov_b64 exec, 0xffff
    buffer_store_dwordx2 v[60:61], v7, s[52:55], s46 offen sc1
    s_mov_b64 exec, -1
    s_waitcnt vmcnt(13)
    v_cmp_gt_u32 vcc, 1, v9
    s_cbranch_vccz L_pollx_15
    s_mov_b32 s35, 0
L_poll_14:
    s_add_u32 s35, s35, 1
    s_cmp_gt_u32 s35, 400000
    s_cbranch_scc1 L_pollx_15
    buffer_load_dword v9, v48, s[52:55], 0 offen sc1
    s_waitcnt vmcnt(0)
    v_cmp_gt_u32 vcc, 1, v9
    s_cbranch_vccnz L_poll_14
L_pollx_15:
    s_mov_b32 s68, s14
    s_mov_b32 s69, s15
    s_mov_b32 s70, 9216
    s_mov_b32 s71, 0x20000
    s_mul_i32 s32, s27, 288
    s_mul_i32 s33, s3, 72
    s_add_u32 s32, s32, s33
    v_lshl_add_u32 v4, v1, 1, s32
    v_lshlrev_b32 v5, 1, v4
    v_lshlrev_b32 v4, 2, v4
    s_mov_b32 exec_lo, -1
    s_mov_b32 exec_hi, 15
    buffer_load_dword v8, v5, s[68:71], 0 offen
    s_mov_b32 s32, 7864320
    buffer_load_dwordx2 v[64:65], v4, s[52:55], s32 offen sc1
    s_add_u32 s32, s32, 18432
    buffer_load_dwordx2 v[66:67], v4, s[52:55], s32 offen sc1
    s_add_u32 s32, s32, 18432
    buffer_load_dwordx2 v[68:69], v4, s[52:55], s32 offen sc1
    s_add_u32 s32, s32, 18432
    buffer_load_dwordx2 v[70:71], v4, s[52:55], s32 offen sc1
    s_add_u32 s32, s32, 18432
    buffer_load_dwordx2 v[72:73], v4, s[52:55], s32 offen sc1
    s_add_u32 s32, s32, 18432
    buffer_load_dwordx2 v[74:75], v4, s[52:55], s32 offen sc1
    s_add_u32 s32, s32, 18432
    buffer_load_dwordx2 v[76:77], v4, s[52:55], s32 offen sc1
    s_add_u32 s32, s32, 18432
    buffer_load_dwordx2 v[78:79], v4, s[52:55], s32 offen sc1
    s_add_u32 s32, s32, 18432
    buffer_load_dwordx2 v[80:81], v4, s[52:55], s32 offen sc1
    s_add_u32 s32, s32, 18432
    buffer_load_dwordx2 v[82:83], v4, s[52:55], s32 offen sc1
    s_add_u32 s32, s32, 18432
    buffer_load_dwordx2 v[84:85], v4, s[52:55], s32 offen sc1
    s_add_u32 s32, s32, 18432
    buffer_load_dwordx2 v[86:87], v4, s[52:55], s32 offen sc1
    s_mov_b64 exec, -1
    s_waitcnt vmcnt(13)
    s_barrier
    s_cmp_lg_u32 s3, 0
    s_cbranch_scc1 L_w0_16
    v_mov_b32 v19, 2
    s_mov_b64 exec, 1
    buffer_store_dword v19, v18, s[52:55], s65 offen offset:0 sc1
    s_mov_b64 exec, -1
L_w0_16:
    s_xor_b32 s33, s27, 1
    v_mov_b32 v4, s33
    v_cmp_eq_u32 vcc, s27, v2
    s_lshl_b32 s32, s26, 11
    s_nop 0
    v_cndmask_b32 v4, v2, v4, vcc
    v_lshl_add_u32 v48, v4, 7, s32
    s_add_u32 s40, s38, 1
    s_and_b32 s40, s40, 3
    s_lshl_b32 s40, s40, 6
    s_add_u32 s40, s40, s36
    s_lshl_b32 s40, s40, 1
    s_add_u32 s40, s40, 0
    s_add_u32 m0, s41, 36864
    s_nop 0
    buffer_load_dwordx4 v50, s[92:95], s40 offen offset:0  lds
    buffer_load_dwordx4 v51, s[92:95], s40 offen offset:1024  lds
    buffer_load_dwordx4 v52, s[92:95], s40 offen offset:2048  lds
    buffer_load_dwordx4 v53, s[92:95], s40 offen offset:3072  lds
    s_add_u32 m0, s41, 40960
    s_nop 0
    buffer_load_dwordx4 v54, s[92:95], s40 offen offset:0  lds
    buffer_load_dwordx4 v55, s[92:95], s40 offen offset:1024  lds
    buffer_load_dwordx4 v56, s[92:95], s40 offen offset:2048  lds
    buffer_load_dwordx4 v57, s[92:95], s40 offen offset:3072  lds
    s_add_u32 m0, s41, 45056
    s_nop 0
    buffer_load_dwordx4 v58, s[92:95], s40 offen offset:0  lds
    s_cmp_lg_u32 s3, 3
    s_cbranch_scc1 L_only_17
    s_getpc_b64 s[46:47]
L_pc2:
    s_lshr_b32 s32, s2, 3
    s_and_b32 s32, s32, 7
    s_lshl_b32 s32, s32, 6
    v_add_u32 v4, s32, v1
    v_lshlrev_b32 v4, 7, v4
    v_min_u32 v4, L_end - L_pc2, v4
    v_mov_b32 v13, s47
    v_add_co_u32 v12, vcc, s46, v4
    s_nop 1
    v_addc_co_u32 v13, vcc, 0, v13, vcc
    global_load_dword v12, v[12:13], off
L_only_17:
    v_lshrrev_b32 v4, 2, v1
    v_mul_u32_u24 v4, 9216, v4
    s_mul_i32 s32, s3, 1327104
    s_mul_i32 s33, s27, 576
    s_add_u32 s32, s32, s33
    v_add_u32 v4, s32, v4
    v_and_b32 v5, 3, v1
    v_lshrrev_b32 v6, 5, v1
    v_lshlrev_b32 v6, 1, v6
    v_xor_b32 v5, v5, v6
    v_lshl_add_u32 v10, v5, 4, v4
    v_lshrrev_b32 v4, 3, v1
    v_mul_u32_u24 v4, 1152, v4
    v_and_b32 v5, 7, v1
    v_lshlrev_b32 v6, 1, v3
    v_xor_b32 v5, v5, v6
    v_lshl_add_u32 v14, v5, 4, v4
    s_mul_i32 s32, s3, 72
    s_lshl_b32 s33, s38, 6
    s_add_u32 s32, s32, s33
    s_add_u32 s33, s32, 0
    s_and_b32 s33, s33, 255
    s_mul_i32 s33, s33, 1152
    s_add_u32 s45, s33, 4096
    s_add_u32 s33, s32, 8
    s_and_b32 s33, s33, 255
    s_mul_i32 s33, s33, 1152
    s_add_u32 s46, s33, 3072
    s_add_u32 s33, s32, 16
    s_and_b32 s33, s33, 255
    s_mul_i32 s33, s33, 1152
    s_add_u32 s47, s33, 2048
    s_add_u32 s33, s32, 24
    s_and_b32 s33, s33, 255
    s_mul_i32 s33, s33, 1152
    s_add_u32 s66, s33, 1024
    s_add_u32 s33, s32, 32
    s_and_b32 s33, s33, 255
    s_mul_i32 s33, s33, 1152
    s_add_u32 s67, s33, 4096
    s_add_u32 s33, s32, 40
    s_and_b32 s33, s33, 255
    s_cmp_eq_u32 s3, 3
    s_cselect_b32 s33, 0, s33
    s_mul_i32 s33, s33, 1152
    s_add_u32 s68, s33, 3072
    s_add_u32 s33, s32, 48
    s_and_b32 s33, s33, 255
    s_cmp_eq_u32 s3, 3
    s_cselect_b32 s33, 8, s33
    s_mul_i32 s33, s33, 1152
    s_add_u32 s69, s33, 2048
    s_add_u32 s33, s32, 56
    s_and_b32 s33, s33, 255
    s_cmp_eq_u32 s3, 3
    s_cselect_b32 s33, 16, s33
    s_mul_i32 s33, s33, 1152
    s_add_u32 s70, s33, 1024
    s_add_u32 s33, s32, 64
    s_and_b32 s33, s33, 255
    s_cmp_eq_u32 s3, 3
    s_cselect_b32 s33, 24, s33
    s_mul_i32 s33, s33, 1152
    s_add_u32 s71, s33, 4096
    s_mul_i32 s32, s27, 288
    s_add_u32 s33, s32, s36
    s_add_u32 s34, s32, s37
    s_cmp_eq_u32 s3, 3
    s_cselect_b32 s34, s34, s33
    s_mul_i32 s72, s33, 1152
    s_mul_i32 s73, s34, 1152
    s_xor_b32 s32, s27, 1
    s_mul_i32 s32, s32, 288
    s_sub_u32 s33, s32, s36
    s_add_u32 s33, s33, 32
    s_sub_u32 s34, s32, s37
    s_add_u32 s34, s34, 256
    s_cmp_eq_u32 s3, 3
    s_cselect_b32 s34, s34, s33
    s_mul_i32 s74, s33, 1152
    s_mul_i32 s75, s34, 1152
    s_and_b32 s32, s27, 1
    s_mul_i32 s39, s32, 640
    v_bfe_u32 v4, v1, 2, 2
    v_lshl_add_u32 v4, v3, 3, v4
    v_and_b32 v5, 3, v1
    v_lshlrev_b32 v5, 3, v5
    v_bfe_u32 v6, v1, 3, 2
    s_lshl_b32 s32, s42, 1
    v_xor_b32 v6, s32, v6
    v_lshl_add_u32 v7, v4, 7, v5
    v_lshl_add_u32 v15, v6, 5, v7
    v_xor_b32 v16, 32, v15
    v_lshl_add_u32 v7, v4, 6, v5
    v_and_b32 v6, 1, v3
    v_xor_b32 v6, s42, v6
    v_lshl_add_u32 v20, v6, 5, v7
    v_add_u32 v20, 73728, v20
    buffer_load_dword v9, v48, s[52:55], 0 offen sc1
    s_waitcnt vmcnt(10)
    v_pk_add_f32 v[64:65], v[64:65], v[66:67]
    v_pk_add_f32 v[64:65], v[64:65], v[68:69]
    v_pk_add_f32 v[64:65], v[64:65], v[70:71]
    v_pk_add_f32 v[64:65], v[64:65], v[72:73]
    v_pk_add_f32 v[64:65], v[64:65], v[74:75]
    v_pk_add_f32 v[64:65], v[64:65], v[76:77]
    v_pk_add_f32 v[64:65], v[64:65], v[78:79]
    v_pk_add_f32 v[64:65], v[64:65], v[80:81]
    v_pk_add_f32 v[64:65], v[64:65], v[82:83]
    v_pk_add_f32 v[64:65], v[64:65], v[84:85]
    v_pk_add_f32 v[64:65], v[64:65], v[86:87]
    v_cvt_pk_bf16_f32 v4, v64, v64
    v_and_b32 v5, 0xffff0000, v4
    v_sub_f32 v5, v64, v5
    v_cvt_pk_bf16_f32 v68, v64, v5
    s_mov_b32 s32, 0x5040100
    v_perm_b32 v69, v8, v4, s32
    v_cvt_pk_bf16_f32 v4, v65, v65
    v_and_b32 v5, 0xffff0000, v4
    v_sub_f32 v5, v65, v5
    v_cvt_pk_bf16_f32 v70, v65, v5
    s_mov_b32 s32, 0x7060100
    v_perm_b32 v71, v8, v4, s32
    s_mul_i32 s32, s3, 576
    s_add_u32 s32, s32, 147456
    v_add_u32 v4, s32, v17
    s_mov_b32 exec_lo, -1
    s_mov_b32 exec_hi, 15
    ds_write_b128 v4, v[68:71]
    s_mov_b64 exec, -1
    s_lshl_b32 s32, s26, 2
    s_add_u32 s32, s32, s3
    s_mul_i32 s32, s32, 36864
    s_add_u32 s76, s32, 4194304
    s_add_u32 s77, s76, 18432
    s_lshl_b32 s78, s3, 11
    s_add_u32 s78, s78, 73728
    s_lshl_b32 s32, s43, 12
    s_add_u32 s32, s32, 73728
    v_add_u32 v8, s32, v17
    s_lshl_b32 s32, s26, 1
    s_add_u32 s32, s32, s43
    s_lshl_b32 s32, s32, 12
    s_add_u32 s79, s32, 7340032
    v_lshlrev_b32 v7, 3, v1
    s_lshl_b32 s33, s42, 8
    s_add_u32 s33, s33, 147456
    v_lshl_add_u32 v21, v2, 3, s33
    v_add_u32 v49, 0x10000, v8
    s_waitcnt vmcnt(0)
    v_cmp_gt_u32 vcc, 2, v9
    s_cbranch_vccz L_pollx_19
    s_mov_b32 s35, 0
L_poll_18:
    s_add_u32 s35, s35, 1
    s_cmp_gt_u32 s35, 400000
    s_cbranch_scc1 L_pollx_19
    buffer_load_dword v9, v48, s[52:55], 0 offen sc1
    s_waitcnt vmcnt(0)
    v_cmp_gt_u32 vcc, 2, v9
    s_cbranch_vccnz L_poll_18
L_pollx_19:
    s_add_u32 m0, s78, 0
    s_add_u32 s34, s76, 0
    buffer_load_dwordx4 v17, s[52:55], s34 offen sc1 lds
    s_add_u32 m0, s78, 1024
    s_add_u32 s34, s77, 0
    buffer_load_dwordx4 v17, s[52:55], s34 offen sc1 lds
    s_add_u32 m0, s78, 8192
    s_add_u32 s34, s76, 1024
    buffer_load_dwordx4 v17, s[52:55], s34 offen sc1 lds
    s_add_u32 m0, s78, 9216
    s_add_u32 s34, s77, 1024
    buffer_load_dwordx4 v17, s[52:55], s34 offen sc1 lds
    s_add_u32 m0, s78, 16384
    s_add_u32 s34, s76, 2048
    buffer_load_dwordx4 v17, s[52:55], s34 offen sc1 lds
    s_add_u32 m0, s78, 17408
    s_add_u32 s34, s77, 2048
    buffer_load_dwordx4 v17, s[52:55], s34 offen sc1 lds
    s_add_u32 m0, s78, 24576
    s_add_u32 s34, s76, 3072
    buffer_load_dwordx4 v17, s[52:55], s34 offen sc1 lds
    s_add_u32 m0, s78, 25600
    s_add_u32 s34, s77, 3072
    buffer_load_dwordx4 v17, s[52:55], s34 offen sc1 lds
    s_add_u32 m0, s78, 32768
    s_add_u32 s34, s76, 4096
    buffer_load_dwordx4 v17, s[52:55], s34 offen sc1 lds
    s_add_u32 m0, s78, 33792
    s_add_u32 s34, s77, 4096
    buffer_load_dwordx4 v17, s[52:55], s34 offen sc1 lds
    s_add_u32 m0, s78, 40960
    s_add_u32 s34, s76, 5120
    buffer_load_dwordx4 v17, s[52:55], s34 offen sc1 lds
    s_add_u32 m0, s78, 41984
    s_add_u32 s34, s77, 5120
    buffer_load_dwordx4 v17, s[52:55], s34 offen sc1 lds
    s_add_u32 m0, s78, 49152
    s_add_u32 s34, s76, 6144
    buffer_load_dwordx4 v17, s[52:55], s34 offen sc1 lds
    s_add_u32 m0, s78, 50176
    s_add_u32 s34, s77, 6144
    buffer_load_dwordx4 v17, s[52:55], s34 offen sc1 lds
    s_add_u32 m0, s78, 57344
    s_add_u32 s34, s76, 7168
    buffer_load_dwordx4 v17, s[52:55], s34 offen sc1 lds
    s_add_u32 m0, s78, 58368
    s_add_u32 s34, s77, 7168
    buffer_load_dwordx4 v17, s[52:55], s34 offen sc1 lds
    s_add_u32 m0, s78, 65536
    s_add_u32 s34, s76, 8192
    buffer_load_dwordx4 v17, s[52:55], s34 offen sc1 lds
    s_add_u32 m0, s78, 66560
    s_add_u32 s34, s77, 8192
    buffer_load_dwordx4 v17, s[52:55], s34 offen sc1 lds
    buffer_load_dwordx2 v[180:181], v7, s[52:55], s79 offen offset:0 sc1
    buffer_load_dwordx2 v[182:183], v7, s[52:55], s79 offen offset:512 sc1
    buffer_load_dwordx2 v[184:185], v7, s[52:55], s79 offen offset:1024 sc1
    buffer_load_dwordx2 v[186:187], v7, s[52:55], s79 offen offset:1536 sc1
    buffer_load_dwordx2 v[188:189], v7, s[52:55], s79 offen offset:2048 sc1
    buffer_load_dwordx2 v[190:191], v7, s[52:55], s79 offen offset:2560 sc1
    buffer_load_dwordx2 v[192:193], v7, s[52:55], s79 offen offset:3072 sc1
    buffer_load_dwordx2 v[194:195], v7, s[52:55], s79 offen offset:3584 sc1
    s_waitcnt vmcnt(20)
    s_waitcnt lgkmcnt(0)
    s_barrier
    ds_read_b128 a[0:3], v8 offset:0
    ds_read_b128 a[4:7], v8 offset:1024
    ds_read_b128 a[8:11], v8 offset:2048
    ds_read_b128 a[12:15], v8 offset:3072
    ds_read_b64_tr_b16 v[196:197], v15 offset:0
    ds_read_b64_tr_b16 v[198:199], v15 offset:512
    ds_read_b64_tr_b16 v[200:201], v16 offset:0
    ds_read_b64_tr_b16 v[202:203], v16 offset:512
    ds_read_b128 a[16:19], v8 offset:8192
    ds_read_b128 a[20:23], v8 offset:9216
    ds_read_b128 a[24:27], v8 offset:10240
    ds_read_b128 a[28:31], v8 offset:11264
    ds_read_b128 a[32:35], v8 offset:16384
    ds_read_b128 a[36:39], v8 offset:17408
    ds_read_b128 a[40:43], v8 offset:18432
    ds_read_b128 a[44:47], v8 offset:19456
    s_waitcnt lgkmcnt(10)
    v_mfma_f32_16x16x32_bf16 v[68:71], v[196:199], a[0:3], 0
    ds_read_b64_tr_b16 v[204:205], v15 offset:4096
    v_mfma_f32_16x16x32_bf16 v[72:75], v[196:199], a[4:7], 0
    ds_read_b64_tr_b16 v[206:207], v15 offset:4608
    v_mfma_f32_16x16x32_bf16 v[76:79], v[196:199], a[8:11], 0
    v_mfma_f32_16x16x32_bf16 v[80:83], v[196:199], a[12:15], 0
    s_waitcnt lgkmcnt(10)
    v_mfma_f32_16x16x32_bf16 v[84:87], v[200:203], a[0:3], 0
    ds_read_b64_tr_b16 v[196:197], v16 offset:4096
    v_mfma_f32_16x16x32_bf16 v[88:91], v[200:203], a[4:7], 0
    ds_read_b64_tr_b16 v[198:199], v16 offset:4608
    v_mfma_f32_16x16x32_bf16 v[92:95], v[200:203], a[8:11], 0
    v_mfma_f32_16x16x32_bf16 v[96:99], v[200:203], a[12:15], 0
    s_waitcnt lgkmcnt(2)
    v_mfma_f32_16x16x32_bf16 v[68:71], v[204:207], a[16:19], v[68:71]
    s_waitcnt vmcnt(14)
    s_barrier
    ds_read_b64_tr_b16 v[200:201], v15 offset:8192
    v_mfma_f32_16x16x32_bf16 v[72:75], v[204:207], a[20:23], v[72:75]
    ds_read_b64_tr_b16 v[202:203], v15 offset:8704
    ds_read_b128 a[48:51], v8 offset:24576
    s_add_u32 m0, s78, 0
    s_add_u32 s34, s76, 9216
    buffer_load_dwordx4 v17, s[52:55], s34 offen sc1 lds
    v_mfma_f32_16x16x32_bf16 v[76:79], v[204:207], a[24:27], v[76:79]
    ds_read_b128 a[52:55], v8 offset:25600
    ds_read_b128 a[56:59], v8 offset:26624
    s_add_u32 m0, s78, 1024
    s_add_u32 s34, s77, 9216
    buffer_load_dwordx4 v17, s[52:55], s34 offen sc1 lds
    v_mfma_f32_16x16x32_bf16 v[80:83], v[204:207], a[28:31], v[80:83]
    ds_read_b128 a[60:63], v8 offset:27648
    s_waitcnt lgkmcnt(6)
    v_mfma_f32_16x16x32_bf16 v[84:87], v[196:199], a[16:19], v[84:87]
    ds_read_b64_tr_b16 v[204:205], v16 offset:8192
    ds_read_b64_tr_b16 v[206:207], v16 offset:8704
    v_mfma_f32_16x16x32_bf16 v[88:91], v[196:199], a[20:23], v[88:91]
    ds_read_b128 a[64:67], v8 offset:32768
    s_add_u32 m0, s78, 8192
    s_add_u32 s34, s76, 10240
    buffer_load_dwordx4 v17, s[52:55], s34 offen sc1 lds
    v_mfma_f32_16x16x32_bf16 v[92:95], v[196:199], a[24:27], v[92:95]
    ds_read_b128 a[68:71], v8 offset:33792
    ds_read_b128 a[72:75], v8 offset:34816
    v_mfma_f32_16x16x32_bf16 v[96:99], v[196:199], a[28:31], v[96:99]
    s_add_u32 m0, s78, 9216
    s_add_u32 s34, s77, 10240
    buffer_load_dwordx4 v17, s[52:55], s34 offen sc1 lds
    ds_read_b128 a[76:79], v8 offset:35840
    s_waitcnt lgkmcnt(10)
    v_mfma_f32_16x16x32_bf16 v[68:71], v[200:203], a[32:35], v[68:71]
    ds_read_b64_tr_b16 v[196:197], v15 offset:12288
    ds_read_b64_tr_b16 v[198:199], v15 offset:12800
    v_mfma_f32_16x16x32_bf16 v[72:75], v[200:203], a[36:39], v[72:75]
    ds_read_b128 a[80:83], v8 offset:40960
    s_add_u32 m0, s78, 16384
    s_add_u32 s34, s76, 11264
    buffer_load_dwordx4 v17, s[52:55], s34 offen sc1 lds
    v_mfma_f32_16x16x32_bf16 v[76:79], v[200:203], a[40:43], v[76:79]
    ds_read_b128 a[84:87], v8 offset:41984
    ds_read_b128 a[88:91], v8 offset:43008
    v_mfma_f32_16x16x32_bf16 v[80:83], v[200:203], a[44:47], v[80:83]
    s_add_u32 m0, s78, 17408
    s_add_u32 s34, s77, 11264
    buffer_load_dwordx4 v17, s[52:55], s34 offen sc1 lds
    ds_read_b128 a[92:95], v8 offset:44032
    s_waitcnt lgkmcnt(10)
    v_mfma_f32_16x16x32_bf16 v[84:87], v[204:207], a[32:35], v[84:87]
    ds_read_b64_tr_b16 v[200:201], v16 offset:12288
    v_mfma_f32_16x16x32_bf16 v[88:91], v[204:207], a[36:39], v[88:91]
    ds_read_b64_tr_b16 v[202:203], v16 offset:12800
    v_mfma_f32_16x16x32_bf16 v[92:95], v[204:207], a[40:43], v[92:95]
    v_mfma_f32_16x16x32_bf16 v[96:99], v[204:207], a[44:47], v[96:99]
    s_waitcnt lgkmcnt(6)
    v_mfma_f32_16x16x32_bf16 v[68:71], v[196:199], a[48:51], v[68:71]
    s_waitcnt vmcnt(14)
    s_waitcnt lgkmcnt(2)
    s_barrier
    v_mfma_f32_16x16x32_bf16 v[72:75], v[196:199], a[52:55], v[72:75]
    ds_read_b64_tr_b16 v[204:205], v15 offset:16384
    ds_read_b64_tr_b16 v[206:207], v15 offset:16896
    ds_read_b128 a[96:99], v8 offset:49152
    v_mfma_f32_16x16x32_bf16 v[76:79], v[196:199], a[56:59], v[76:79]
    s_add_u32 m0, s78, 24576
    s_add_u32 s34, s76, 12288
    buffer_load_dwordx4 v17, s[52:55], s34 offen sc1 lds
    ds_read_b128 a[100:103], v8 offset:50176
    ds_read_b128 a[104:107], v8 offset:51200
    v_mfma_f32_16x16x32_bf16 v[80:83], v[196:199], a[60:63], v[80:83]
    s_add_u32 m0, s78, 25600
    s_add_u32 s34, s77, 12288
    buffer_load_dwordx4 v17, s[52:55], s34 offen sc1 lds
    ds_read_b128 a[108:111], v8 offset:52224
    s_waitcnt lgkmcnt(6)
    v_mfma_f32_16x16x32_bf16 v[84:87], v[200:203], a[48:51], v[84:87]
    ds_read_b64_tr_b16 v[196:197], v16 offset:16384
    ds_read_b64_tr_b16 v[198:199], v16 offset:16896
    v_mfma_f32_16x16x32_bf16 v[88:91], v[200:203], a[52:55], v[88:91]
    ds_read_b128 a[112:115], v8 offset:57344
    s_add_u32 m0, s78, 32768
    s_add_u32 s34, s76, 13312
    buffer_load_dwordx4 v17, s[52:55], s34 offen sc1 lds
    v_mfma_f32_16x16x32_bf16 v[92:95], v[200:203], a[56:59], v[92:95]
    ds_read_b128 a[116:119], v8 offset:58368
    ds_read_b128 a[120:123], v8 offset:59392
    v_mfma_f32_16x16x32_bf16 v[96:99], v[200:203], a[60:63], v[96:99]
    s_add_u32 m0, s78, 33792
    s_add_u32 s34, s77, 13312
    buffer_load_dwordx4 v17, s[52:55], s34 offen sc1 lds
    ds_read_b128 a[124:127], v8 offset:60416
    s_waitcnt lgkmcnt(10)
    v_mfma_f32_16x16x32_bf16 v[68:71], v[204:207], a[64:67], v[68:71]
    ds_read_b64_tr_b16 v[200:201], v15 offset:20480
    ds_read_b64_tr_b16 v[202:203], v15 offset:20992
    v_mfma_f32_16x16x32_bf16 v[72:75], v[204:207], a[68:71], v[72:75]
    ds_read_b128 a[128:131], v49 offset:0
    s_add_u32 m0, s78, 40960
    s_add_u32 s34, s76, 14336
    buffer_load_dwordx4 v17, s[52:55], s34 offen sc1 lds
    v_mfma_f32_16x16x32_bf16 v[76:79], v[204:207], a[72:75], v[76:79]
    ds_read_b128 a[132:135], v49 offset:1024
    ds_read_b128 a[136:139], v49 offset:2048
    v_mfma_f32_16x16x32_bf16 v[80:83], v[204:207], a[76:79], v[80:83]
    s_add_u32 m0, s78, 41984
    s_add_u32 s34, s77, 14336
    buffer_load_dwordx4 v17, s[52:55], s34 offen sc1 lds
    ds_read_b128 a[140:143], v49 offset:3072
    s_waitcnt lgkmcnt(10)
    v_mfma_f32_16x16x32_bf16 v[84:87], v[196:199], a[64:67], v[84:87]
    ds_read_b64_tr_b16 v[204:205], v16 offset:20480
    v_mfma_f32_16x16x32_bf16 v[88:91], v[196:199], a[68:71], v[88:91]
    ds_read_b64_tr_b16 v[206:207], v16 offset:20992
    v_mfma_f32_16x16x32_bf16 v[92:95], v[196:199], a[72:75], v[92:95]
    v_mfma_f32_16x16x32_bf16 v[96:99], v[196:199], a[76:79], v[96:99]
    s_waitcnt lgkmcnt(6)
    v_mfma_f32_16x16x32_bf16 v[68:71], v[200:203], a[80:83], v[68:71]
    ds_read_b64_tr_b16 v[196:197], v15 offset:24576
    v_mfma_f32_16x16x32_bf16 v[72:75], v[200:203], a[84:87], v[72:75]
    ds_read_b64_tr_b16 v[198:199], v15 offset:25088
    v_mfma_f32_16x16x32_bf16 v[76:79], v[200:203], a[88:91], v[76:79]
    v_mfma_f32_16x16x32_bf16 v[80:83], v[200:203], a[92:95], v[80:83]
    s_waitcnt lgkmcnt(2)
    v_mfma_f32_16x16x32_bf16 v[84:87], v[204:207], a[80:83], v[84:87]
    s_barrier
    v_mfma_f32_16x16x32_bf16 v[88:91], v[204:207], a[84:87], v[88:91]
    ds_read_b64_tr_b16 v[200:201], v16 offset:24576
    ds_read_b64_tr_b16 v[202:203], v16 offset:25088
    v_mfma_f32_16x16x32_bf16 v[92:95], v[204:207], a[88:91], v[92:95]
    s_add_u32 m0, s78, 49152
    s_add_u32 s34, s76, 15360
    buffer_load_dwordx4 v17, s[52:55], s34 offen sc1 lds
    s_add_u32 m0, s78, 50176
    s_add_u32 s34, s77, 15360
    buffer_load_dwordx4 v17, s[52:55], s34 offen sc1 lds
    v_mfma_f32_16x16x32_bf16 v[96:99], v[204:207], a[92:95], v[96:99]
    s_waitcnt lgkmcnt(2)
    v_mfma_f32_16x16x32_bf16 v[68:71], v[196:199], a[96:99], v[68:71]
    ds_read_b64_tr_b16 v[204:205], v15 offset:28672
    v_mfma_f32_16x16x32_bf16 v[72:75], v[196:199], a[100:103], v[72:75]
    ds_read_b64_tr_b16 v[206:207], v15 offset:29184
    v_mfma_f32_16x16x32_bf16 v[76:79], v[196:199], a[104:107], v[76:79]
    s_add_u32 m0, s78, 57344
    s_add_u32 s34, s76, 16384
    buffer_load_dwordx4 v17, s[52:55], s34 offen sc1 lds
    v_mfma_f32_16x16x32_bf16 v[80:83], v[196:199], a[108:111], v[80:83]
    s_waitcnt lgkmcnt(2)
    v_mfma_f32_16x16x32_bf16 v[84:87], v[200:203], a[96:99], v[84:87]
    ds_read_b64_tr_b16 v[196:197], v16 offset:28672
    v_mfma_f32_16x16x32_bf16 v[88:91], v[200:203], a[100:103], v[88:91]
    ds_read_b64_tr_b16 v[198:199], v16 offset:29184
    v_mfma_f32_16x16x32_bf16 v[92:95], v[200:203], a[104:107], v[92:95]
    s_add_u32 m0, s78, 58368
    s_add_u32 s34, s77, 16384
    buffer_load_dwordx4 v17, s[52:55], s34 offen sc1 lds
    v_mfma_f32_16x16x32_bf16 v[96:99], v[200:203], a[108:111], v[96:99]
    s_waitcnt lgkmcnt(2)
    v_mfma_f32_16x16x32_bf16 v[68:71], v[204:207], a[112:115], v[68:71]
    ds_read_b64_tr_b16 v[200:201], v15 offset:32768
    v_mfma_f32_16x16x32_bf16 v[72:75], v[204:207], a[116:119], v[72:75]
    ds_read_b64_tr_b16 v[202:203], v15 offset:33280
    v_mfma_f32_16x16x32_bf16 v[76:79], v[204:207], a[120:123], v[76:79]
    s_add_u32 m0, s78, 65536
    s_add_u32 s34, s76, 17408
    buffer_load_dwordx4 v17, s[52:55], s34 offen sc1 lds
    v_mfma_f32_16x16x32_bf16 v[80:83], v[204:207], a[124:127], v[80:83]
    s_waitcnt lgkmcnt(2)
    v_mfma_f32_16x16x32_bf16 v[84:87], v[196:199], a[112:115], v[84:87]
    ds_read_b64_tr_b16 v[204:205], v16 offset:32768
    v_mfma_f32_16x16x32_bf16 v[88:91], v[196:199], a[116:119], v[88:91]
    ds_read_b64_tr_b16 v[206:207], v16 offset:33280
    v_mfma_f32_16x16x32_bf16 v[92:95], v[196:199], a[120:123], v[92:95]
    s_add_u32 m0, s78, 66560
    s_add_u32 s34, s77, 17408
    buffer_load_dwordx4 v17, s[52:55], s34 offen sc1 lds
    v_mfma_f32_16x16x32_bf16 v[96:99], v[196:199], a[124:127], v[96:99]
    s_waitcnt lgkmcnt(2)
    v_mfma_f32_16x16x32_bf16 v[68:71], v[200:203], a[128:131], v[68:71]
    s_waitcnt vmcnt(12)
    v_mfma_f32_16x16x32_bf16 v[72:75], v[200:203], a[132:135], v[72:75]
    s_barrier
    v_add_u32 v15, 0x9000, v15
    v_mfma_f32_16x16x32_bf16 v[76:79], v[200:203], a[136:139], v[76:79]
    v_add_u32 v16, 0x9000, v16
    ds_read_b64_tr_b16 v[196:197], v15 offset:0
    v_mfma_f32_16x16x32_bf16 v[80:83], v[200:203], a[140:143], v[80:83]
    ds_read_b64_tr_b16 v[198:199], v15 offset:512
    s_waitcnt lgkmcnt(2)
    v_mfma_f32_16x16x32_bf16 v[84:87], v[204:207], a[128:131], v[84:87]
    ds_read_b64_tr_b16 v[200:201], v16 offset:0
    v_mfma_f32_16x16x32_bf16 v[88:91], v[204:207], a[132:135], v[88:91]
    ds_read_b64_tr_b16 v[202:203], v16 offset:512
    v_mfma_f32_16x16x32_bf16 v[92:95], v[204:207], a[136:139], v[92:95]
    v_mfma_f32_16x16x32_bf16 v[96:99], v[204:207], a[140:143], v[96:99]
    s_waitcnt lgkmcnt(2)
    v_mfma_f32_16x16x32_bf16 v[100:103], v[196:199], a[0:3], 0
    ds_read_b64_tr_b16 v[204:205], v15 offset:4096
    ds_read_b64_tr_b16 v[206:207], v15 offset:4608
    v_mfma_f32_16x16x32_bf16 v[104:107], v[196:199], a[4:7], 0
    s_add_u32 s40, s38, 0
    s_and_b32 s40, s40, 3
    s_lshl_b32 s40, s40, 6
    ds_read_b128 a[144:147], v8 offset:0
    v_mfma_f32_16x16x32_bf16 v[108:111], v[196:199], a[8:11], 0
    s_add_u32 s40, s40, s36
    s_lshl_b32 s40, s40, 1
    s_add_u32 s40, s40, 2654208
    ds_read_b128 a[148:151], v8 offset:1024
    v_mfma_f32_16x16x32_bf16 v[112:115], v[196:199], a[12:15], 0
    s_add_u32 m0, s41, 0
    s_waitcnt lgkmcnt(4)
    v_mfma_f32_16x16x32_bf16 v[116:119], v[200:203], a[0:3], 0
    ds_read_b64_tr_b16 v[196:197], v16 offset:4096
    ds_read_b64_tr_b16 v[198:199], v16 offset:4608
    v_mfma_f32_16x16x32_bf16 v[120:123], v[200:203], a[4:7], 0
    ds_read_b128 a[152:155], v8 offset:2048
    buffer_load_dwordx4 v50, s[92:95], s40 offen offset:0  lds
    v_mfma_f32_16x16x32_bf16 v[124:127], v[200:203], a[8:11], 0
    ds_read_b128 a[156:159], v8 offset:3072
    buffer_load_dwordx4 v51, s[92:95], s40 offen offset:1024  lds
    v_mfma_f32_16x16x32_bf16 v[128:131], v[200:203], a[12:15], 0
    s_waitcnt lgkmcnt(6)
    v_mfma_f32_16x16x32_bf16 v[100:103], v[204:207], a[16:19], v[100:103]
    ds_read_b64_tr_b16 v[200:201], v15 offset:8192
    ds_read_b64_tr_b16 v[202:203], v15 offset:8704
    v_mfma_f32_16x16x32_bf16 v[104:107], v[204:207], a[20:23], v[104:107]
    ds_read_b128 a[160:163], v8 offset:8192
    buffer_load_dwordx4 v52, s[92:95], s40 offen offset:2048  lds
    v_mfma_f32_16x16x32_bf16 v[108:111], v[204:207], a[24:27], v[108:111]
    ds_read_b128 a[164:167], v8 offset:9216
    buffer_load_dwordx4 v53, s[92:95], s40 offen offset:3072  lds
    v_mfma_f32_16x16x32_bf16 v[112:115], v[204:207], a[28:31], v[112:115]
    s_waitcnt lgkmcnt(6)
    v_mfma_f32_16x16x32_bf16 v[116:119], v[196:199], a[16:19], v[116:119]
    ds_read_b64_tr_b16 v[204:205], v16 offset:8192
    ds_read_b64_tr_b16 v[206:207], v16 offset:8704
    v_mfma_f32_16x16x32_bf16 v[120:123], v[196:199], a[20:23], v[120:123]
    s_add_u32 m0, s41, 4096
    ds_read_b128 a[168:171], v8 offset:10240
    v_mfma_f32_16x16x32_bf16 v[124:127], v[196:199], a[24:27], v[124:127]
    buffer_load_dwordx4 v54, s[92:95], s40 offen offset:0  lds
    ds_read_b128 a[172:175], v8 offset:11264
    v_mfma_f32_16x16x32_bf16 v[128:131], v[196:199], a[28:31], v[128:131]
    buffer_load_dwordx4 v55, s[92:95], s40 offen offset:1024  lds
    s_waitcnt lgkmcnt(6)
    v_mfma_f32_16x16x32_bf16 v[100:103], v[200:203], a[32:35], v[100:103]
    ds_read_b64_tr_b16 v[196:197], v15 offset:12288
    ds_read_b64_tr_b16 v[198:199], v15 offset:12800
    v_mfma_f32_16x16x32_bf16 v[104:107], v[200:203], a[36:39], v[104:107]
    ds_read_b128 a[176:179], v8 offset:16384
    buffer_load_dwordx4 v56, s[92:95], s40 offen offset:2048  lds
    v_mfma_f32_16x16x32_bf16 v[108:111], v[200:203], a[40:43], v[108:111]
    ds_read_b128 a[180:183], v8 offset:17408
    buffer_load_dwordx4 v57, s[92:95], s40 offen offset:3072  lds
    v_mfma_f32_16x16x32_bf16 v[112:115], v[200:203], a[44:47], v[112:115]
    s_waitcnt lgkmcnt(6)
    v_mfma_f32_16x16x32_bf16 v[116:119], v[204:207], a[32:35], v[116:119]
    ds_read_b64_tr_b16 v[200:201], v16 offset:12288
    ds_read_b64_tr_b16 v[202:203], v16 offset:12800
    v_mfma_f32_16x16x32_bf16 v[120:123], v[204:207], a[36:39], v[120:123]
    ds_read_b128 a[184:187], v8 offset:18432
    s_add_u32 m0, s41, 8192
    v_mfma_f32_16x16x32_bf16 v[124:127], v[204:207], a[40:43], v[124:127]
    ds_read_b128 a[188:191], v8 offset:19456
    buffer_load_dwordx4 v58, s[92:95], s40 offen offset:0  lds
    v_mfma_f32_16x16x32_bf16 v[128:131], v[204:207], a[44:47], v[128:131]
    s_waitcnt lgkmcnt(6)
    v_mfma_f32_16x16x32_bf16 v[100:103], v[196:199], a[48:51], v[100:103]
    s_waitcnt vmcnt(9)
    s_barrier
    v_mfma_f32_16x16x32_bf16 v[104:107], v[196:199], a[52:55], v[104:107]
    ds_read_b64_tr_b16 v[204:205], v15 offset:16384
    ds_read_b64_tr_b16 v[206:207], v15 offset:16896
    v_mfma_f32_16x16x32_bf16 v[108:111], v[196:199], a[56:59], v[108:111]
    ds_read_b128 a[192:195], v8 offset:24576
    ds_read_b128 a[196:199], v8 offset:25600
    v_mfma_f32_16x16x32_bf16 v[112:115], v[196:199], a[60:63], v[112:115]
    ds_read_b128 a[200:203], v8 offset:26624
    ds_read_b128 a[204:207], v8 offset:27648
    s_waitcnt lgkmcnt(8)
    v_mfma_f32_16x16x32_bf16 v[116:119], v[200:203], a[48:51], v[116:119]
    ds_read_b64_tr_b16 v[196:197], v16 offset:16384
    ds_read_b64_tr_b16 v[198:199], v16 offset:16896
    v_mfma_f32_16x16x32_bf16 v[120:123], v[200:203], a[52:55], v[120:123]
    ds_read_b128 a[208:211], v8 offset:32768
    ds_read_b128 a[212:215], v8 offset:33792
    v_mfma_f32_16x16x32_bf16 v[124:127], v[200:203], a[56:59], v[124:127]
    ds_read_b128 a[216:219], v8 offset:34816
    ds_read_b128 a[220:223], v8 offset:35840
    v_mfma_f32_16x16x32_bf16 v[128:131], v[200:203], a[60:63], v[128:131]
    s_waitcnt lgkmcnt(10)
    v_mfma_f32_16x16x32_bf16 v[100:103], v[204:207], a[64:67], v[100:103]
    ds_read_b64_tr_b16 v[200:201], v15 offset:20480
    ds_read_b64_tr_b16 v[202:203], v15 offset:20992
    v_mfma_f32_16x16x32_bf16 v[104:107], v[204:207], a[68:71], v[104:107]
    ds_read_b128 a[224:227], v8 offset:40960
    ds_read_b128 a[228:231], v8 offset:41984
    v_mfma_f32_16x16x32_bf16 v[108:111], v[204:207], a[72:75], v[108:111]
    ds_read_b128 a[232:235], v8 offset:43008
    ds_read_b128 a[236:239], v8 offset:44032
    v_mfma_f32_16x16x32_bf16 v[112:115], v[204:207], a[76:79], v[112:115]
    s_waitcnt lgkmcnt(10)
    v_mfma_f32_16x16x32_bf16 v[116:119], v[196:199], a[64:67], v[116:119]
    ds_read_b64_tr_b16 v[204:205], v16 offset:20480
    ds_read_b64_tr_b16 v[206:207], v16 offset:20992
    v_mfma_f32_16x16x32_bf16 v[120:123], v[196:199], a[68:71], v[120:123]
    ds_read_b128 a[240:243], v8 offset:49152
    ds_read_b128 a[244:247], v8 offset:50176
    v_mfma_f32_16x16x32_bf16 v[124:127], v[196:199], a[72:75], v[124:127]
    ds_read_b128 a[248:251], v8 offset:51200
    ds_read_b128 a[252:255], v8 offset:52224
    v_mfma_f32_16x16x32_bf16 v[128:131], v[196:199], a[76:79], v[128:131]
    s_waitcnt lgkmcnt(10)
    v_mfma_f32_16x16x32_bf16 v[100:103], v[200:203], a[80:83], v[100:103]
    ds_read_b64_tr_b16 v[196:197], v15 offset:24576
    ds_read_b64_tr_b16 v[198:199], v15 offset:25088
    v_mfma_f32_16x16x32_bf16 v[104:107], v[200:203], a[84:87], v[104:107]
    ds_read_b128 v[24:27], v8 offset:57344
    ds_read_b128 v[28:31], v8 offset:58368
    v_mfma_f32_16x16x32_bf16 v[108:111], v[200:203], a[88:91], v[108:111]
    ds_read_b128 v[32:35], v8 offset:59392
    ds_read_b128 v[36:39], v8 offset:60416
    v_mfma_f32_16x16x32_bf16 v[112:115], v[200:203], a[92:95], v[112:115]
    s_waitcnt lgkmcnt(10)
    v_mfma_f32_16x16x32_bf16 v[116:119], v[204:207], a[80:83], v[116:119]
    ds_read_b64_tr_b16 v[200:201], v16 offset:24576
    ds_read_b64_tr_b16 v[202:203], v16 offset:25088
    v_mfma_f32_16x16x32_bf16 v[120:123], v[204:207], a[84:87], v[120:123]
    ds_read_b128 v[40:43], v49 offset:0
    ds_read_b128 v[44:47], v49 offset:1024
    v_mfma_f32_16x16x32_bf16 v[124:127], v[204:207], a[88:91], v[124:127]
    ds_read_b128 v[60:63], v49 offset:2048
    ds_read_b128 v[64:67], v49 offset:3072
    v_mfma_f32_16x16x32_bf16 v[128:131], v[204:207], a[92:95], v[128:131]
    s_waitcnt lgkmcnt(10)
    v_mfma_f32_16x16x32_bf16 v[100:103], v[196:199], a[96:99], v[100:103]
    ds_read_b64_tr_b16 v[204:205], v15 offset:28672
    ds_read_b64_tr_b16 v[206:207], v15 offset:29184
    v_mfma_f32_16x16x32_bf16 v[104:107], v[196:199], a[100:103], v[104:107]
    v_pk_add_f32 v[180:181], v[180:181], v[182:183]
    v_mfma_f32_16x16x32_bf16 v[108:111], v[196:199], a[104:107], v[108:111]
    v_pk_add_f32 v[180:181], v[180:181], v[184:185]
    v_mfma_f32_16x16x32_bf16 v[112:115], v[196:199], a[108:111], v[112:115]
    s_waitcnt lgkmcnt(6)
    v_mfma_f32_16x16x32_bf16 v[116:119], v[200:203], a[96:99], v[116:119]
    ds_read_b64_tr_b16 v[196:197], v16 offset:28672
    v_mfma_f32_16x16x32_bf16 v[120:123], v[200:203], a[100:103], v[120:123]
    ds_read_b64_tr_b16 v[198:199], v16 offset:29184
    v_mfma_f32_16x16x32_bf16 v[124:127], v[200:203], a[104:107], v[124:127]
    v_pk_add_f32 v[180:181], v[180:181], v[186:187]
    v_mfma_f32_16x16x32_bf16 v[128:131], v[200:203], a[108:111], v[128:131]
    v_pk_add_f32 v[180:181], v[180:181], v[188:189]
    s_waitcnt lgkmcnt(2)
    v_mfma_f32_16x16x32_bf16 v[100:103], v[204:207], a[112:115], v[100:103]
    ds_read_b64_tr_b16 v[200:201], v15 offset:32768
    ds_read_b64_tr_b16 v[202:203], v15 offset:33280
    v_mfma_f32_16x16x32_bf16 v[104:107], v[204:207], a[116:119], v[104:107]
    v_pk_add_f32 v[180:181], v[180:181], v[190:191]
    v_pk_add_f32 v[180:181], v[180:181], v[192:193]
    v_mfma_f32_16x16x32_bf16 v[108:111], v[204:207], a[120:123], v[108:111]
    v_pk_add_f32 v[180:181], v[180:181], v[194:195]
    v_mfma_f32_16x16x32_bf16 v[112:115], v[204:207], a[124:127], v[112:115]
    s_waitcnt lgkmcnt(2)
    v_mfma_f32_16x16x32_bf16 v[116:119], v[196:199], a[112:115], v[116:119]
    ds_read_b64_tr_b16 v[204:205], v16 offset:32768
    v_mfma_f32_16x16x32_bf16 v[120:123], v[196:199], a[116:119], v[120:123]
    ds_read_b64_tr_b16 v[206:207], v16 offset:33280
    v_mfma_f32_16x16x32_bf16 v[124:127], v[196:199], a[120:123], v[124:127]
    s_mov_b32 s32, 0x3ae38e39
    v_mul_f32 v180, s32, -v180
    v_mul_f32 v182, v180, v180
    v_fma_f32 v181, v181, s32, -v182
    v_mfma_f32_16x16x32_bf16 v[128:131], v[196:199], a[124:127], v[128:131]
    v_max_f32 v181, 0, v181
    s_waitcnt lgkmcnt(2)
    v_mfma_f32_16x16x32_bf16 v[100:103], v[200:203], a[128:131], v[100:103]
    s_waitcnt vmcnt(0)
    v_mfma_f32_16x16x32_bf16 v[104:107], v[200:203], a[132:135], v[104:107]
    s_barrier
    v_add_u32 v15, 0xffff7000, v15
    v_mfma_f32_16x16x32_bf16 v[108:111], v[200:203], a[136:139], v[108:111]
    v_add_u32 v16, 0xffff7000, v16
    ds_read_b64_tr_b16 v[196:197], v15 offset:0
    v_mfma_f32_16x16x32_bf16 v[112:115], v[200:203], a[140:143], v[112:115]
    ds_read_b64_tr_b16 v[198:199], v15 offset:512
    s_waitcnt lgkmcnt(2)
    v_mfma_f32_16x16x32_bf16 v[116:119], v[204:207], a[128:131], v[116:119]
    ds_read_b64_tr_b16 v[200:201], v16 offset:0
    v_mfma_f32_16x16x32_bf16 v[120:123], v[204:207], a[132:135], v[120:123]
    ds_read_b64_tr_b16 v[202:203], v16 offset:512
    v_mfma_f32_16x16x32_bf16 v[124:127], v[204:207], a[136:139], v[124:127]
    v_mfma_f32_16x16x32_bf16 v[128:131], v[204:207], a[140:143], v[128:131]
    s_waitcnt lgkmcnt(2)
    v_mfma_f32_16x16x32_bf16 v[68:71], v[196:199], a[144:147], v[68:71]
    ds_read_b64_tr_b16 v[204:205], v15 offset:4096
    ds_read_b64_tr_b16 v[206:207], v15 offset:4608
    v_mfma_f32_16x16x32_bf16 v[72:75], v[196:199], a[148:151], v[72:75]
    s_add_u32 s40, s38, 1
    s_and_b32 s40, s40, 3
    s_lshl_b32 s40, s40, 6
    s_add_u32 s40, s40, s36
    s_lshl_b32 s40, s40, 1
    s_add_u32 s40, s40, 2654208
    v_mfma_f32_16x16x32_bf16 v[76:79], v[196:199], a[152:155], v[76:79]
    s_add_u32 m0, s41, 36864
    v_add_f32 v181, 0x3727c5ac, v181
    v_mfma_f32_16x16x32_bf16 v[80:83], v[196:199], a[156:159], v[80:83]
    s_waitcnt lgkmcnt(2)
    v_mfma_f32_16x16x32_bf16 v[84:87], v[200:203], a[144:147], v[84:87]
    ds_read_b64_tr_b16 v[196:197], v16 offset:4096
    ds_read_b64_tr_b16 v[198:199], v16 offset:4608
    v_mfma_f32_16x16x32_bf16 v[88:91], v[200:203], a[148:151], v[88:91]
    buffer_load_dwordx4 v50, s[92:95], s40 offen offset:0  lds
    buffer_load_dwordx4 v51, s[92:95], s40 offen offset:1024  lds
    v_mfma_f32_16x16x32_bf16 v[92:95], v[200:203], a[152:155], v[92:95]
    buffer_load_dwordx4 v52, s[92:95], s40 offen offset:2048  lds
    v_sqrt_f32 v182, v181
    v_mfma_f32_16x16x32_bf16 v[96:99], v[200:203], a[156:159], v[96:99]
    s_waitcnt lgkmcnt(2)
    v_mfma_f32_16x16x32_bf16 v[68:71], v[204:207], a[160:163], v[68:71]
    ds_read_b64_tr_b16 v[200:201], v15 offset:8192
    ds_read_b64_tr_b16 v[202:203], v15 offset:8704
    v_mfma_f32_16x16x32_bf16 v[72:75], v[204:207], a[164:167], v[72:75]
    buffer_load_dwordx4 v53, s[92:95], s40 offen offset:3072  lds
    s_add_u32 m0, s41, 40960
    v_mfma_f32_16x16x32_bf16 v[76:79], v[204:207], a[168:171], v[76:79]
    buffer_load_dwordx4 v54, s[92:95], s40 offen offset:0  lds
    v_rcp_f32 v183, v181
    v_mfma_f32_16x16x32_bf16 v[80:83], v[204:207], a[172:175], v[80:83]
    s_waitcnt lgkmcnt(2)
    v_mfma_f32_16x16x32_bf16 v[84:87], v[196:199], a[160:163], v[84:87]
    ds_read_b64_tr_b16 v[204:205], v16 offset:8192
    ds_read_b64_tr_b16 v[206:207], v16 offset:8704
    v_mfma_f32_16x16x32_bf16 v[88:91], v[196:199], a[164:167], v[88:91]
    buffer_load_dwordx4 v55, s[92:95], s40 offen offset:1024  lds
    buffer_load_dwordx4 v56, s[92:95], s40 offen offset:2048  lds
    v_mfma_f32_16x16x32_bf16 v[92:95], v[196:199], a[168:171], v[92:95]
    buffer_load_dwordx4 v57, s[92:95], s40 offen offset:3072  lds
    v_mfma_f32_16x16x32_bf16 v[96:99], v[196:199], a[172:175], v[96:99]
    s_waitcnt lgkmcnt(2)
    v_mfma_f32_16x16x32_bf16 v[68:71], v[200:203], a[176:179], v[68:71]
    ds_read_b64_tr_b16 v[196:197], v15 offset:12288
    ds_read_b64_tr_b16 v[198:199], v15 offset:12800
    v_mfma_f32_16x16x32_bf16 v[72:75], v[200:203], a[180:183], v[72:75]
    s_add_u32 m0, s41, 45056
    s_nop 0
    buffer_load_dwordx4 v58, s[92:95], s40 offen offset:0  lds
    v_mfma_f32_16x16x32_bf16 v[76:79], v[200:203], a[184:187], v[76:79]
    v_cvt_pk_bf16_f32 v22, v180, v180
    v_mfma_f32_16x16x32_bf16 v[80:83], v[200:203], a[188:191], v[80:83]
    s_waitcnt lgkmcnt(2)
    v_mfma_f32_16x16x32_bf16 v[84:87], v[204:207], a[176:179], v[84:87]
    ds_read_b64_tr_b16 v[200:201], v16 offset:12288
    ds_read_b64_tr_b16 v[202:203], v16 offset:12800
    v_mfma_f32_16x16x32_bf16 v[88:91], v[204:207], a[180:183], v[88:91]
    s_add_u32 s40, s38, 2
    s_and_b32 s40, s40, 3
    s_lshl_b32 s40, s40, 6
    s_add_u32 s40, s40, s36
    s_lshl_b32 s40, s40, 1
    s_add_u32 s40, s40, 0
    v_mfma_f32_16x16x32_bf16 v[92:95], v[204:207], a[184:187], v[92:95]
    v_and_b32 v185, 0xffff0000, v22
    v_mfma_f32_16x16x32_bf16 v[96:99], v[204:207], a[188:191], v[96:99]
    s_waitcnt lgkmcnt(2)
    v_mfma_f32_16x16x32_bf16 v[68:71], v[196:199], a[192:195], v[68:71]
    ds_read_b64_tr_b16 v[204:205], v15 offset:16384
    v_mfma_f32_16x16x32_bf16 v[72:75], v[196:199], a[196:199], v[72:75]
    ds_read_b64_tr_b16 v[206:207], v15 offset:16896
    v_mfma_f32_16x16x32_bf16 v[76:79], v[196:199], a[200:203], v[76:79]
    s_add_u32 m0, s41, 73728
    v_mfma_f32_16x16x32_bf16 v[80:83], v[196:199], a[204:207], v[80:83]
    s_waitcnt lgkmcnt(2)
    v_mfma_f32_16x16x32_bf16 v[84:87], v[200:203], a[192:195], v[84:87]
    ds_read_b64_tr_b16 v[196:197], v16 offset:16384
    v_mfma_f32_16x16x32_bf16 v[88:91], v[200:203], a[196:199], v[88:91]
    ds_read_b64_tr_b16 v[198:199], v16 offset:16896
    v_mfma_f32_16x16x32_bf16 v[92:95], v[200:203], a[200:203], v[92:95]
    buffer_load_dwordx4 v50, s[92:95], s40 offen offset:0  lds
    v_mfma_f32_16x16x32_bf16 v[96:99], v[200:203], a[204:207], v[96:99]
    v_sub_f32 v185, v180, v185
    s_waitcnt lgkmcnt(2)
    v_mfma_f32_16x16x32_bf16 v[68:71], v[204:207], a[208:211], v[68:71]
    ds_read_b64_tr_b16 v[200:201], v15 offset:20480
    v_mfma_f32_16x16x32_bf16 v[72:75], v[204:207], a[212:215], v[72:75]
    ds_read_b64_tr_b16 v[202:203], v15 offset:20992
    v_mfma_f32_16x16x32_bf16 v[76:79], v[204:207], a[216:219], v[76:79]
    buffer_load_dwordx4 v51, s[92:95], s40 offen offset:1024  lds
    v_mfma_f32_16x16x32_bf16 v[80:83], v[204:207], a[220:223], v[80:83]
    v_cvt_pk_bf16_f32 v23, v185, v182
    s_waitcnt lgkmcnt(2)
    v_mfma_f32_16x16x32_bf16 v[84:87], v[196:199], a[208:211], v[84:87]
    ds_read_b64_tr_b16 v[204:205], v16 offset:20480
    v_mfma_f32_16x16x32_bf16 v[88:91], v[196:199], a[212:215], v[88:91]
    ds_read_b64_tr_b16 v[206:207], v16 offset:20992
    v_mfma_f32_16x16x32_bf16 v[92:95], v[196:199], a[216:219], v[92:95]
    buffer_load_dwordx4 v52, s[92:95], s40 offen offset:2048  lds
    v_mfma_f32_16x16x32_bf16 v[96:99], v[196:199], a[220:223], v[96:99]
    s_waitcnt lgkmcnt(2)
    v_mfma_f32_16x16x32_bf16 v[68:71], v[200:203], a[224:227], v[68:71]
    ds_read_b64_tr_b16 v[196:197], v15 offset:24576
    v_mfma_f32_16x16x32_bf16 v[72:75], v[200:203], a[228:231], v[72:75]
    ds_read_b64_tr_b16 v[198:199], v15 offset:25088
    v_mfma_f32_16x16x32_bf16 v[76:79], v[200:203], a[232:235], v[76:79]
    buffer_load_dwordx4 v53, s[92:95], s40 offen offset:3072  lds
    v_mfma_f32_16x16x32_bf16 v[80:83], v[200:203], a[236:239], v[80:83]
    s_lshl_b32 s32, s43, 8
    s_add_u32 s32, s32, 152064
    v_lshl_add_u32 v187, v1, 2, s32
    s_waitcnt lgkmcnt(2)
    v_mfma_f32_16x16x32_bf16 v[84:87], v[204:207], a[224:227], v[84:87]
    ds_read_b64_tr_b16 v[200:201], v16 offset:24576
    v_mfma_f32_16x16x32_bf16 v[88:91], v[204:207], a[228:231], v[88:91]
    ds_read_b64_tr_b16 v[202:203], v16 offset:25088
    v_mfma_f32_16x16x32_bf16 v[92:95], v[204:207], a[232:235], v[92:95]
    s_add_u32 m0, s41, 77824
    v_mfma_f32_16x16x32_bf16 v[96:99], v[204:207], a[236:239], v[96:99]
    ds_write_b32 v187, v183
    s_waitcnt lgkmcnt(3)
    v_mfma_f32_16x16x32_bf16 v[68:71], v[196:199], a[240:243], v[68:71]
    ds_read_b64_tr_b16 v[204:205], v15 offset:28672
    v_mfma_f32_16x16x32_bf16 v[72:75], v[196:199], a[244:247], v[72:75]
    ds_read_b64_tr_b16 v[206:207], v15 offset:29184
    v_mfma_f32_16x16x32_bf16 v[76:79], v[196:199], a[248:251], v[76:79]
    buffer_load_dwordx4 v54, s[92:95], s40 offen offset:0  lds
    v_mfma_f32_16x16x32_bf16 v[80:83], v[196:199], a[252:255], v[80:83]
    s_waitcnt lgkmcnt(3)
    v_mfma_f32_16x16x32_bf16 v[84:87], v[200:203], a[240:243], v[84:87]
    ds_read_b64_tr_b16 v[196:197], v16 offset:28672
    v_mfma_f32_16x16x32_bf16 v[88:91], v[200:203], a[244:247], v[88:91]
    ds_read_b64_tr_b16 v[198:199], v16 offset:29184
    v_mfma_f32_16x16x32_bf16 v[92:95], v[200:203], a[248:251], v[92:95]
    buffer_load_dwordx4 v55, s[92:95], s40 offen offset:1024  lds
    v_mfma_f32_16x16x32_bf16 v[96:99], v[200:203], a[252:255], v[96:99]
    s_mul_i32 s81, s64, 73728
    s_lshl_b32 s32, s43, 15
    s_add_u32 s81, s81, s32
    s_lshl_b32 s33, s42, 12
    s_add_u32 s81, s81, s33
    s_add_u32 s81, s81, 31981568
    s_waitcnt lgkmcnt(2)
    v_mfma_f32_16x16x32_bf16 v[68:71], v[204:207], v[24:27], v[68:71]
    ds_read_b64_tr_b16 v[200:201], v15 offset:32768
    v_mfma_f32_16x16x32_bf16 v[72:75], v[204:207], v[28:31], v[72:75]
    ds_read_b64_tr_b16 v[202:203], v15 offset:33280
    v_mfma_f32_16x16x32_bf16 v[76:79], v[204:207], v[32:35], v[76:79]
    buffer_load_dwordx4 v56, s[92:95], s40 offen offset:2048  lds
    v_mfma_f32_16x16x32_bf16 v[80:83], v[204:207], v[36:39], v[80:83]
    s_xor_b32 s82, s64, 1
    s_mul_i32 s82, s82, 73728
    s_lshl_b32 s32, s43, 15
    s_add_u32 s82, s82, s32
    s_add_u32 s82, s82, 31981568
    s_waitcnt lgkmcnt(2)
    v_mfma_f32_16x16x32_bf16 v[84:87], v[196:199], v[24:27], v[84:87]
    ds_read_b64_tr_b16 v[204:205], v16 offset:32768
    v_mfma_f32_16x16x32_bf16 v[88:91], v[196:199], v[28:31], v[88:91]
    ds_read_b64_tr_b16 v[206:207], v16 offset:33280
    v_mfma_f32_16x16x32_bf16 v[92:95], v[196:199], v[32:35], v[92:95]
    buffer_load_dwordx4 v57, s[92:95], s40 offen offset:3072  lds
    v_mfma_f32_16x16x32_bf16 v[96:99], v[196:199], v[36:39], v[96:99]
    s_waitcnt lgkmcnt(2)
    v_mfma_f32_16x16x32_bf16 v[68:71], v[200:203], v[40:43], v[68:71]
    s_waitcnt vmcnt(8)
    s_barrier
    v_add_u32 v15, 0x9000, v15
    v_mfma_f32_16x16x32_bf16 v[72:75], v[200:203], v[44:47], v[72:75]
    v_add_u32 v16, 0x9000, v16
    ds_read_b64_tr_b16 v[196:197], v15 offset:0
    ds_read_b64_tr_b16 v[198:199], v15 offset:512
    v_mfma_f32_16x16x32_bf16 v[76:79], v[200:203], v[60:63], v[76:79]
    s_add_u32 m0, s41, 81920
    s_add_u32 s32, s38, 0
    s_and_b32 s32, s32, 3
    s_lshl_b32 s32, s32, 6
    s_add_u32 s32, s32, s36
    s_lshl_b32 s32, s32, 3
    v_add_u32 v7, s32, v21
    ds_read_b64 v[208:209], v7 offset:0
    v_mfma_f32_16x16x32_bf16 v[80:83], v[200:203], v[64:67], v[80:83]
    ds_read_b64 v[210:211], v7 offset:128
    s_waitcnt lgkmcnt(4)
    v_mfma_f32_16x16x32_bf16 v[84:87], v[204:207], v[40:43], v[84:87]
    ds_read_b64_tr_b16 v[200:201], v16 offset:0
    v_mfma_f32_16x16x32_bf16 v[88:91], v[204:207], v[44:47], v[88:91]
    ds_read_b64_tr_b16 v[202:203], v16 offset:512
    v_mfma_f32_16x16x32_bf16 v[92:95], v[204:207], v[60:63], v[92:95]
    buffer_load_dwordx4 v58, s[92:95], s40 offen offset:0  lds
    v_mfma_f32_16x16x32_bf16 v[96:99], v[204:207], v[64:67], v[96:99]
    s_waitcnt lgkmcnt(2)
    v_mfma_f32_16x16x4bf16_1k v[68:83], v[208:209], v[22:23], v[68:83]
    s_nop 3
    v_mfma_f32_16x16x4bf16_1k v[84:99], v[210:211], v[22:23], v[84:99]
    v_mfma_f32_16x16x32_bf16 v[100:103], v[196:199], a[144:147], v[100:103]
    ds_read_b64_tr_b16 v[204:205], v15 offset:4096
    ds_read_b64_tr_b16 v[206:207], v15 offset:4608
    v_mfma_f32_16x16x32_bf16 v[104:107], v[196:199], a[148:151], v[104:107]
    s_nop 2
    v_mul_f32 v68, v68, |v68|
    v_mul_f32 v69, v69, |v69|
    v_mfma_f32_16x16x32_bf16 v[108:111], v[196:199], a[152:155], v[108:111]
    s_add_u32 s40, s38, 2
    s_and_b32 s40, s40, 3
    s_lshl_b32 s40, s40, 6
    v_mul_f32 v70, v70, |v70|
    v_mfma_f32_16x16x32_bf16 v[112:115], v[196:199], a[156:159], v[112:115]
    v_mul_f32 v71, v71, |v71|
    v_cvt_pk_bf16_f32 v132, v68, v69
    s_waitcnt lgkmcnt(2)
    v_mfma_f32_16x16x32_bf16 v[116:119], v[200:203], a[144:147], v[116:119]
    ds_read_b64_tr_b16 v[196:197], v16 offset:4096
    ds_read_b64_tr_b16 v[198:199], v16 offset:4608
    v_mfma_f32_16x16x32_bf16 v[120:123], v[200:203], a[148:151], v[120:123]
    v_cvt_pk_bf16_f32 v133, v70, v71
    v_pk_max_i16 v132, v132, 0
    v_mfma_f32_16x16x32_bf16 v[124:127], v[200:203], a[152:155], v[124:127]
    s_add_u32 s40, s40, s36
    s_lshl_b32 s40, s40, 1
    s_add_u32 s40, s40, 2654208
    v_pk_max_i16 v133, v133, 0
    v_mfma_f32_16x16x32_bf16 v[128:131], v[200:203], a[156:159], v[128:131]
    v_mul_f32 v84, v84, |v84|
    s_waitcnt lgkmcnt(2)
    v_mfma_f32_16x16x32_bf16 v[100:103], v[204:207], a[160:163], v[100:103]
    ds_read_b64_tr_b16 v[200:201], v15 offset:8192
    ds_read_b64_tr_b16 v[202:203], v15 offset:8704
    v_mfma_f32_16x16x32_bf16 v[104:107], v[204:207], a[164:167], v[104:107]
    v_mul_f32 v85, v85, |v85|
    v_mul_f32 v86, v86, |v86|
    v_mfma_f32_16x16x32_bf16 v[108:111], v[204:207], a[168:171], v[108:111]
    v_mul_f32 v87, v87, |v87|
    s_add_u32 m0, s41, 110592
    v_mfma_f32_16x16x32_bf16 v[112:115], v[204:207], a[172:175], v[112:115]
    v_cvt_pk_bf16_f32 v134, v84, v85
    s_waitcnt lgkmcnt(2)
    v_mfma_f32_16x16x32_bf16 v[116:119], v[196:199], a[160:163], v[116:119]
    ds_read_b64_tr_b16 v[204:205], v16 offset:8192
    ds_read_b64_tr_b16 v[206:207], v16 offset:8704
    v_mfma_f32_16x16x32_bf16 v[120:123], v[196:199], a[164:167], v[120:123]
    v_cvt_pk_bf16_f32 v135, v86, v87
    v_pk_max_i16 v134, v134, 0
    v_mfma_f32_16x16x32_bf16 v[124:127], v[196:199], a[168:171], v[124:127]
    v_pk_max_i16 v135, v135, 0
    s_add_u32 s79, s81, 0
    buffer_store_dwordx4 v[132:135], v17, s[52:55], s79 offen offset:0 sc1
    v_mfma_f32_16x16x32_bf16 v[128:131], v[196:199], a[172:175], v[128:131]
    buffer_load_dwordx4 v50, s[92:95], s40 offen offset:0  lds
    s_waitcnt lgkmcnt(2)
    v_mfma_f32_16x16x32_bf16 v[100:103], v[200:203], a[176:179], v[100:103]
    ds_read_b64_tr_b16 v[196:197], v15 offset:12288
    ds_read_b64_tr_b16 v[198:199], v15 offset:12800
    v_mfma_f32_16x16x32_bf16 v[104:107], v[200:203], a[180:183], v[104:107]
    v_mul_f32 v72, v72, |v72|
    v_mul_f32 v73, v73, |v73|
    v_mfma_f32_16x16x32_bf16 v[108:111], v[200:203], a[184:187], v[108:111]
    v_mul_f32 v74, v74, |v74|
    v_mul_f32 v75, v75, |v75|
    v_mfma_f32_16x16x32_bf16 v[112:115], v[200:203], a[188:191], v[112:115]
    v_cvt_pk_bf16_f32 v136, v72, v73
    s_waitcnt lgkmcnt(2)
    v_mfma_f32_16x16x32_bf16 v[116:119], v[204:207], a[176:179], v[116:119]
    ds_read_b64_tr_b16 v[200:201], v16 offset:12288
    ds_read_b64_tr_b16 v[202:203], v16 offset:12800
    v_mfma_f32_16x16x32_bf16 v[120:123], v[204:207], a[180:183], v[120:123]
    buffer_load_dwordx4 v51, s[92:95], s40 offen offset:1024  lds
    v_cvt_pk_bf16_f32 v137, v74, v75
    v_mfma_f32_16x16x32_bf16 v[124:127], v[204:207], a[184:187], v[124:127]
    v_pk_max_i16 v136, v136, 0
    v_pk_max_i16 v137, v137, 0
    v_mfma_f32_16x16x32_bf16 v[128:131], v[204:207], a[188:191], v[128:131]
    v_mul_f32 v88, v88, |v88|
    s_waitcnt lgkmcnt(2)
    v_mfma_f32_16x16x32_bf16 v[100:103], v[196:199], a[192:195], v[100:103]
    ds_read_b64_tr_b16 v[204:205], v15 offset:16384
    ds_read_b64_tr_b16 v[206:207], v15 offset:16896
    v_mfma_f32_16x16x32_bf16 v[104:107], v[196:199], a[196:199], v[104:107]
    v_mul_f32 v89, v89, |v89|
    buffer_load_dwordx4 v52, s[92:95], s40 offen offset:2048  lds
    v_mfma_f32_16x16x32_bf16 v[108:111], v[196:199], a[200:203], v[108:111]
    v_mul_f32 v90, v90, |v90|
    v_mul_f32 v91, v91, |v91|
    v_mfma_f32_16x16x32_bf16 v[112:115], v[196:199], a[204:207], v[112:115]
    v_cvt_pk_bf16_f32 v138, v88, v89
    s_waitcnt lgkmcnt(2)
    v_mfma_f32_16x16x32_bf16 v[116:119], v[200:203], a[192:195], v[116:119]
    ds_read_b64_tr_b16 v[196:197], v16 offset:16384
    ds_read_b64_tr_b16 v[198:199], v16 offset:16896
    v_mfma_f32_16x16x32_bf16 v[120:123], v[200:203], a[196:199], v[120:123]
    v_cvt_pk_bf16_f32 v139, v90, v91
    v_pk_max_i16 v138, v138, 0
    v_mfma_f32_16x16x32_bf16 v[124:127], v[200:203], a[200:203], v[124:127]
    buffer_load_dwordx4 v53, s[92:95], s40 offen offset:3072  lds
    v_pk_max_i16 v139, v139, 0
    v_mfma_f32_16x16x32_bf16 v[128:131], v[200:203], a[204:207], v[128:131]
    buffer_store_dwordx4 v[136:139], v17, s[52:55], s79 offen offset:1024 sc1
    s_waitcnt lgkmcnt(2)
    v_mfma_f32_16x16x32_bf16 v[100:103], v[204:207], a[208:211], v[100:103]
    ds_read_b64_tr_b16 v[200:201], v15 offset:20480
    ds_read_b64_tr_b16 v[202:203], v15 offset:20992
    v_mfma_f32_16x16x32_bf16 v[104:107], v[204:207], a[212:215], v[104:107]
    v_mul_f32 v76, v76, |v76|
    v_mul_f32 v77, v77, |v77|
    v_mfma_f32_16x16x32_bf16 v[108:111], v[204:207], a[216:219], v[108:111]
    s_add_u32 m0, s41, 114688
    v_mul_f32 v78, v78, |v78|
    v_mfma_f32_16x16x32_bf16 v[112:115], v[204:207], a[220:223], v[112:115]
    v_mul_f32 v79, v79, |v79|
    v_cvt_pk_bf16_f32 v140, v76, v77
    s_waitcnt lgkmcnt(2)
    v_mfma_f32_16x16x32_bf16 v[116:119], v[196:199], a[208:211], v[116:119]
    ds_read_b64_tr_b16 v[204:205], v16 offset:20480
    ds_read_b64_tr_b16 v[206:207], v16 offset:20992
    v_mfma_f32_16x16x32_bf16 v[120:123], v[196:199], a[212:215], v[120:123]
    v_cvt_pk_bf16_f32 v141, v78, v79
    v_pk_max_i16 v140, v140, 0
    v_mfma_f32_16x16x32_bf16 v[124:127], v[196:199], a[216:219], v[124:127]
    buffer_load_dwordx4 v54, s[92:95], s40 offen offset:0  lds
    v_pk_max_i16 v141, v141, 0
    v_mfma_f32_16x16x32_bf16 v[128:131], v[196:199], a[220:223], v[128:131]
    v_mul_f32 v92, v92, |v92|
    s_waitcnt lgkmcnt(2)
    v_mfma_f32_16x16x32_bf16 v[100:103], v[200:203], a[224:227], v[100:103]
    ds_read_b64_tr_b16 v[196:197], v15 offset:24576
    ds_read_b64_tr_b16 v[198:199], v15 offset:25088
    v_mfma_f32_16x16x32_bf16 v[104:107], v[200:203], a[228:231], v[104:107]
    v_mul_f32 v93, v93, |v93|
    v_mul_f32 v94, v94, |v94|
    v_mfma_f32_16x16x32_bf16 v[108:111], v[200:203], a[232:235], v[108:111]
    v_mul_f32 v95, v95, |v95|
    buffer_load_dwordx4 v55, s[92:95], s40 offen offset:1024  lds
    v_mfma_f32_16x16x32_bf16 v[112:115], v[200:203], a[236:239], v[112:115]
    v_cvt_pk_bf16_f32 v142, v92, v93
    s_waitcnt lgkmcnt(2)
    v_mfma_f32_16x16x32_bf16 v[116:119], v[204:207], a[224:227], v[116:119]
    ds_read_b64_tr_b16 v[200:201], v16 offset:24576
    ds_read_b64_tr_b16 v[202:203], v16 offset:25088
    v_mfma_f32_16x16x32_bf16 v[120:123], v[204:207], a[228:231], v[120:123]
    v_cvt_pk_bf16_f32 v143, v94, v95
    v_pk_max_i16 v142, v142, 0
    v_mfma_f32_16x16x32_bf16 v[124:127], v[204:207], a[232:235], v[124:127]
    v_pk_max_i16 v143, v143, 0
    buffer_store_dwordx4 v[140:143], v17, s[52:55], s79 offen offset:2048 sc1
    v_mfma_f32_16x16x32_bf16 v[128:131], v[204:207], a[236:239], v[128:131]
    buffer_load_dwordx4 v56, s[92:95], s40 offen offset:2048  lds
    s_waitcnt lgkmcnt(2)
    v_mfma_f32_16x16x32_bf16 v[100:103], v[196:199], a[240:243], v[100:103]
    ds_read_b64_tr_b16 v[204:205], v15 offset:28672
    ds_read_b64_tr_b16 v[206:207], v15 offset:29184
    v_mfma_f32_16x16x32_bf16 v[104:107], v[196:199], a[244:247], v[104:107]
    v_mul_f32 v80, v80, |v80|
    v_mul_f32 v81, v81, |v81|
    v_mfma_f32_16x16x32_bf16 v[108:111], v[196:199], a[248:251], v[108:111]
    v_mul_f32 v82, v82, |v82|
    v_mul_f32 v83, v83, |v83|
    v_mfma_f32_16x16x32_bf16 v[112:115], v[196:199], a[252:255], v[112:115]
    v_cvt_pk_bf16_f32 v144, v80, v81
    s_waitcnt lgkmcnt(2)
    v_mfma_f32_16x16x32_bf16 v[116:119], v[200:203], a[240:243], v[116:119]
    ds_read_b64_tr_b16 v[196:197], v16 offset:28672
    ds_read_b64_tr_b16 v[198:199], v16 offset:29184
    v_mfma_f32_16x16x32_bf16 v[120:123], v[200:203], a[244:247], v[120:123]
    buffer_load_dwordx4 v57, s[92:95], s40 offen offset:3072  lds
    v_cvt_pk_bf16_f32 v145, v82, v83
    v_mfma_f32_16x16x32_bf16 v[124:127], v[200:203], a[248:251], v[124:127]
    v_pk_max_i16 v144, v144, 0
    v_pk_max_i16 v145, v145, 0
    v_mfma_f32_16x16x32_bf16 v[128:131], v[200:203], a[252:255], v[128:131]
    v_mul_f32 v96, v96, |v96|
    s_waitcnt lgkmcnt(2)
    v_mfma_f32_16x16x32_bf16 v[100:103], v[204:207], v[24:27], v[100:103]
    ds_read_b64_tr_b16 v[200:201], v15 offset:32768
    ds_read_b64_tr_b16 v[202:203], v15 offset:33280
    v_mfma_f32_16x16x32_bf16 v[104:107], v[204:207], v[28:31], v[104:107]
    v_mul_f32 v97, v97, |v97|
    s_add_u32 m0, s41, 118784
    v_mfma_f32_16x16x32_bf16 v[108:111], v[204:207], v[32:35], v[108:111]
    v_mul_f32 v98, v98, |v98|
    v_mul_f32 v99, v99, |v99|
    v_mfma_f32_16x16x32_bf16 v[112:115], v[204:207], v[36:39], v[112:115]
    v_cvt_pk_bf16_f32 v146, v96, v97
    s_waitcnt lgkmcnt(2)
    v_mfma_f32_16x16x32_bf16 v[116:119], v[196:199], v[24:27], v[116:119]
    ds_read_b64_tr_b16 v[204:205], v16 offset:32768
    ds_read_b64_tr_b16 v[206:207], v16 offset:33280
    v_mfma_f32_16x16x32_bf16 v[120:123], v[196:199], v[28:31], v[120:123]
    v_cvt_pk_bf16_f32 v147, v98, v99
    v_pk_max_i16 v146, v146, 0
    v_mfma_f32_16x16x32_bf16 v[124:127], v[196:199], v[32:35], v[124:127]
    buffer_load_dwordx4 v58, s[92:95], s40 offen offset:0  lds
    v_pk_max_i16 v147, v147, 0
    v_mfma_f32_16x16x32_bf16 v[128:131], v[196:199], v[36:39], v[128:131]
    buffer_store_dwordx4 v[144:147], v17, s[52:55], s79 offen offset:3072 sc1
    s_waitcnt lgkmcnt(2)
    v_mfma_f32_16x16x32_bf16 v[100:103], v[200:203], v[40:43], v[100:103]
    s_waitcnt vmcnt(13)
    s_barrier
    v_add_u32 v15, 0x9000, v15
    v_mfma_f32_16x16x32_bf16 v[104:107], v[200:203], v[44:47], v[104:107]
    v_add_u32 v16, 0x9000, v16
    ds_read_b64_tr_b16 v[196:197], v15 offset:0
    ds_read_b64_tr_b16 v[198:199], v15 offset:512
    v_mfma_f32_16x16x32_bf16 v[108:111], v[200:203], v[60:63], v[108:111]
    s_add_u32 s32, s38, 1
    s_and_b32 s32, s32, 3
    s_lshl_b32 s32, s32, 6
    s_add_u32 s32, s32, s36
    s_lshl_b32 s32, s32, 3
    v_add_u32 v7, s32, v21
    ds_read_b64 v[208:209], v7 offset:0
    ds_read_b64 v[210:211], v7 offset:128
    v_mfma_f32_16x16x32_bf16 v[112:115], v[200:203], v[64:67], v[112:115]
    s_waitcnt lgkmcnt(4)
    v_mfma_f32_16x16x32_bf16 v[116:119], v[204:207], v[40:43], v[116:119]
    ds_read_b64_tr_b16 v[200:201], v16 offset:0
    v_mfma_f32_16x16x32_bf16 v[120:123], v[204:207], v[44:47], v[120:123]
    ds_read_b64_tr_b16 v[202:203], v16 offset:512
    v_mfma_f32_16x16x32_bf16 v[124:127], v[204:207], v[60:63], v[124:127]
    v_mfma_f32_16x16x32_bf16 v[128:131], v[204:207], v[64:67], v[128:131]
    s_waitcnt lgkmcnt(2)
    v_mfma_f32_16x16x4bf16_1k v[100:115], v[208:209], v[22:23], v[100:115]
    s_nop 3
    v_mfma_f32_16x16x4bf16_1k v[116:131], v[210:211], v[22:23], v[116:131]
    v_mfma_f32_16x16x32_bf16 v[68:71], v[196:199], a[0:3], 0
    ds_read_b64_tr_b16 v[204:205], v15 offset:4096
    ds_read_b64_tr_b16 v[206:207], v15 offset:4608
    v_mfma_f32_16x16x32_bf16 v[72:75], v[196:199], a[4:7], 0
    s_nop 2
    v_mul_f32 v100, v100, |v100|
    s_add_u32 s40, s38, 3
    s_and_b32 s40, s40, 3
    s_lshl_b32 s40, s40, 6
    v_mfma_f32_16x16x32_bf16 v[76:79], v[196:199], a[8:11], 0
    v_mul_f32 v101, v101, |v101|
    v_mfma_f32_16x16x32_bf16 v[80:83], v[196:199], a[12:15], 0
    s_waitcnt lgkmcnt(2)
    v_mfma_f32_16x16x32_bf16 v[84:87], v[200:203], a[0:3], 0
    ds_read_b64_tr_b16 v[196:197], v16 offset:4096
    ds_read_b64_tr_b16 v[198:199], v16 offset:4608
    v_mfma_f32_16x16x32_bf16 v[88:91], v[200:203], a[4:7], 0
    v_mul_f32 v102, v102, |v102|
    v_mul_f32 v103, v103, |v103|
    v_mfma_f32_16x16x32_bf16 v[92:95], v[200:203], a[8:11], 0
    s_add_u32 s40, s40, s36
    s_lshl_b32 s40, s40, 1
    s_add_u32 s40, s40, 0
    v_mfma_f32_16x16x32_bf16 v[96:99], v[200:203], a[12:15], 0
    s_waitcnt lgkmcnt(2)
    v_mfma_f32_16x16x32_bf16 v[68:71], v[204:207], a[16:19], v[68:71]
    ds_read_b64_tr_b16 v[200:201], v15 offset:8192
    ds_read_b64_tr_b16 v[202:203], v15 offset:8704
    v_mfma_f32_16x16x32_bf16 v[72:75], v[204:207], a[20:23], v[72:75]
    v_cvt_pk_bf16_f32 v148, v100, v101
    v_cvt_pk_bf16_f32 v149, v102, v103
    v_mfma_f32_16x16x32_bf16 v[76:79], v[204:207], a[24:27], v[76:79]
    s_add_u32 m0, s41, 0
    v_mfma_f32_16x16x32_bf16 v[80:83], v[204:207], a[28:31], v[80:83]
    s_waitcnt lgkmcnt(2)
    v_mfma_f32_16x16x32_bf16 v[84:87], v[196:199], a[16:19], v[84:87]
    ds_read_b64_tr_b16 v[204:205], v16 offset:8192
    ds_read_b64_tr_b16 v[206:207], v16 offset:8704
    v_mfma_f32_16x16x32_bf16 v[88:91], v[196:199], a[20:23], v[88:91]
    v_pk_max_i16 v148, v148, 0
    v_pk_max_i16 v149, v149, 0
    v_mfma_f32_16x16x32_bf16 v[92:95], v[196:199], a[24:27], v[92:95]
    buffer_load_dwordx4 v50, s[92:95], s40 offen offset:0  lds
    v_mfma_f32_16x16x32_bf16 v[96:99], v[196:199], a[28:31], v[96:99]
    s_waitcnt lgkmcnt(2)
    v_mfma_f32_16x16x32_bf16 v[68:71], v[200:203], a[32:35], v[68:71]
    ds_read_b64_tr_b16 v[196:197], v15 offset:12288
    ds_read_b64_tr_b16 v[198:199], v15 offset:12800
    v_mfma_f32_16x16x32_bf16 v[72:75], v[200:203], a[36:39], v[72:75]
    v_mul_f32 v116, v116, |v116|
    v_mul_f32 v117, v117, |v117|
    v_mfma_f32_16x16x32_bf16 v[76:79], v[200:203], a[40:43], v[76:79]
    v_mul_f32 v118, v118, |v118|
    v_mfma_f32_16x16x32_bf16 v[80:83], v[200:203], a[44:47], v[80:83]
    s_waitcnt lgkmcnt(2)
    v_mfma_f32_16x16x32_bf16 v[84:87], v[204:207], a[32:35], v[84:87]
    ds_read_b64_tr_b16 v[200:201], v16 offset:12288
    ds_read_b64_tr_b16 v[202:203], v16 offset:12800
    v_mfma_f32_16x16x32_bf16 v[88:91], v[204:207], a[36:39], v[88:91]
    buffer_load_dwordx4 v51, s[92:95], s40 offen offset:1024  lds
    v_mul_f32 v119, v119, |v119|
    v_mfma_f32_16x16x32_bf16 v[92:95], v[204:207], a[40:43], v[92:95]
    v_cvt_pk_bf16_f32 v150, v116, v117
    v_mfma_f32_16x16x32_bf16 v[96:99], v[204:207], a[44:47], v[96:99]
    s_waitcnt lgkmcnt(2)
    v_mfma_f32_16x16x32_bf16 v[68:71], v[196:199], a[48:51], v[68:71]
    ds_read_b64_tr_b16 v[204:205], v15 offset:16384
    ds_read_b64_tr_b16 v[206:207], v15 offset:16896
    v_mfma_f32_16x16x32_bf16 v[72:75], v[196:199], a[52:55], v[72:75]
    buffer_load_dwordx4 v52, s[92:95], s40 offen offset:2048  lds
    v_cvt_pk_bf16_f32 v151, v118, v119
    v_mfma_f32_16x16x32_bf16 v[76:79], v[196:199], a[56:59], v[76:79]
    v_pk_max_i16 v150, v150, 0
    v_mfma_f32_16x16x32_bf16 v[80:83], v[196:199], a[60:63], v[80:83]
    s_waitcnt lgkmcnt(2)
    v_mfma_f32_16x16x32_bf16 v[84:87], v[200:203], a[48:51], v[84:87]
    ds_read_b64_tr_b16 v[196:197], v16 offset:16384
    ds_read_b64_tr_b16 v[198:199], v16 offset:16896
    v_mfma_f32_16x16x32_bf16 v[88:91], v[200:203], a[52:55], v[88:91]
    v_pk_max_i16 v151, v151, 0
    buffer_load_dwordx4 v53, s[92:95], s40 offen offset:3072  lds
    v_mfma_f32_16x16x32_bf16 v[92:95], v[200:203], a[56:59], v[92:95]
    s_add_u32 s79, s81, 8192
    buffer_store_dwordx4 v[148:151], v17, s[52:55], s79 offen offset:0 sc1
    v_mfma_f32_16x16x32_bf16 v[96:99], v[200:203], a[60:63], v[96:99]
    s_waitcnt lgkmcnt(2)
    v_mfma_f32_16x16x32_bf16 v[68:71], v[204:207], a[64:67], v[68:71]
    ds_read_b64_tr_b16 v[200:201], v15 offset:20480
    ds_read_b64_tr_b16 v[202:203], v15 offset:20992
    v_mfma_f32_16x16x32_bf16 v[72:75], v[204:207], a[68:71], v[72:75]
    v_mul_f32 v104, v104, |v104|
    s_add_u32 m0, s41, 4096
    v_mfma_f32_16x16x32_bf16 v[76:79], v[204:207], a[72:75], v[76:79]
    v_mul_f32 v105, v105, |v105|
    v_mfma_f32_16x16x32_bf16 v[80:83], v[204:207], a[76:79], v[80:83]
    s_waitcnt lgkmcnt(2)
    v_mfma_f32_16x16x32_bf16 v[84:87], v[196:199], a[64:67], v[84:87]
    ds_read_b64_tr_b16 v[204:205], v16 offset:20480
    ds_read_b64_tr_b16 v[206:207], v16 offset:20992
    v_mfma_f32_16x16x32_bf16 v[88:91], v[196:199], a[68:71], v[88:91]
    v_mul_f32 v106, v106, |v106|
    v_mul_f32 v107, v107, |v107|
    v_mfma_f32_16x16x32_bf16 v[92:95], v[196:199], a[72:75], v[92:95]
    buffer_load_dwordx4 v54, s[92:95], s40 offen offset:0  lds
    v_mfma_f32_16x16x32_bf16 v[96:99], v[196:199], a[76:79], v[96:99]
    s_waitcnt lgkmcnt(2)
    v_mfma_f32_16x16x32_bf16 v[68:71], v[200:203], a[80:83], v[68:71]
    ds_read_b64_tr_b16 v[196:197], v15 offset:24576
    ds_read_b64_tr_b16 v[198:199], v15 offset:25088
    v_mfma_f32_16x16x32_bf16 v[72:75], v[200:203], a[84:87], v[72:75]
    v_cvt_pk_bf16_f32 v152, v104, v105
    v_cvt_pk_bf16_f32 v153, v106, v107
    v_mfma_f32_16x16x32_bf16 v[76:79], v[200:203], a[88:91], v[76:79]
    buffer_load_dwordx4 v55, s[92:95], s40 offen offset:1024  lds
    v_mfma_f32_16x16x32_bf16 v[80:83], v[200:203], a[92:95], v[80:83]
    s_waitcnt lgkmcnt(2)
    v_mfma_f32_16x16x32_bf16 v[84:87], v[204:207], a[80:83], v[84:87]
    ds_read_b64_tr_b16 v[200:201], v16 offset:24576
    ds_read_b64_tr_b16 v[202:203], v16 offset:25088
    v_mfma_f32_16x16x32_bf16 v[88:91], v[204:207], a[84:87], v[88:91]
    v_pk_max_i16 v152, v152, 0
    v_pk_max_i16 v153, v153, 0
    v_mfma_f32_16x16x32_bf16 v[92:95], v[204:207], a[88:91], v[92:95]
    buffer_load_dwordx4 v56, s[92:95], s40 offen offset:2048  lds
    v_mfma_f32_16x16x32_bf16 v[96:99], v[204:207], a[92:95], v[96:99]
    s_waitcnt lgkmcnt(2)
    v_mfma_f32_16x16x32_bf16 v[68:71], v[196:199], a[96:99], v[68:71]
    ds_read_b64_tr_b16 v[204:205], v15 offset:28672
    ds_read_b64_tr_b16 v[206:207], v15 offset:29184
    v_mfma_f32_16x16x32_bf16 v[72:75], v[196:199], a[100:103], v[72:75]
    v_mul_f32 v120, v120, |v120|
    v_mul_f32 v121, v121, |v121|
    v_mfma_f32_16x16x32_bf16 v[76:79], v[196:199], a[104:107], v[76:79]
    v_mul_f32 v122, v122, |v122|
    v_mfma_f32_16x16x32_bf16 v[80:83], v[196:199], a[108:111], v[80:83]
    s_waitcnt lgkmcnt(2)
    v_mfma_f32_16x16x32_bf16 v[84:87], v[200:203], a[96:99], v[84:87]
    ds_read_b64_tr_b16 v[196:197], v16 offset:28672
    ds_read_b64_tr_b16 v[198:199], v16 offset:29184
    v_mfma_f32_16x16x32_bf16 v[88:91], v[200:203], a[100:103], v[88:91]
    buffer_load_dwordx4 v57, s[92:95], s40 offen offset:3072  lds
    v_mul_f32 v123, v123, |v123|
    v_mfma_f32_16x16x32_bf16 v[92:95], v[200:203], a[104:107], v[92:95]
    v_cvt_pk_bf16_f32 v154, v120, v121
    v_mfma_f32_16x16x32_bf16 v[96:99], v[200:203], a[108:111], v[96:99]
    s_waitcnt lgkmcnt(2)
    v_mfma_f32_16x16x32_bf16 v[68:71], v[204:207], a[112:115], v[68:71]
    ds_read_b64_tr_b16 v[200:201], v15 offset:32768
    ds_read_b64_tr_b16 v[202:203], v15 offset:33280
    v_mfma_f32_16x16x32_bf16 v[72:75], v[204:207], a[116:119], v[72:75]
    s_add_u32 m0, s41, 8192
    v_cvt_pk_bf16_f32 v155, v122, v123
    v_mfma_f32_16x16x32_bf16 v[76:79], v[204:207], a[120:123], v[76:79]
    v_pk_max_i16 v154, v154, 0
    v_mfma_f32_16x16x32_bf16 v[80:83], v[204:207], a[124:127], v[80:83]
    s_waitcnt lgkmcnt(2)
    v_mfma_f32_16x16x32_bf16 v[84:87], v[196:199], a[112:115], v[84:87]
    ds_read_b64_tr_b16 v[204:205], v16 offset:32768
    ds_read_b64_tr_b16 v[206:207], v16 offset:33280
    v_mfma_f32_16x16x32_bf16 v[88:91], v[196:199], a[116:119], v[88:91]
    v_pk_max_i16 v155, v155, 0
    buffer_load_dwordx4 v58, s[92:95], s40 offen offset:0  lds
    v_mfma_f32_16x16x32_bf16 v[92:95], v[196:199], a[120:123], v[92:95]
    buffer_store_dwordx4 v[152:155], v17, s[52:55], s79 offen offset:1024 sc1
    v_mfma_f32_16x16x32_bf16 v[96:99], v[196:199], a[124:127], v[96:99]
    s_waitcnt lgkmcnt(2)
    v_mfma_f32_16x16x32_bf16 v[68:71], v[200:203], a[128:131], v[68:71]
    s_waitcnt vmcnt(12)
    s_barrier
    v_mfma_f32_16x16x32_bf16 v[72:75], v[200:203], a[132:135], v[72:75]
    v_add_u32 v15, 0x9000, v15
    v_add_u32 v16, 0x9000, v16
    v_mfma_f32_16x16x32_bf16 v[76:79], v[200:203], a[136:139], v[76:79]
    ds_read_b64_tr_b16 v[196:197], v15 offset:0
    ds_read_b64_tr_b16 v[198:199], v15 offset:512
    v_mfma_f32_16x16x32_bf16 v[80:83], v[200:203], a[140:143], v[80:83]
    s_waitcnt lgkmcnt(2)
    v_mfma_f32_16x16x32_bf16 v[84:87], v[204:207], a[128:131], v[84:87]
    ds_read_b64_tr_b16 v[200:201], v16 offset:0
    v_mfma_f32_16x16x32_bf16 v[88:91], v[204:207], a[132:135], v[88:91]
    ds_read_b64_tr_b16 v[202:203], v16 offset:512
    v_mfma_f32_16x16x32_bf16 v[92:95], v[204:207], a[136:139], v[92:95]
    v_mfma_f32_16x16x32_bf16 v[96:99], v[204:207], a[140:143], v[96:99]
    s_waitcnt lgkmcnt(2)
    v_mfma_f32_16x16x32_bf16 v[68:71], v[196:199], a[144:147], v[68:71]
    ds_read_b64_tr_b16 v[204:205], v15 offset:4096
    ds_read_b64_tr_b16 v[206:207], v15 offset:4608
    v_mfma_f32_16x16x32_bf16 v[72:75], v[196:199], a[148:151], v[72:75]
    v_mul_f32 v108, v108, |v108|
    s_add_u32 s40, s38, 3
    s_and_b32 s40, s40, 3
    s_lshl_b32 s40, s40, 6
    v_mfma_f32_16x16x32_bf16 v[76:79], v[196:199], a[152:155], v[76:79]
    v_mul_f32 v109, v109, |v109|
    v_mul_f32 v110, v110, |v110|
    v_mfma_f32_16x16x32_bf16 v[80:83], v[196:199], a[156:159], v[80:83]
    s_waitcnt lgkmcnt(2)
    v_mfma_f32_16x16x32_bf16 v[84:87], v[200:203], a[144:147], v[84:87]
    ds_read_b64_tr_b16 v[196:197], v16 offset:4096
    ds_read_b64_tr_b16 v[198:199], v16 offset:4608
    v_mfma_f32_16x16x32_bf16 v[88:91], v[200:203], a[148:151], v[88:91]
    s_lshl_b32 s32, s3, 13
    v_add_u32 v8, s32, v17
    s_add_u32 s40, s40, s36
    s_lshl_b32 s40, s40, 1
    s_add_u32 s40, s40, 2654208
    v_mfma_f32_16x16x32_bf16 v[92:95], v[200:203], a[152:155], v[92:95]
    v_mul_f32 v111, v111, |v111|
    v_mfma_f32_16x16x32_bf16 v[96:99], v[200:203], a[156:159], v[96:99]
    s_waitcnt lgkmcnt(2)
    v_mfma_f32_16x16x32_bf16 v[68:71], v[204:207], a[160:163], v[68:71]
    ds_read_b64_tr_b16 v[200:201], v15 offset:8192
    ds_read_b64_tr_b16 v[202:203], v15 offset:8704
    v_mfma_f32_16x16x32_bf16 v[72:75], v[204:207], a[164:167], v[72:75]
    v_cvt_pk_bf16_f32 v156, v108, v109
    v_cvt_pk_bf16_f32 v157, v110, v111
    v_mfma_f32_16x16x32_bf16 v[76:79], v[204:207], a[168:171], v[76:79]
    s_add_u32 m0, s41, 36864
    v_mfma_f32_16x16x32_bf16 v[80:83], v[204:207], a[172:175], v[80:83]
    s_waitcnt lgkmcnt(2)
    v_mfma_f32_16x16x32_bf16 v[84:87], v[196:199], a[160:163], v[84:87]
    ds_read_b64_tr_b16 v[204:205], v16 offset:8192
    ds_read_b64_tr_b16 v[206:207], v16 offset:8704
    v_mfma_f32_16x16x32_bf16 v[88:91], v[196:199], a[164:167], v[88:91]
    v_pk_max_i16 v156, v156, 0
    v_pk_max_i16 v157, v157, 0
    v_mfma_f32_16x16x32_bf16 v[92:95], v[196:199], a[168:171], v[92:95]
    v_mul_f32 v124, v124, |v124|
    buffer_load_dwordx4 v50, s[92:95], s40 offen offset:0  lds
    v_mfma_f32_16x16x32_bf16 v[96:99], v[196:199], a[172:175], v[96:99]
    s_waitcnt lgkmcnt(2)
    v_mfma_f32_16x16x32_bf16 v[68:71], v[200:203], a[176:179], v[68:71]
    ds_read_b64_tr_b16 v[196:197], v15 offset:12288
    ds_read_b64_tr_b16 v[198:199], v15 offset:12800
    v_mfma_f32_16x16x32_bf16 v[72:75], v[200:203], a[180:183], v[72:75]
    v_mul_f32 v125, v125, |v125|
    v_xor_b32 v49, 0x2000, v8
    v_mfma_f32_16x16x32_bf16 v[76:79], v[200:203], a[184:187], v[76:79]
    v_mul_f32 v126, v126, |v126|
    v_mfma_f32_16x16x32_bf16 v[80:83], v[200:203], a[188:191], v[80:83]
    s_waitcnt lgkmcnt(2)
    v_mfma_f32_16x16x32_bf16 v[84:87], v[204:207], a[176:179], v[84:87]
    ds_read_b64_tr_b16 v[200:201], v16 offset:12288
    ds_read_b64_tr_b16 v[202:203], v16 offset:12800
    v_mfma_f32_16x16x32_bf16 v[88:91], v[204:207], a[180:183], v[88:91]
    buffer_load_dwordx4 v51, s[92:95], s40 offen offset:1024  lds
    v_mul_f32 v127, v127, |v127|
    v_mfma_f32_16x16x32_bf16 v[92:95], v[204:207], a[184:187], v[92:95]
    v_cvt_pk_bf16_f32 v158, v124, v125
    v_mfma_f32_16x16x32_bf16 v[96:99], v[204:207], a[188:191], v[96:99]
    s_waitcnt lgkmcnt(2)
    v_mfma_f32_16x16x32_bf16 v[68:71], v[196:199], a[192:195], v[68:71]
    ds_read_b64_tr_b16 v[204:205], v15 offset:16384
    ds_read_b64_tr_b16 v[206:207], v15 offset:16896
    v_mfma_f32_16x16x32_bf16 v[72:75], v[196:199], a[196:199], v[72:75]
    buffer_load_dwordx4 v52, s[92:95], s40 offen offset:2048  lds
    v_cvt_pk_bf16_f32 v159, v126, v127
    v_mfma_f32_16x16x32_bf16 v[76:79], v[196:199], a[200:203], v[76:79]
    v_pk_max_i16 v158, v158, 0
    v_pk_max_i16 v159, v159, 0
    v_mfma_f32_16x16x32_bf16 v[80:83], v[196:199], a[204:207], v[80:83]
    s_waitcnt lgkmcnt(2)
    v_mfma_f32_16x16x32_bf16 v[84:87], v[200:203], a[192:195], v[84:87]
    ds_read_b64_tr_b16 v[196:197], v16 offset:16384
    ds_read_b64_tr_b16 v[198:199], v16 offset:16896
    v_mfma_f32_16x16x32_bf16 v[88:91], v[200:203], a[196:199], v[88:91]
    buffer_load_dwordx4 v53, s[92:95], s40 offen offset:3072  lds
    buffer_store_dwordx4 v[156:159], v17, s[52:55], s79 offen offset:2048 sc1
    v_mfma_f32_16x16x32_bf16 v[92:95], v[200:203], a[200:203], v[92:95]
    s_lshl_b32 s32, s43, 12
    s_add_u32 s32, s32, 152576
    v_add_u32 v212, s32, v17
    v_mfma_f32_16x16x32_bf16 v[96:99], v[200:203], a[204:207], v[96:99]
    s_waitcnt lgkmcnt(2)
    v_mfma_f32_16x16x32_bf16 v[68:71], v[204:207], a[208:211], v[68:71]
    ds_read_b64_tr_b16 v[200:201], v15 offset:20480
    ds_read_b64_tr_b16 v[202:203], v15 offset:20992
    v_mfma_f32_16x16x32_bf16 v[72:75], v[204:207], a[212:215], v[72:75]
    v_mul_f32 v112, v112, |v112|
    s_add_u32 m0, s41, 40960
    v_mfma_f32_16x16x32_bf16 v[76:79], v[204:207], a[216:219], v[76:79]
    v_mul_f32 v113, v113, |v113|
    v_mfma_f32_16x16x32_bf16 v[80:83], v[204:207], a[220:223], v[80:83]
    s_waitcnt lgkmcnt(2)
    v_mfma_f32_16x16x32_bf16 v[84:87], v[196:199], a[208:211], v[84:87]
    ds_read_b64_tr_b16 v[204:205], v16 offset:20480
    ds_read_b64_tr_b16 v[206:207], v16 offset:20992
    v_mfma_f32_16x16x32_bf16 v[88:91], v[196:199], a[212:215], v[88:91]
    v_mul_f32 v114, v114, |v114|
    v_mul_f32 v115, v115, |v115|
    v_mfma_f32_16x16x32_bf16 v[92:95], v[196:199], a[216:219], v[92:95]
    buffer_load_dwordx4 v54, s[92:95], s40 offen offset:0  lds
    v_cvt_pk_bf16_f32 v160, v112, v113
    v_mfma_f32_16x16x32_bf16 v[96:99], v[196:199], a[220:223], v[96:99]
    s_waitcnt lgkmcnt(2)
    v_mfma_f32_16x16x32_bf16 v[68:71], v[200:203], a[224:227], v[68:71]
    ds_read_b64_tr_b16 v[196:197], v15 offset:24576
    ds_read_b64_tr_b16 v[198:199], v15 offset:25088
    v_mfma_f32_16x16x32_bf16 v[72:75], v[200:203], a[228:231], v[72:75]
    v_cvt_pk_bf16_f32 v161, v114, v115
    buffer_load_dwordx4 v55, s[92:95], s40 offen offset:1024  lds
    v_mfma_f32_16x16x32_bf16 v[76:79], v[200:203], a[232:235], v[76:79]
    v_pk_max_i16 v160, v160, 0
    v_mfma_f32_16x16x32_bf16 v[80:83], v[200:203], a[236:239], v[80:83]
    s_waitcnt lgkmcnt(2)
    v_mfma_f32_16x16x32_bf16 v[84:87], v[204:207], a[224:227], v[84:87]
    ds_read_b64_tr_b16 v[200:201], v16 offset:24576
    ds_read_b64_tr_b16 v[202:203], v16 offset:25088
    v_mfma_f32_16x16x32_bf16 v[88:91], v[204:207], a[228:231], v[88:91]
    s_lshl_b32 s32, s42, 3
    v_add_u32 v59, s32, v212
    v_pk_max_i16 v161, v161, 0
    v_mfma_f32_16x16x32_bf16 v[92:95], v[204:207], a[232:235], v[92:95]
    buffer_load_dwordx4 v56, s[92:95], s40 offen offset:2048  lds
    v_mfma_f32_16x16x32_bf16 v[96:99], v[204:207], a[236:239], v[96:99]
    s_waitcnt lgkmcnt(2)
    v_mfma_f32_16x16x32_bf16 v[68:71], v[196:199], a[240:243], v[68:71]
    ds_read_b64_tr_b16 v[204:205], v15 offset:28672
    ds_read_b64_tr_b16 v[206:207], v15 offset:29184
    v_mfma_f32_16x16x32_bf16 v[72:75], v[196:199], a[244:247], v[72:75]
    v_mul_f32 v128, v128, |v128|
    v_mul_f32 v129, v129, |v129|
    v_mfma_f32_16x16x32_bf16 v[76:79], v[196:199], a[248:251], v[76:79]
    v_mul_f32 v130, v130, |v130|
    buffer_load_dwordx4 v57, s[92:95], s40 offen offset:3072  lds
    v_mfma_f32_16x16x32_bf16 v[80:83], v[196:199], a[252:255], v[80:83]
    s_waitcnt lgkmcnt(2)
    v_mfma_f32_16x16x32_bf16 v[84:87], v[200:203], a[240:243], v[84:87]
    ds_read_b64_tr_b16 v[196:197], v16 offset:28672
    ds_read_b64_tr_b16 v[198:199], v16 offset:29184
    v_mfma_f32_16x16x32_bf16 v[88:91], v[200:203], a[244:247], v[88:91]
    v_mul_f32 v131, v131, |v131|
    v_cvt_pk_bf16_f32 v162, v128, v129
    v_mfma_f32_16x16x32_bf16 v[92:95], v[200:203], a[248:251], v[92:95]
    v_cvt_pk_bf16_f32 v163, v130, v131
    v_mfma_f32_16x16x32_bf16 v[96:99], v[200:203], a[252:255], v[96:99]
    s_waitcnt lgkmcnt(2)
    v_mfma_f32_16x16x32_bf16 v[68:71], v[204:207], v[24:27], v[68:71]
    ds_read_b64_tr_b16 v[200:201], v15 offset:32768
    ds_read_b64_tr_b16 v[202:203], v15 offset:33280
    v_mfma_f32_16x16x32_bf16 v[72:75], v[204:207], v[28:31], v[72:75]
    s_add_u32 m0, s41, 45056
    v_add_u32 v8, 0, v8
    v_add_u32 v49, 0, v49
    v_mfma_f32_16x16x32_bf16 v[76:79], v[204:207], v[32:35], v[76:79]
    v_pk_max_i16 v162, v162, 0
    v_mfma_f32_16x16x32_bf16 v[80:83], v[204:207], v[36:39], v[80:83]
    s_waitcnt lgkmcnt(2)
    v_mfma_f32_16x16x32_bf16 v[84:87], v[196:199], v[24:27], v[84:87]
    ds_read_b64_tr_b16 v[204:205], v16 offset:32768
    ds_read_b64_tr_b16 v[206:207], v16 offset:33280
    v_mfma_f32_16x16x32_bf16 v[88:91], v[196:199], v[28:31], v[88:91]
    v_pk_max_i16 v163, v163, 0
    buffer_load_dwordx4 v58, s[92:95], s40 offen offset:0  lds
    v_mfma_f32_16x16x32_bf16 v[92:95], v[196:199], v[32:35], v[92:95]
    buffer_store_dwordx4 v[160:163], v17, s[52:55], s79 offen offset:3072 sc1
    v_mfma_f32_16x16x32_bf16 v[96:99], v[196:199], v[36:39], v[96:99]
    s_waitcnt lgkmcnt(2)
    v_mfma_f32_16x16x32_bf16 v[68:71], v[200:203], v[40:43], v[68:71]
    s_waitcnt vmcnt(12)
    s_barrier
    v_add_u32 v15, 0xfffe5000, v15
    v_mfma_f32_16x16x32_bf16 v[72:75], v[200:203], v[44:47], v[72:75]
    v_add_u32 v16, 0xfffe5000, v16
    ds_read_b64_tr_b16 v[196:197], v15 offset:0
    ds_read_b64_tr_b16 v[198:199], v15 offset:512
    v_mfma_f32_16x16x32_bf16 v[76:79], v[200:203], v[60:63], v[76:79]
    s_add_u32 s32, s38, 2
    s_and_b32 s32, s32, 3
    s_lshl_b32 s32, s32, 6
    s_add_u32 s32, s32, s36
    s_lshl_b32 s32, s32, 3
    v_add_u32 v7, s32, v21
    ds_read_b64 v[208:209], v7 offset:0
    ds_read_b64 v[210:211], v7 offset:128
    v_mfma_f32_16x16x32_bf16 v[80:83], v[200:203], v[64:67], v[80:83]
    s_waitcnt lgkmcnt(4)
    v_mfma_f32_16x16x32_bf16 v[84:87], v[204:207], v[40:43], v[84:87]
    ds_read_b64_tr_b16 v[200:201], v16 offset:0
    v_mfma_f32_16x16x32_bf16 v[88:91], v[204:207], v[44:47], v[88:91]
    ds_read_b64_tr_b16 v[202:203], v16 offset:512
    v_mfma_f32_16x16x32_bf16 v[92:95], v[204:207], v[60:63], v[92:95]
    s_and_b32 s32, s26, 15
    s_lshl_b32 s32, s32, 2
    s_add_u32 s32, s32, s3
    s_mul_i32 s32, s32, 5248
    s_mul_i32 s33, s27, 331776
    s_add_u32 s32, s32, s33
    s_add_u32 s32, s32, 4096
    v_min_u32 v213, 40, v1
    v_lshlrev_b32 v213, 7, v213
    v_add_u32 v213, s32, v213
    buffer_load_dword v214, v213, s[60:63], 0 offen
    v_mfma_f32_16x16x32_bf16 v[96:99], v[204:207], v[64:67], v[96:99]
    s_waitcnt lgkmcnt(2)
    v_mfma_f32_16x16x4bf16_1k v[68:83], v[208:209], v[22:23], v[68:83]
    s_nop 3
    v_mfma_f32_16x16x4bf16_1k v[84:99], v[210:211], v[22:23], v[84:99]
    v_mfma_f32_16x16x32_bf16 v[100:103], v[196:199], a[0:3], 0
    ds_read_b64_tr_b16 v[204:205], v15 offset:4096
    ds_read_b64_tr_b16 v[206:207], v15 offset:4608
    v_mfma_f32_16x16x32_bf16 v[104:107], v[196:199], a[4:7], 0
    s_nop 2
    v_mul_f32 v68, v68, |v68|
    v_add_u32 v50, 4096, v10
    v_mfma_f32_16x16x32_bf16 v[108:111], v[196:199], a[8:11], 0
    v_mul_f32 v69, v69, |v69|
    v_add_u32 v51, 150528, v10
    v_mfma_f32_16x16x32_bf16 v[112:115], v[196:199], a[12:15], 0
    s_waitcnt lgkmcnt(2)
    v_mfma_f32_16x16x32_bf16 v[116:119], v[200:203], a[0:3], 0
    ds_read_b64_tr_b16 v[196:197], v16 offset:4096
    ds_read_b64_tr_b16 v[198:199], v16 offset:4608
    v_mfma_f32_16x16x32_bf16 v[120:123], v[200:203], a[4:7], 0
    v_mul_f32 v70, v70, |v70|
    v_mul_f32 v71, v71, |v71|
    v_mfma_f32_16x16x32_bf16 v[124:127], v[200:203], a[8:11], 0
    v_add_u32 v52, 296960, v10
    v_cvt_pk_bf16_f32 v164, v68, v69
    v_mfma_f32_16x16x32_bf16 v[128:131], v[200:203], a[12:15], 0
    s_waitcnt lgkmcnt(2)
    v_mfma_f32_16x16x32_bf16 v[100:103], v[204:207], a[16:19], v[100:103]
    ds_read_b64_tr_b16 v[200:201], v15 offset:8192
    ds_read_b64_tr_b16 v[202:203], v15 offset:8704
    v_mfma_f32_16x16x32_bf16 v[104:107], v[204:207], a[20:23], v[104:107]
    v_add_u32 v53, 443392, v10
    v_cvt_pk_bf16_f32 v165, v70, v71
    v_mfma_f32_16x16x32_bf16 v[108:111], v[204:207], a[24:27], v[108:111]
    v_pk_max_i16 v164, v164, 0
    v_mfma_f32_16x16x32_bf16 v[112:115], v[204:207], a[28:31], v[112:115]
    s_waitcnt lgkmcnt(2)
    v_mfma_f32_16x16x32_bf16 v[116:119], v[196:199], a[16:19], v[116:119]
    ds_read_b64_tr_b16 v[204:205], v16 offset:8192
    ds_read_b64_tr_b16 v[206:207], v16 offset:8704
    v_mfma_f32_16x16x32_bf16 v[120:123], v[196:199], a[20:23], v[120:123]
    v_add_u32 v54, 593920, v10
    v_pk_max_i16 v165, v165, 0
    v_mfma_f32_16x16x32_bf16 v[124:127], v[196:199], a[24:27], v[124:127]
    v_add_u32 v55, 740352, v10
    v_mul_f32 v84, v84, |v84|
    v_mfma_f32_16x16x32_bf16 v[128:131], v[196:199], a[28:31], v[128:131]
    s_waitcnt lgkmcnt(2)
    v_mfma_f32_16x16x32_bf16 v[100:103], v[200:203], a[32:35], v[100:103]
    ds_read_b64_tr_b16 v[196:197], v15 offset:12288
    ds_read_b64_tr_b16 v[198:199], v15 offset:12800
    v_mfma_f32_16x16x32_bf16 v[104:107], v[200:203], a[36:39], v[104:107]
    v_mul_f32 v85, v85, |v85|
    v_add_u32 v56, 886784, v10
    v_mfma_f32_16x16x32_bf16 v[108:111], v[200:203], a[40:43], v[108:111]
    v_mul_f32 v86, v86, |v86|
    v_mfma_f32_16x16x32_bf16 v[112:115], v[200:203], a[44:47], v[112:115]
    s_waitcnt lgkmcnt(2)
    v_mfma_f32_16x16x32_bf16 v[116:119], v[204:207], a[32:35], v[116:119]
    ds_read_b64_tr_b16 v[200:201], v16 offset:12288
    ds_read_b64_tr_b16 v[202:203], v16 offset:12800
    v_mfma_f32_16x16x32_bf16 v[120:123], v[204:207], a[36:39], v[120:123]
    v_mul_f32 v87, v87, |v87|
    v_add_u32 v57, 1033216, v10
    v_mfma_f32_16x16x32_bf16 v[124:127], v[204:207], a[40:43], v[124:127]
    v_cvt_pk_bf16_f32 v166, v84, v85
    v_add_u32 v58, 1183744, v10
    v_mfma_f32_16x16x32_bf16 v[128:131], v[204:207], a[44:47], v[128:131]
    s_waitcnt lgkmcnt(2)
    v_mfma_f32_16x16x32_bf16 v[100:103], v[196:199], a[48:51], v[100:103]
    ds_read_b64_tr_b16 v[204:205], v15 offset:16384
    ds_read_b64_tr_b16 v[206:207], v15 offset:16896
    v_mfma_f32_16x16x32_bf16 v[104:107], v[196:199], a[52:55], v[104:107]
    v_cvt_pk_bf16_f32 v167, v86, v87
    v_pk_max_i16 v166, v166, 0
    v_mfma_f32_16x16x32_bf16 v[108:111], v[196:199], a[56:59], v[108:111]
    s_lshl_b32 s40, s37, 1
    v_mfma_f32_16x16x32_bf16 v[112:115], v[196:199], a[60:63], v[112:115]
    s_waitcnt lgkmcnt(2)
    v_mfma_f32_16x16x32_bf16 v[116:119], v[200:203], a[48:51], v[116:119]
    ds_read_b64_tr_b16 v[196:197], v16 offset:16384
    ds_read_b64_tr_b16 v[198:199], v16 offset:16896
    v_mfma_f32_16x16x32_bf16 v[120:123], v[200:203], a[52:55], v[120:123]
    v_pk_max_i16 v167, v167, 0
    s_add_u32 m0, s41, 73728
    v_mfma_f32_16x16x32_bf16 v[124:127], v[200:203], a[56:59], v[124:127]
    s_add_u32 s79, s81, 16384
    buffer_store_dwordx4 v[164:167], v17, s[52:55], s79 offen offset:0 sc1
    s_xor_b32 s34, s65, 128
    v_mov_b32 v215, s34
    v_mfma_f32_16x16x32_bf16 v[128:131], v[200:203], a[60:63], v[128:131]
    s_waitcnt lgkmcnt(2)
    v_mfma_f32_16x16x32_bf16 v[100:103], v[204:207], a[64:67], v[100:103]
    ds_read_b64_tr_b16 v[200:201], v15 offset:20480
    ds_read_b64_tr_b16 v[202:203], v15 offset:20992
    v_mfma_f32_16x16x32_bf16 v[104:107], v[204:207], a[68:71], v[104:107]
    v_mul_f32 v72, v72, |v72|
    buffer_load_dwordx4 v50, s[92:95], s40 offen offset:0  lds
    v_mfma_f32_16x16x32_bf16 v[108:111], v[204:207], a[72:75], v[108:111]
    v_mul_f32 v73, v73, |v73|
    buffer_load_dwordx4 v51, s[92:95], s40 offen offset:1024  lds
    v_mfma_f32_16x16x32_bf16 v[112:115], v[204:207], a[76:79], v[112:115]
    s_waitcnt lgkmcnt(2)
    v_mfma_f32_16x16x32_bf16 v[116:119], v[196:199], a[64:67], v[116:119]
    ds_read_b64_tr_b16 v[204:205], v16 offset:20480
    ds_read_b64_tr_b16 v[206:207], v16 offset:20992
    v_mfma_f32_16x16x32_bf16 v[120:123], v[196:199], a[68:71], v[120:123]
    v_mul_f32 v74, v74, |v74|
    v_mul_f32 v75, v75, |v75|
    v_mfma_f32_16x16x32_bf16 v[124:127], v[196:199], a[72:75], v[124:127]
    buffer_load_dwordx4 v52, s[92:95], s40 offen offset:2048  lds
    v_mfma_f32_16x16x32_bf16 v[128:131], v[196:199], a[76:79], v[128:131]
    s_waitcnt lgkmcnt(2)
    v_mfma_f32_16x16x32_bf16 v[100:103], v[200:203], a[80:83], v[100:103]
    ds_read_b64_tr_b16 v[196:197], v15 offset:24576
    ds_read_b64_tr_b16 v[198:199], v15 offset:25088
    v_mfma_f32_16x16x32_bf16 v[104:107], v[200:203], a[84:87], v[104:107]
    v_cvt_pk_bf16_f32 v168, v72, v73
    buffer_load_dwordx4 v53, s[92:95], s40 offen offset:3072  lds
    v_mfma_f32_16x16x32_bf16 v[108:111], v[200:203], a[88:91], v[108:111]
    v_cvt_pk_bf16_f32 v169, v74, v75
    v_pk_max_i16 v168, v168, 0
    v_mfma_f32_16x16x32_bf16 v[112:115], v[200:203], a[92:95], v[112:115]
    s_waitcnt lgkmcnt(2)
    v_mfma_f32_16x16x32_bf16 v[116:119], v[204:207], a[80:83], v[116:119]
    ds_read_b64_tr_b16 v[200:201], v16 offset:24576
    ds_read_b64_tr_b16 v[202:203], v16 offset:25088
    v_mfma_f32_16x16x32_bf16 v[120:123], v[204:207], a[84:87], v[120:123]
    s_add_u32 m0, s41, 77824
    v_pk_max_i16 v169, v169, 0
    v_mfma_f32_16x16x32_bf16 v[124:127], v[204:207], a[88:91], v[124:127]
    buffer_load_dwordx4 v54, s[92:95], s40 offen offset:0  lds
    v_mfma_f32_16x16x32_bf16 v[128:131], v[204:207], a[92:95], v[128:131]
    s_waitcnt lgkmcnt(2)
    v_mfma_f32_16x16x32_bf16 v[100:103], v[196:199], a[96:99], v[100:103]
    ds_read_b64_tr_b16 v[204:205], v15 offset:28672
    ds_read_b64_tr_b16 v[206:207], v15 offset:29184
    v_mfma_f32_16x16x32_bf16 v[104:107], v[196:199], a[100:103], v[104:107]
    v_mul_f32 v88, v88, |v88|
    v_mul_f32 v89, v89, |v89|
    v_mfma_f32_16x16x32_bf16 v[108:111], v[196:199], a[104:107], v[108:111]
    buffer_load_dwordx4 v55, s[92:95], s40 offen offset:1024  lds
    v_mul_f32 v90, v90, |v90|
    v_mfma_f32_16x16x32_bf16 v[112:115], v[196:199], a[108:111], v[112:115]
    s_waitcnt lgkmcnt(2)
    v_mfma_f32_16x16x32_bf16 v[116:119], v[200:203], a[96:99], v[116:119]
    ds_read_b64_tr_b16 v[196:197], v16 offset:28672
    ds_read_b64_tr_b16 v[198:199], v16 offset:29184
    v_mfma_f32_16x16x32_bf16 v[120:123], v[200:203], a[100:103], v[120:123]
    v_mul_f32 v91, v91, |v91|
    buffer_load_dwordx4 v56, s[92:95], s40 offen offset:2048  lds
    v_mfma_f32_16x16x32_bf16 v[124:127], v[200:203], a[104:107], v[124:127]
    v_cvt_pk_bf16_f32 v170, v88, v89
    v_mfma_f32_16x16x32_bf16 v[128:131], v[200:203], a[108:111], v[128:131]
    s_waitcnt lgkmcnt(2)
    v_mfma_f32_16x16x32_bf16 v[100:103], v[204:207], a[112:115], v[100:103]
    ds_read_b64_tr_b16 v[200:201], v15 offset:32768
    ds_read_b64_tr_b16 v[202:203], v15 offset:33280
    v_mfma_f32_16x16x32_bf16 v[104:107], v[204:207], a[116:119], v[104:107]
    buffer_load_dwordx4 v57, s[92:95], s40 offen offset:3072  lds
    v_cvt_pk_bf16_f32 v171, v90, v91
    v_mfma_f32_16x16x32_bf16 v[108:111], v[204:207], a[120:123], v[108:111]
    v_pk_max_i16 v170, v170, 0
    s_add_u32 m0, s41, 81920
    v_mfma_f32_16x16x32_bf16 v[112:115], v[204:207], a[124:127], v[112:115]
    s_waitcnt lgkmcnt(2)
    v_mfma_f32_16x16x32_bf16 v[116:119], v[196:199], a[112:115], v[116:119]
    ds_read_b64_tr_b16 v[204:205], v16 offset:32768
    ds_read_b64_tr_b16 v[206:207], v16 offset:33280
    v_mfma_f32_16x16x32_bf16 v[120:123], v[196:199], a[116:119], v[120:123]
    v_pk_max_i16 v171, v171, 0
    buffer_load_dwordx4 v58, s[92:95], s40 offen offset:0  lds
    v_mfma_f32_16x16x32_bf16 v[124:127], v[196:199], a[120:123], v[124:127]
    buffer_store_dwordx4 v[168:171], v17, s[52:55], s79 offen offset:1024 sc1
    v_mfma_f32_16x16x32_bf16 v[128:131], v[196:199], a[124:127], v[128:131]
    s_waitcnt lgkmcnt(2)
    v_mfma_f32_16x16x32_bf16 v[100:103], v[200:203], a[128:131], v[100:103]
    s_waitcnt vmcnt(13)
    s_waitcnt vmcnt(12)
    v_mfma_f32_16x16x32_bf16 v[104:107], v[200:203], a[132:135], v[104:107]
    s_barrier
    s_cmp_lg_u32 s3, 0
    s_cbranch_scc1 L_w0_20
    v_mov_b32 v19, 3
    s_mov_b64 exec, 1
    buffer_store_dword v19, v18, s[52:55], s65 offen offset:0 sc1
    s_mov_b64 exec, -1
L_w0_20:
    v_mfma_f32_16x16x32_bf16 v[108:111], v[200:203], a[136:139], v[108:111]
    v_add_u32 v15, 0x9000, v15
    v_add_u32 v16, 0x9000, v16
    v_mfma_f32_16x16x32_bf16 v[112:115], v[200:203], a[140:143], v[112:115]
    ds_read_b64_tr_b16 v[196:197], v15 offset:0
    ds_read_b64_tr_b16 v[198:199], v15 offset:512
    s_waitcnt lgkmcnt(2)
    v_mfma_f32_16x16x32_bf16 v[116:119], v[204:207], a[128:131], v[116:119]
    ds_read_b64_tr_b16 v[200:201], v16 offset:0
    v_mfma_f32_16x16x32_bf16 v[120:123], v[204:207], a[132:135], v[120:123]
    ds_read_b64_tr_b16 v[202:203], v16 offset:512
    v_mfma_f32_16x16x32_bf16 v[124:127], v[204:207], a[136:139], v[124:127]
    v_mfma_f32_16x16x32_bf16 v[128:131], v[204:207], a[140:143], v[128:131]
    s_waitcnt lgkmcnt(2)
    v_mfma_f32_16x16x32_bf16 v[100:103], v[196:199], a[144:147], v[100:103]
    ds_read_b64_tr_b16 v[204:205], v15 offset:4096
    ds_read_b64_tr_b16 v[206:207], v15 offset:4608
    v_mfma_f32_16x16x32_bf16 v[104:107], v[196:199], a[148:151], v[104:107]
    v_mul_f32 v76, v76, |v76|
    v_add_u32 v50, s45, v14
    v_mfma_f32_16x16x32_bf16 v[108:111], v[196:199], a[152:155], v[108:111]
    v_lshrrev_b32 v4, 2, v1
    v_mul_f32 v77, v77, |v77|
    v_mfma_f32_16x16x32_bf16 v[112:115], v[196:199], a[156:159], v[112:115]
    v_and_b32 v5, 3, v1
    v_lshlrev_b32 v5, 3, v5
    s_waitcnt lgkmcnt(2)
    v_mfma_f32_16x16x32_bf16 v[116:119], v[200:203], a[144:147], v[116:119]
    ds_read_b64_tr_b16 v[196:197], v16 offset:4096
    ds_read_b64_tr_b16 v[198:199], v16 offset:4608
    v_mfma_f32_16x16x32_bf16 v[120:123], v[200:203], a[148:151], v[120:123]
    v_add_u32 v51, s46, v14
    v_mul_f32 v78, v78, |v78|
    v_mfma_f32_16x16x32_bf16 v[124:127], v[200:203], a[152:155], v[124:127]
    v_mul_f32 v79, v79, |v79|
    v_add_u32 v52, s47, v14
    v_mfma_f32_16x16x32_bf16 v[128:131], v[200:203], a[156:159], v[128:131]
    v_lshl_add_u32 v5, v4, 7, v5
    s_waitcnt lgkmcnt(2)
    v_mfma_f32_16x16x32_bf16 v[100:103], v[204:207], a[160:163], v[100:103]
    ds_read_b64_tr_b16 v[200:201], v15 offset:8192
    ds_read_b64_tr_b16 v[202:203], v15 offset:8704
    v_mfma_f32_16x16x32_bf16 v[104:107], v[204:207], a[164:167], v[104:107]
    v_cvt_pk_bf16_f32 v172, v76, v77
    v_bfe_u32 v6, v1, 3, 2
    v_mfma_f32_16x16x32_bf16 v[108:111], v[204:207], a[168:171], v[108:111]
    v_add_u32 v53, s66, v14
    v_cvt_pk_bf16_f32 v173, v78, v79
    v_mfma_f32_16x16x32_bf16 v[112:115], v[204:207], a[172:175], v[112:115]
    v_pk_max_i16 v172, v172, 0
    s_waitcnt lgkmcnt(2)
    v_mfma_f32_16x16x32_bf16 v[116:119], v[196:199], a[160:163], v[116:119]
    ds_read_b64_tr_b16 v[204:205], v16 offset:8192
    ds_read_b64_tr_b16 v[206:207], v16 offset:8704
    v_mfma_f32_16x16x32_bf16 v[120:123], v[196:199], a[164:167], v[120:123]
    v_add_u32 v54, s67, v14
    s_lshl_b32 s32, s42, 1
    v_xor_b32 v6, s32, v6
    v_mfma_f32_16x16x32_bf16 v[124:127], v[196:199], a[168:171], v[124:127]
    v_pk_max_i16 v173, v173, 0
    v_mul_f32 v92, v92, |v92|
    v_mfma_f32_16x16x32_bf16 v[128:131], v[196:199], a[172:175], v[128:131]
    v_add_u32 v55, s68, v14
    s_waitcnt lgkmcnt(2)
    v_mfma_f32_16x16x32_bf16 v[100:103], v[200:203], a[176:179], v[100:103]
    ds_read_b64_tr_b16 v[196:197], v15 offset:12288
    ds_read_b64_tr_b16 v[198:199], v15 offset:12800
    v_mfma_f32_16x16x32_bf16 v[104:107], v[200:203], a[180:183], v[104:107]
    v_lshl_add_u32 v5, v6, 5, v5
    v_mul_f32 v93, v93, |v93|
    v_mfma_f32_16x16x32_bf16 v[108:111], v[200:203], a[184:187], v[108:111]
    v_add_u32 v219, 110592, v5
    v_add_u32 v56, s69, v14
    v_mfma_f32_16x16x32_bf16 v[112:115], v[200:203], a[188:191], v[112:115]
    v_mul_f32 v94, v94, |v94|
    s_waitcnt lgkmcnt(2)
    v_mfma_f32_16x16x32_bf16 v[116:119], v[204:207], a[176:179], v[116:119]
    ds_read_b64_tr_b16 v[200:201], v16 offset:12288
    ds_read_b64_tr_b16 v[202:203], v16 offset:12800
    v_mfma_f32_16x16x32_bf16 v[120:123], v[204:207], a[180:183], v[120:123]
    v_mul_f32 v95, v95, |v95|
    v_add_u32 v57, s70, v14
    v_mfma_f32_16x16x32_bf16 v[124:127], v[204:207], a[184:187], v[124:127]
    v_xor_b32 v5, 32, v5
    v_cvt_pk_bf16_f32 v174, v92, v93
    v_mfma_f32_16x16x32_bf16 v[128:131], v[204:207], a[188:191], v[128:131]
    v_add_u32 v220, 110592, v5
    s_waitcnt lgkmcnt(2)
    v_mfma_f32_16x16x32_bf16 v[100:103], v[196:199], a[192:195], v[100:103]
    ds_read_b64_tr_b16 v[204:205], v15 offset:16384
    ds_read_b64_tr_b16 v[206:207], v15 offset:16896
    v_mfma_f32_16x16x32_bf16 v[104:107], v[196:199], a[196:199], v[104:107]
    v_add_u32 v58, s71, v14
    v_cvt_pk_bf16_f32 v175, v94, v95
    v_mfma_f32_16x16x32_bf16 v[108:111], v[196:199], a[200:203], v[108:111]
    v_pk_max_i16 v174, v174, 0
    s_add_u32 s40, s72, 512
    s_add_u32 s44, s73, 512
    v_mfma_f32_16x16x32_bf16 v[112:115], v[196:199], a[204:207], v[112:115]
    s_lshl_b32 s32, s42, 12
    s_xor_b32 s33, s32, 0x1000
    s_waitcnt lgkmcnt(2)
    v_mfma_f32_16x16x32_bf16 v[116:119], v[200:203], a[192:195], v[116:119]
    ds_read_b64_tr_b16 v[196:197], v16 offset:16384
    ds_read_b64_tr_b16 v[198:199], v16 offset:16896
    v_mfma_f32_16x16x32_bf16 v[120:123], v[200:203], a[196:199], v[120:123]
    v_pk_max_i16 v175, v175, 0
    v_add_u32 v10, s32, v219
    v_mfma_f32_16x16x32_bf16 v[124:127], v[200:203], a[200:203], v[124:127]
    s_add_u32 m0, s41, 110592
    buffer_store_dwordx4 v[172:175], v17, s[52:55], s79 offen offset:2048 sc1
    v_mfma_f32_16x16x32_bf16 v[128:131], v[200:203], a[204:207], v[128:131]
    s_waitcnt lgkmcnt(2)
    v_mfma_f32_16x16x32_bf16 v[100:103], v[204:207], a[208:211], v[100:103]
    ds_read_b64_tr_b16 v[200:201], v15 offset:20480
    ds_read_b64_tr_b16 v[202:203], v15 offset:20992
    v_mfma_f32_16x16x32_bf16 v[104:107], v[204:207], a[212:215], v[104:107]
    v_mul_f32 v80, v80, |v80|
    buffer_load_dwordx4 v50, s[60:63], s40 offen offset:0  lds
    v_mfma_f32_16x16x32_bf16 v[108:111], v[204:207], a[216:219], v[108:111]
    v_add_u32 v217, s33, v219
    v_mul_f32 v81, v81, |v81|
    v_mfma_f32_16x16x32_bf16 v[112:115], v[204:207], a[220:223], v[112:115]
    v_add_u32 v216, s32, v220
    s_waitcnt lgkmcnt(2)
    v_mfma_f32_16x16x32_bf16 v[116:119], v[196:199], a[208:211], v[116:119]
    ds_read_b64_tr_b16 v[204:205], v16 offset:20480
    ds_read_b64_tr_b16 v[206:207], v16 offset:20992
    v_mfma_f32_16x16x32_bf16 v[120:123], v[196:199], a[212:215], v[120:123]
    buffer_load_dwordx4 v51, s[60:63], s40 offen offset:1024  lds
    v_mul_f32 v82, v82, |v82|
    v_mfma_f32_16x16x32_bf16 v[124:127], v[196:199], a[216:219], v[124:127]
    v_mul_f32 v83, v83, |v83|
    buffer_load_dwordx4 v52, s[60:63], s40 offen offset:2048  lds
    v_mfma_f32_16x16x32_bf16 v[128:131], v[196:199], a[220:223], v[128:131]
    v_add_u32 v218, s33, v220
    s_waitcnt lgkmcnt(2)
    v_mfma_f32_16x16x32_bf16 v[100:103], v[200:203], a[224:227], v[100:103]
    ds_read_b64_tr_b16 v[196:197], v15 offset:24576
    ds_read_b64_tr_b16 v[198:199], v15 offset:25088
    v_mfma_f32_16x16x32_bf16 v[104:107], v[200:203], a[228:231], v[104:107]
    v_cvt_pk_bf16_f32 v176, v80, v81
    ds_write_b128 v8, v[132:135] offset:0
    v_mfma_f32_16x16x32_bf16 v[108:111], v[200:203], a[232:235], v[108:111]
    buffer_load_dwordx4 v53, s[60:63], s40 offen offset:3072  lds
    v_cvt_pk_bf16_f32 v177, v82, v83
    v_mfma_f32_16x16x32_bf16 v[112:115], v[200:203], a[236:239], v[112:115]
    v_pk_max_i16 v176, v176, 0
    s_waitcnt lgkmcnt(3)
    v_mfma_f32_16x16x32_bf16 v[116:119], v[204:207], a[224:227], v[116:119]
    ds_read_b64_tr_b16 v[200:201], v16 offset:24576
    ds_read_b64_tr_b16 v[202:203], v16 offset:25088
    v_mfma_f32_16x16x32_bf16 v[120:123], v[204:207], a[228:231], v[120:123]
    s_add_u32 m0, s41, 114688
    ds_write_b128 v8, v[136:139] offset:1024
    v_mfma_f32_16x16x32_bf16 v[124:127], v[204:207], a[232:235], v[124:127]
    v_pk_max_i16 v177, v177, 0
    v_mul_f32 v96, v96, |v96|
    v_mfma_f32_16x16x32_bf16 v[128:131], v[204:207], a[236:239], v[128:131]
    buffer_load_dwordx4 v54, s[60:63], s40 offen offset:0  lds
    s_waitcnt lgkmcnt(4)
    v_mfma_f32_16x16x32_bf16 v[100:103], v[196:199], a[240:243], v[100:103]
    ds_read_b64_tr_b16 v[204:205], v15 offset:28672
    ds_read_b64_tr_b16 v[206:207], v15 offset:29184
    v_mfma_f32_16x16x32_bf16 v[104:107], v[196:199], a[244:247], v[104:107]
    ds_write_b128 v8, v[140:143] offset:2048
    v_mul_f32 v97, v97, |v97|
    v_mfma_f32_16x16x32_bf16 v[108:111], v[196:199], a[248:251], v[108:111]
    ds_write_b128 v8, v[144:147] offset:3072
    buffer_load_dwordx4 v55, s[60:63], s44 offen offset:1024  lds
    v_mfma_f32_16x16x32_bf16 v[112:115], v[196:199], a[252:255], v[112:115]
    v_mul_f32 v98, v98, |v98|
    s_waitcnt lgkmcnt(5)
    v_mfma_f32_16x16x32_bf16 v[116:119], v[200:203], a[240:243], v[116:119]
    ds_read_b64_tr_b16 v[196:197], v16 offset:28672
    ds_read_b64_tr_b16 v[198:199], v16 offset:29184
    v_mfma_f32_16x16x32_bf16 v[120:123], v[200:203], a[244:247], v[120:123]
    v_mul_f32 v99, v99, |v99|
    buffer_load_dwordx4 v56, s[60:63], s44 offen offset:2048  lds
    v_mfma_f32_16x16x32_bf16 v[124:127], v[200:203], a[248:251], v[124:127]
    ds_write_b128 v8, v[148:151] offset:4096
    v_cvt_pk_bf16_f32 v178, v96, v97
    v_mfma_f32_16x16x32_bf16 v[128:131], v[200:203], a[252:255], v[128:131]
    ds_write_b128 v8, v[152:155] offset:5120
    s_waitcnt lgkmcnt(6)
    v_mfma_f32_16x16x32_bf16 v[100:103], v[204:207], v[24:27], v[100:103]
    ds_read_b64_tr_b16 v[200:201], v15 offset:32768
    ds_read_b64_tr_b16 v[202:203], v15 offset:33280
    v_mfma_f32_16x16x32_bf16 v[104:107], v[204:207], v[28:31], v[104:107]
    buffer_load_dwordx4 v57, s[60:63], s44 offen offset:3072  lds
    v_cvt_pk_bf16_f32 v179, v98, v99
    v_mfma_f32_16x16x32_bf16 v[108:111], v[204:207], v[32:35], v[108:111]
    v_pk_max_i16 v178, v178, 0
    s_add_u32 m0, s41, 118784
    v_mfma_f32_16x16x32_bf16 v[112:115], v[204:207], v[36:39], v[112:115]
    ds_write_b128 v8, v[156:159] offset:6144
    s_waitcnt lgkmcnt(5)
    v_mfma_f32_16x16x32_bf16 v[116:119], v[196:199], v[24:27], v[116:119]
    ds_read_b64_tr_b16 v[204:205], v16 offset:32768
    ds_read_b64_tr_b16 v[206:207], v16 offset:33280
    v_mfma_f32_16x16x32_bf16 v[120:123], v[196:199], v[28:31], v[120:123]
    v_pk_max_i16 v179, v179, 0
    ds_write_b128 v8, v[160:163] offset:7168
    v_mfma_f32_16x16x32_bf16 v[124:127], v[196:199], v[32:35], v[124:127]
    buffer_load_dwordx4 v58, s[60:63], s44 offen offset:0  lds
    buffer_store_dwordx4 v[176:179], v17, s[52:55], s79 offen offset:3072 sc1
    v_mfma_f32_16x16x32_bf16 v[128:131], v[196:199], v[36:39], v[128:131]
    s_waitcnt lgkmcnt(4)
    v_mfma_f32_16x16x32_bf16 v[100:103], v[200:203], v[40:43], v[100:103]
    s_waitcnt vmcnt(12)
    s_barrier
    v_mfma_f32_16x16x32_bf16 v[104:107], v[200:203], v[44:47], v[104:107]
    ds_read_b64_tr_b16 v[196:197], v20 offset:0
    ds_read_b64_tr_b16 v[198:199], v20 offset:256
    v_mfma_f32_16x16x32_bf16 v[108:111], v[200:203], v[60:63], v[108:111]
    s_add_u32 s32, s38, 3
    s_and_b32 s32, s32, 3
    s_lshl_b32 s32, s32, 6
    s_add_u32 s32, s32, s36
    s_lshl_b32 s32, s32, 3
    v_add_u32 v7, s32, v21
    ds_read_b64 v[208:209], v7 offset:0
    v_mfma_f32_16x16x32_bf16 v[112:115], v[200:203], v[64:67], v[112:115]
    ds_read_b64 v[210:211], v7 offset:128
    s_waitcnt lgkmcnt(5)
    v_mfma_f32_16x16x32_bf16 v[116:119], v[204:207], v[40:43], v[116:119]
    ds_read_b64_tr_b16 v[200:201], v20 offset:2048
    v_mfma_f32_16x16x32_bf16 v[120:123], v[204:207], v[44:47], v[120:123]
    ds_read_b64_tr_b16 v[202:203], v20 offset:2304
    v_mfma_f32_16x16x32_bf16 v[124:127], v[204:207], v[60:63], v[124:127]
    v_mfma_f32_16x16x32_bf16 v[128:131], v[204:207], v[64:67], v[128:131]
    s_waitcnt lgkmcnt(2)
    v_mfma_f32_16x16x4bf16_1k v[100:115], v[208:209], v[22:23], v[100:115]
    s_nop 3
    v_mfma_f32_16x16x4bf16_1k v[116:131], v[210:211], v[22:23], v[116:131]
    v_mfma_f32_16x16x32_bf16 v[68:71], v[196:199], a[0:3], 0
    ds_read_b64_tr_b16 v[204:205], v20 offset:4096
    ds_read_b64_tr_b16 v[206:207], v20 offset:4352
    v_mfma_f32_16x16x32_bf16 v[72:75], v[196:199], a[4:7], 0
    s_nop 2
    v_mul_f32 v100, v100, |v100|
    v_mul_f32 v101, v101, |v101|
    v_mfma_f32_16x16x32_bf16 v[76:79], v[196:199], a[8:11], 0
    s_add_u32 s44, s38, 0
    s_and_b32 s44, s44, 3
    s_lshl_b32 s44, s44, 7
    v_mul_f32 v102, v102, |v102|
    v_mfma_f32_16x16x32_bf16 v[80:83], v[196:199], a[12:15], 0
    v_mul_f32 v103, v103, |v103|
    v_cvt_pk_bf16_f32 v180, v100, v101
    s_waitcnt lgkmcnt(2)
    v_mfma_f32_16x16x32_bf16 v[68:71], v[200:203], a[16:19], v[68:71]
    ds_read_b64_tr_b16 v[196:197], v20 offset:6144
    ds_read_b64_tr_b16 v[198:199], v20 offset:6400
    v_mfma_f32_16x16x32_bf16 v[72:75], v[200:203], a[20:23], v[72:75]
    v_cvt_pk_bf16_f32 v181, v102, v103
    v_pk_max_i16 v180, v180, 0
    v_mfma_f32_16x16x32_bf16 v[76:79], v[200:203], a[24:27], v[76:79]
    s_add_u32 s44, s44, s39
    s_add_u32 s40, s44, s72
    s_add_u32 s44, s44, s73
    v_pk_max_i16 v181, v181, 0
    v_mfma_f32_16x16x32_bf16 v[80:83], v[200:203], a[28:31], v[80:83]
    v_mul_f32 v116, v116, |v116|
    s_waitcnt lgkmcnt(2)
    v_mfma_f32_16x16x32_bf16 v[68:71], v[204:207], a[32:35], v[68:71]
    buffer_load_dword v9, v215, s[52:55], 0 offen sc1
    ds_read_b64_tr_b16 v[200:201], v20 offset:8192
    v_mfma_f32_16x16x32_bf16 v[72:75], v[204:207], a[36:39], v[72:75]
    ds_read_b64_tr_b16 v[202:203], v20 offset:8448
    v_mul_f32 v117, v117, |v117|
    v_mfma_f32_16x16x32_bf16 v[76:79], v[204:207], a[40:43], v[76:79]
    v_mul_f32 v118, v118, |v118|
    v_mul_f32 v119, v119, |v119|
    v_mfma_f32_16x16x32_bf16 v[80:83], v[204:207], a[44:47], v[80:83]
    s_add_u32 m0, s41, 36864
    v_cvt_pk_bf16_f32 v182, v116, v117
    s_waitcnt lgkmcnt(2)
    v_mfma_f32_16x16x32_bf16 v[68:71], v[196:199], a[48:51], v[68:71]
    ds_read_b64_tr_b16 v[204:205], v20 offset:10240
    ds_read_b64_tr_b16 v[206:207], v20 offset:10496
    v_mfma_f32_16x16x32_bf16 v[72:75], v[196:199], a[52:55], v[72:75]
    v_cvt_pk_bf16_f32 v183, v118, v119
    v_pk_max_i16 v182, v182, 0
    v_mfma_f32_16x16x32_bf16 v[76:79], v[196:199], a[56:59], v[76:79]
    v_pk_max_i16 v183, v183, 0
    s_add_u32 s79, s81, 24576
    buffer_store_dwordx4 v[180:183], v17, s[52:55], s79 offen offset:0 sc1
    v_mfma_f32_16x16x32_bf16 v[80:83], v[196:199], a[60:63], v[80:83]
    buffer_load_dwordx4 v50, s[60:63], s40 offen offset:0  lds
    s_waitcnt lgkmcnt(2)
    v_mfma_f32_16x16x32_bf16 v[68:71], v[200:203], a[64:67], v[68:71]
    ds_read_b64_tr_b16 v[196:197], v20 offset:12288
    ds_read_b64_tr_b16 v[198:199], v20 offset:12544
    v_mfma_f32_16x16x32_bf16 v[72:75], v[200:203], a[68:71], v[72:75]
    v_mul_f32 v104, v104, |v104|
    v_mul_f32 v105, v105, |v105|
    v_mfma_f32_16x16x32_bf16 v[76:79], v[200:203], a[72:75], v[76:79]
    v_mul_f32 v106, v106, |v106|
    v_mul_f32 v107, v107, |v107|
    v_mfma_f32_16x16x32_bf16 v[80:83], v[200:203], a[76:79], v[80:83]
    v_cvt_pk_bf16_f32 v184, v104, v105
    s_waitcnt lgkmcnt(2)
    v_mfma_f32_16x16x32_bf16 v[68:71], v[204:207], a[80:83], v[68:71]
    ds_read_b64_tr_b16 v[200:201], v20 offset:14336
    ds_read_b64_tr_b16 v[202:203], v20 offset:14592
    v_mfma_f32_16x16x32_bf16 v[72:75], v[204:207], a[84:87], v[72:75]
    buffer_load_dwordx4 v51, s[60:63], s40 offen offset:1024  lds
    v_cvt_pk_bf16_f32 v185, v106, v107
    v_mfma_f32_16x16x32_bf16 v[76:79], v[204:207], a[88:91], v[76:79]
    v_pk_max_i16 v184, v184, 0
    v_pk_max_i16 v185, v185, 0
    v_mfma_f32_16x16x32_bf16 v[80:83], v[204:207], a[92:95], v[80:83]
    v_mul_f32 v120, v120, |v120|
    s_waitcnt lgkmcnt(2)
    v_mfma_f32_16x16x32_bf16 v[68:71], v[196:199], a[96:99], v[68:71]
    ds_read_b64_tr_b16 v[204:205], v20 offset:16384
    ds_read_b64_tr_b16 v[206:207], v20 offset:16640
    v_mfma_f32_16x16x32_bf16 v[72:75], v[196:199], a[100:103], v[72:75]
    v_mul_f32 v121, v121, |v121|
    buffer_load_dwordx4 v52, s[60:63], s40 offen offset:2048  lds
    v_mfma_f32_16x16x32_bf16 v[76:79], v[196:199], a[104:107], v[76:79]
    v_mul_f32 v122, v122, |v122|
    v_mul_f32 v123, v123, |v123|
    v_mfma_f32_16x16x32_bf16 v[80:83], v[196:199], a[108:111], v[80:83]
    v_cvt_pk_bf16_f32 v186, v120, v121
    s_waitcnt lgkmcnt(2)
    v_mfma_f32_16x16x32_bf16 v[68:71], v[200:203], a[112:115], v[68:71]
    ds_read_b64_tr_b16 v[196:197], v20 offset:18432
    ds_read_b64_tr_b16 v[198:199], v20 offset:18688
    v_mfma_f32_16x16x32_bf16 v[72:75], v[200:203], a[116:119], v[72:75]
    v_cvt_pk_bf16_f32 v187, v122, v123
    v_pk_max_i16 v186, v186, 0
    v_mfma_f32_16x16x32_bf16 v[76:79], v[200:203], a[120:123], v[76:79]
    buffer_load_dwordx4 v53, s[60:63], s40 offen offset:3072  lds
    v_pk_max_i16 v187, v187, 0
    v_mfma_f32_16x16x32_bf16 v[80:83], v[200:203], a[124:127], v[80:83]
    buffer_store_dwordx4 v[184:187], v17, s[52:55], s79 offen offset:1024 sc1
    s_waitcnt lgkmcnt(2)
    v_mfma_f32_16x16x32_bf16 v[68:71], v[204:207], a[128:131], v[68:71]
    ds_read_b64_tr_b16 v[200:201], v20 offset:20480
    ds_read_b64_tr_b16 v[202:203], v20 offset:20736
    v_mfma_f32_16x16x32_bf16 v[72:75], v[204:207], a[132:135], v[72:75]
    v_mul_f32 v108, v108, |v108|
    v_mul_f32 v109, v109, |v109|
    v_mfma_f32_16x16x32_bf16 v[76:79], v[204:207], a[136:139], v[76:79]
    s_add_u32 m0, s41, 40960
    v_mul_f32 v110, v110, |v110|
    v_mfma_f32_16x16x32_bf16 v[80:83], v[204:207], a[140:143], v[80:83]
    v_mul_f32 v111, v111, |v111|
    v_cvt_pk_bf16_f32 v188, v108, v109
    s_waitcnt lgkmcnt(2)
    v_mfma_f32_16x16x32_bf16 v[68:71], v[196:199], a[144:147], v[68:71]
    ds_read_b64_tr_b16 v[204:205], v20 offset:22528
    ds_read_b64_tr_b16 v[206:207], v20 offset:22784
    v_mfma_f32_16x16x32_bf16 v[72:75], v[196:199], a[148:151], v[72:75]
    v_cvt_pk_bf16_f32 v189, v110, v111
    v_pk_max_i16 v188, v188, 0
    v_mfma_f32_16x16x32_bf16 v[76:79], v[196:199], a[152:155], v[76:79]
    buffer_load_dwordx4 v54, s[60:63], s40 offen offset:0  lds
    v_pk_max_i16 v189, v189, 0
    v_mfma_f32_16x16x32_bf16 v[80:83], v[196:199], a[156:159], v[80:83]
    v_mul_f32 v124, v124, |v124|
    s_waitcnt lgkmcnt(2)
    v_mfma_f32_16x16x32_bf16 v[68:71], v[200:203], a[160:163], v[68:71]
    ds_read_b64_tr_b16 v[196:197], v20 offset:24576
    ds_read_b64_tr_b16 v[198:199], v20 offset:24832
    v_mfma_f32_16x16x32_bf16 v[72:75], v[200:203], a[164:167], v[72:75]
    v_mul_f32 v125, v125, |v125|
    v_mul_f32 v126, v126, |v126|
    v_mfma_f32_16x16x32_bf16 v[76:79], v[200:203], a[168:171], v[76:79]
    v_mul_f32 v127, v127, |v127|
    buffer_load_dwordx4 v55, s[60:63], s44 offen offset:1024  lds
    v_mfma_f32_16x16x32_bf16 v[80:83], v[200:203], a[172:175], v[80:83]
    v_cvt_pk_bf16_f32 v190, v124, v125
    s_waitcnt lgkmcnt(2)
    v_mfma_f32_16x16x32_bf16 v[68:71], v[204:207], a[176:179], v[68:71]
    ds_read_b64_tr_b16 v[200:201], v20 offset:26624
    ds_read_b64_tr_b16 v[202:203], v20 offset:26880
    v_mfma_f32_16x16x32_bf16 v[72:75], v[204:207], a[180:183], v[72:75]
    v_cvt_pk_bf16_f32 v191, v126, v127
    v_pk_max_i16 v190, v190, 0
    v_mfma_f32_16x16x32_bf16 v[76:79], v[204:207], a[184:187], v[76:79]
    v_pk_max_i16 v191, v191, 0
    buffer_store_dwordx4 v[188:191], v17, s[52:55], s79 offen offset:2048 sc1
    v_mfma_f32_16x16x32_bf16 v[80:83], v[204:207], a[188:191], v[80:83]
    buffer_load_dwordx4 v56, s[60:63], s44 offen offset:2048  lds
    s_waitcnt lgkmcnt(2)
    v_mfma_f32_16x16x32_bf16 v[68:71], v[196:199], a[192:195], v[68:71]
    ds_read_b64_tr_b16 v[204:205], v20 offset:28672
    ds_read_b64_tr_b16 v[206:207], v20 offset:28928
    v_mfma_f32_16x16x32_bf16 v[72:75], v[196:199], a[196:199], v[72:75]
    v_mul_f32 v112, v112, |v112|
    v_mul_f32 v113, v113, |v113|
    v_mfma_f32_16x16x32_bf16 v[76:79], v[196:199], a[200:203], v[76:79]
    v_mul_f32 v114, v114, |v114|
    v_mul_f32 v115, v115, |v115|
    v_mfma_f32_16x16x32_bf16 v[80:83], v[196:199], a[204:207], v[80:83]
    v_cvt_pk_bf16_f32 v192, v112, v113
    s_waitcnt lgkmcnt(2)
    v_mfma_f32_16x16x32_bf16 v[68:71], v[200:203], a[208:211], v[68:71]
    ds_read_b64_tr_b16 v[196:197], v20 offset:30720
    ds_read_b64_tr_b16 v[198:199], v20 offset:30976
    v_mfma_f32_16x16x32_bf16 v[72:75], v[200:203], a[212:215], v[72:75]
    buffer_load_dwordx4 v57, s[60:63], s44 offen offset:3072  lds
    v_cvt_pk_bf16_f32 v193, v114, v115
    v_mfma_f32_16x16x32_bf16 v[76:79], v[200:203], a[216:219], v[76:79]
    v_pk_max_i16 v192, v192, 0
    v_pk_max_i16 v193, v193, 0
    v_mfma_f32_16x16x32_bf16 v[80:83], v[200:203], a[220:223], v[80:83]
    v_mul_f32 v128, v128, |v128|
    s_waitcnt lgkmcnt(2)
    v_mfma_f32_16x16x32_bf16 v[68:71], v[204:207], a[224:227], v[68:71]
    ds_read_b64_tr_b16 v[200:201], v20 offset:32768
    ds_read_b64_tr_b16 v[202:203], v20 offset:33024
    v_mfma_f32_16x16x32_bf16 v[72:75], v[204:207], a[228:231], v[72:75]
    v_mul_f32 v129, v129, |v129|
    s_add_u32 m0, s41, 45056
    v_mfma_f32_16x16x32_bf16 v[76:79], v[204:207], a[232:235], v[76:79]
    v_mul_f32 v130, v130, |v130|
    v_mul_f32 v131, v131, |v131|
    v_mfma_f32_16x16x32_bf16 v[80:83], v[204:207], a[236:239], v[80:83]
    v_cvt_pk_bf16_f32 v194, v128, v129
    s_waitcnt lgkmcnt(2)
    v_mfma_f32_16x16x32_bf16 v[68:71], v[196:199], a[240:243], v[68:71]
    ds_read_b64_tr_b16 v[204:205], v20 offset:34816
    ds_read_b64_tr_b16 v[206:207], v20 offset:35072
    v_mfma_f32_16x16x32_bf16 v[72:75], v[196:199], a[244:247], v[72:75]
    v_cvt_pk_bf16_f32 v195, v130, v131
    v_pk_max_i16 v194, v194, 0
    v_mfma_f32_16x16x32_bf16 v[76:79], v[196:199], a[248:251], v[76:79]
    buffer_load_dwordx4 v58, s[60:63], s44 offen offset:0  lds
    v_pk_max_i16 v195, v195, 0
    v_mfma_f32_16x16x32_bf16 v[80:83], v[196:199], a[252:255], v[80:83]
    buffer_store_dwordx4 v[192:195], v17, s[52:55], s79 offen offset:3072 sc1
    s_waitcnt lgkmcnt(2)
    v_mfma_f32_16x16x32_bf16 v[68:71], v[200:203], v[24:27], v[68:71]
    s_waitcnt vmcnt(15)
    v_mfma_f32_16x16x32_bf16 v[72:75], v[200:203], v[28:31], v[72:75]
    s_barrier
    ds_read_b64_tr_b16 v[196:197], v10 offset:0
    v_mfma_f32_16x16x32_bf16 v[76:79], v[200:203], v[32:35], v[76:79]
    ds_read_b64_tr_b16 v[198:199], v10 offset:2048
    s_lshl_b32 s32, s42, 7
    s_lshl_b32 s33, s37, 3
    s_sub_u32 s32, s33, s32
    v_add_u32 v7, s32, v21
    v_mfma_f32_16x16x32_bf16 v[80:83], v[200:203], v[36:39], v[80:83]
    ds_read_b64 v[208:209], v7 offset:0
    s_waitcnt lgkmcnt(3)
    v_mfma_f32_16x16x32_bf16 v[68:71], v[204:207], v[40:43], v[68:71]
    ds_read_b64_tr_b16 v[200:201], v216 offset:0
    v_mfma_f32_16x16x32_bf16 v[72:75], v[204:207], v[44:47], v[72:75]
    ds_read_b64_tr_b16 v[202:203], v216 offset:2048
    v_mfma_f32_16x16x32_bf16 v[76:79], v[204:207], v[60:63], v[76:79]
    v_mfma_f32_16x16x32_bf16 v[80:83], v[204:207], v[64:67], v[80:83]
    s_waitcnt lgkmcnt(2)
    s_nop 4
    v_mfma_f32_16x16x4bf16_1k v[68:83], v[208:209], v[22:23], v[68:83]
    v_mfma_f32_16x16x32_bf16 v[100:103], v[196:199], v[132:135], 0
    s_waitcnt vmcnt(13)
    v_cmp_gt_u32 vcc, 3, v9
    s_cbranch_vccz L_pollx_22
    s_mov_b32 s35, 0
L_poll_21:
    s_add_u32 s35, s35, 1
    s_cmp_gt_u32 s35, 400000
    s_cbranch_scc1 L_pollx_22
    buffer_load_dword v9, v215, s[52:55], 0 offen sc1
    s_waitcnt vmcnt(0)
    v_cmp_gt_u32 vcc, 3, v9
    s_cbranch_vccnz L_poll_21
L_pollx_22:
    ds_read_b64_tr_b16 v[204:205], v10 offset:8192
    ds_read_b64_tr_b16 v[206:207], v10 offset:10240
    v_mfma_f32_16x16x32_bf16 v[104:107], v[196:199], v[136:139], 0
    ds_read_b128 a[0:3], v49 offset:0
    ds_read_b128 a[4:7], v49 offset:1024
    ds_read_b128 a[8:11], v49 offset:2048
    v_mfma_f32_16x16x32_bf16 v[108:111], v[196:199], v[140:143], 0
    ds_read_b128 a[12:15], v49 offset:3072
    ds_read_b128 a[16:19], v49 offset:4096
    ds_read_b128 a[20:23], v49 offset:5120
    v_mfma_f32_16x16x32_bf16 v[112:115], v[196:199], v[144:147], 0
    s_add_u32 s83, s82, 0
    buffer_load_dwordx4 a[80:83], v17, s[52:55], s83 offen offset:0 sc1
    s_waitcnt lgkmcnt(8)
    v_mfma_f32_16x16x32_bf16 v[116:119], v[200:203], v[132:135], 0
    ds_read_b64_tr_b16 v[196:197], v216 offset:8192
    ds_read_b64_tr_b16 v[198:199], v216 offset:10240
    v_mfma_f32_16x16x32_bf16 v[120:123], v[200:203], v[136:139], 0
    ds_read_b128 a[24:27], v49 offset:6144
    ds_read_b128 a[28:31], v49 offset:7168
    v_mfma_f32_16x16x32_bf16 v[124:127], v[200:203], v[140:143], 0
    v_add_u32 v8, 0x12000, v8
    v_add_u32 v49, 0x12000, v49
    ds_write_b128 v8, v[164:167] offset:0
    v_mfma_f32_16x16x32_bf16 v[128:131], v[200:203], v[144:147], 0
    v_mul_f32 v68, v68, |v68|
    buffer_load_dwordx4 a[84:87], v17, s[52:55], s83 offen offset:1024 sc1
    s_waitcnt lgkmcnt(11)
    v_mfma_f32_16x16x32_bf16 v[100:103], v[204:207], v[148:151], v[100:103]
    ds_read_b64_tr_b16 v[200:201], v10 offset:16384
    ds_read_b64_tr_b16 v[202:203], v10 offset:18432
    v_mfma_f32_16x16x32_bf16 v[104:107], v[204:207], v[152:155], v[104:107]
    v_mul_f32 v69, v69, |v69|
    v_mul_f32 v70, v70, |v70|
    v_mfma_f32_16x16x32_bf16 v[108:111], v[204:207], v[156:159], v[108:111]
    v_mul_f32 v71, v71, |v71|
    ds_write_b128 v8, v[168:171] offset:1024
    v_mfma_f32_16x16x32_bf16 v[112:115], v[204:207], v[160:163], v[112:115]
    v_cvt_pk_bf16_f32 v20, v68, v69
    buffer_load_dwordx4 a[88:91], v17, s[52:55], s83 offen offset:2048 sc1
    s_waitcnt lgkmcnt(6)
    v_mfma_f32_16x16x32_bf16 v[116:119], v[196:199], v[148:151], v[116:119]
    ds_read_b64_tr_b16 v[204:205], v216 offset:16384
    ds_read_b64_tr_b16 v[206:207], v216 offset:18432
    v_cvt_pk_bf16_f32 v21, v70, v71
    v_mfma_f32_16x16x32_bf16 v[120:123], v[196:199], v[152:155], v[120:123]
    v_pk_max_i16 v20, v20, 0
    v_pk_max_i16 v21, v21, 0
    ds_write_b64 v59, v[20:21] offset:0
    v_mfma_f32_16x16x32_bf16 v[124:127], v[196:199], v[156:159], v[124:127]
    ds_write_b128 v8, v[172:175] offset:2048
    v_mul_f32 v72, v72, |v72|
    buffer_load_dwordx4 a[92:95], v17, s[52:55], s83 offen offset:3072 sc1
    v_mfma_f32_16x16x32_bf16 v[128:131], v[196:199], v[160:163], v[128:131]
    s_waitcnt lgkmcnt(5)
    v_mfma_f32_16x16x32_bf16 v[100:103], v[200:203], v[164:167], v[100:103]
    ds_read_b64_tr_b16 v[196:197], v10 offset:24576
    ds_read_b64_tr_b16 v[198:199], v10 offset:26624
    v_mfma_f32_16x16x32_bf16 v[104:107], v[200:203], v[168:171], v[104:107]
    v_mul_f32 v73, v73, |v73|
    v_mul_f32 v74, v74, |v74|
    v_mfma_f32_16x16x32_bf16 v[108:111], v[200:203], v[172:175], v[108:111]
    v_mul_f32 v75, v75, |v75|
    ds_write_b128 v8, v[176:179] offset:3072
    v_mfma_f32_16x16x32_bf16 v[112:115], v[200:203], v[176:179], v[112:115]
    v_cvt_pk_bf16_f32 v22, v72, v73
    s_add_u32 s83, s82, 4096
    buffer_load_dwordx4 a[96:99], v17, s[52:55], s83 offen offset:0 sc1
    s_waitcnt lgkmcnt(5)
    v_mfma_f32_16x16x32_bf16 v[116:119], v[204:207], v[164:167], v[116:119]
    ds_read_b64_tr_b16 v[200:201], v216 offset:24576
    ds_read_b64_tr_b16 v[202:203], v216 offset:26624
    v_mfma_f32_16x16x32_bf16 v[120:123], v[204:207], v[168:171], v[120:123]
    v_cvt_pk_bf16_f32 v23, v74, v75
    v_pk_max_i16 v22, v22, 0
    v_mfma_f32_16x16x32_bf16 v[124:127], v[204:207], v[172:175], v[124:127]
    v_pk_max_i16 v23, v23, 0
    ds_write_b64 v59, v[22:23] offset:1024
    v_mfma_f32_16x16x32_bf16 v[128:131], v[204:207], v[176:179], v[128:131]
    ds_write_b128 v8, v[180:183] offset:4096
    buffer_load_dwordx4 a[100:103], v17, s[52:55], s83 offen offset:1024 sc1
    s_waitcnt lgkmcnt(5)
    v_mfma_f32_16x16x32_bf16 v[100:103], v[196:199], v[180:183], v[100:103]
    ds_read_b64_tr_b16 v[204:205], v217 offset:0
    ds_read_b64_tr_b16 v[206:207], v217 offset:2048
    v_mul_f32 v76, v76, |v76|
    v_mfma_f32_16x16x32_bf16 v[104:107], v[196:199], v[184:187], v[104:107]
    v_mul_f32 v77, v77, |v77|
    v_mul_f32 v78, v78, |v78|
    v_mul_f32 v79, v79, |v79|
    v_mfma_f32_16x16x32_bf16 v[108:111], v[196:199], v[188:191], v[108:111]
    ds_write_b128 v8, v[184:187] offset:5120
    v_cvt_pk_bf16_f32 v24, v76, v77
    buffer_load_dwordx4 a[104:107], v17, s[52:55], s83 offen offset:2048 sc1
    v_mfma_f32_16x16x32_bf16 v[112:115], v[196:199], v[192:195], v[112:115]
    s_waitcnt lgkmcnt(5)
    v_mfma_f32_16x16x32_bf16 v[116:119], v[200:203], v[180:183], v[116:119]
    ds_read_b64_tr_b16 v[196:197], v218 offset:0
    ds_read_b64_tr_b16 v[198:199], v218 offset:2048
    v_mfma_f32_16x16x32_bf16 v[120:123], v[200:203], v[184:187], v[120:123]
    v_cvt_pk_bf16_f32 v25, v78, v79
    v_pk_max_i16 v24, v24, 0
    v_mfma_f32_16x16x32_bf16 v[124:127], v[200:203], v[188:191], v[124:127]
    v_pk_max_i16 v25, v25, 0
    ds_write_b64 v59, v[24:25] offset:2048
    v_mfma_f32_16x16x32_bf16 v[128:131], v[200:203], v[192:195], v[128:131]
    ds_write_b128 v8, v[188:191] offset:6144
    buffer_load_dwordx4 a[108:111], v17, s[52:55], s83 offen offset:3072 sc1
    s_waitcnt lgkmcnt(5)
    v_mfma_f32_16x16x32_bf16 v[100:103], v[204:207], a[0:3], v[100:103]
    ds_read_b64_tr_b16 v[200:201], v217 offset:8192
    ds_read_b64_tr_b16 v[202:203], v217 offset:10240
    v_mfma_f32_16x16x32_bf16 v[104:107], v[204:207], a[4:7], v[104:107]
    v_mul_f32 v80, v80, |v80|
    v_mul_f32 v81, v81, |v81|
    v_mfma_f32_16x16x32_bf16 v[108:111], v[204:207], a[8:11], v[108:111]
    v_mul_f32 v82, v82, |v82|
    v_mul_f32 v83, v83, |v83|
    v_mfma_f32_16x16x32_bf16 v[112:115], v[204:207], a[12:15], v[112:115]
    ds_write_b128 v8, v[192:195] offset:7168
    s_waitcnt lgkmcnt(5)
    v_mfma_f32_16x16x32_bf16 v[116:119], v[196:199], a[0:3], v[116:119]
    ds_read_b64_tr_b16 v[204:205], v218 offset:8192
    ds_read_b64_tr_b16 v[206:207], v218 offset:10240
    v_mfma_f32_16x16x32_bf16 v[120:123], v[196:199], a[4:7], v[120:123]
    v_cvt_pk_bf16_f32 v26, v80, v81
    v_cvt_pk_bf16_f32 v27, v82, v83
    v_mfma_f32_16x16x32_bf16 v[124:127], v[196:199], a[8:11], v[124:127]
    v_pk_max_i16 v26, v26, 0
    v_pk_max_i16 v27, v27, 0
    v_mfma_f32_16x16x32_bf16 v[128:131], v[196:199], a[12:15], v[128:131]
    ds_write_b64 v59, v[26:27] offset:3072
    s_waitcnt lgkmcnt(4)
    v_mfma_f32_16x16x32_bf16 v[100:103], v[200:203], a[16:19], v[100:103]
    s_waitcnt lgkmcnt(0)
    s_barrier
    ds_read_b64_tr_b16 v[196:197], v217 offset:16384
    v_mfma_f32_16x16x32_bf16 v[104:107], v[200:203], a[20:23], v[104:107]
    ds_read_b64_tr_b16 v[198:199], v217 offset:18432
    ds_read_b128 a[32:35], v49 offset:0
    ds_read_b128 a[36:39], v49 offset:1024
    v_mfma_f32_16x16x32_bf16 v[108:111], v[200:203], a[24:27], v[108:111]
    ds_read_b128 a[40:43], v49 offset:2048
    ds_read_b128 a[44:47], v49 offset:3072
    ds_read_b128 a[48:51], v49 offset:4096
    v_mfma_f32_16x16x32_bf16 v[112:115], v[200:203], a[28:31], v[112:115]
    s_add_u32 s44, s38, 1
    s_and_b32 s44, s44, 3
    s_lshl_b32 s44, s44, 7
    s_add_u32 s44, s44, s39
    s_add_u32 s40, s44, s72
    s_add_u32 s44, s44, s73
    v_mfma_f32_16x16x32_bf16 v[116:119], v[204:207], a[16:19], v[116:119]
    ds_read_b64_tr_b16 v[200:201], v218 offset:16384
    ds_read_b64_tr_b16 v[202:203], v218 offset:18432
    ds_read_b128 a[52:55], v49 offset:5120
    v_mfma_f32_16x16x32_bf16 v[120:123], v[204:207], a[20:23], v[120:123]
    ds_read_b128 a[56:59], v49 offset:6144
    ds_read_b128 a[60:63], v49 offset:7168
    s_lshl_b32 s32, s42, 11
    v_add_u32 v59, s32, v212
    ds_read_b128 v[20:23], v59
    v_mfma_f32_16x16x32_bf16 v[124:127], v[204:207], a[24:27], v[124:127]
    ds_read_b128 v[24:27], v59 offset:1024
    s_add_u32 m0, s41, 0
    s_nop 0
    buffer_load_dwordx4 v50, s[60:63], s40 offen offset:0  lds
    v_mfma_f32_16x16x32_bf16 v[128:131], v[204:207], a[28:31], v[128:131]
    s_waitcnt lgkmcnt(12)
    s_waitcnt lgkmcnt(8)
    v_mfma_f32_16x16x32_bf16 v[100:103], v[196:199], a[32:35], v[100:103]
    ds_read_b64_tr_b16 v[204:205], v217 offset:24576
    ds_read_b64_tr_b16 v[206:207], v217 offset:26624
    v_mfma_f32_16x16x32_bf16 v[104:107], v[196:199], a[36:39], v[104:107]
    ds_read_b128 a[64:67], v212 offset:0
    ds_read_b128 a[68:71], v212 offset:1024
    v_mfma_f32_16x16x32_bf16 v[108:111], v[196:199], a[40:43], v[108:111]
    ds_read_b128 a[72:75], v212 offset:2048
    ds_read_b128 a[76:79], v212 offset:3072
    v_mfma_f32_16x16x32_bf16 v[112:115], v[196:199], a[44:47], v[112:115]
    buffer_load_dwordx4 v51, s[60:63], s40 offen offset:1024  lds
    buffer_load_dwordx4 v52, s[60:63], s40 offen offset:2048  lds
    s_waitcnt lgkmcnt(11)
    v_mfma_f32_16x16x32_bf16 v[116:119], v[200:203], a[32:35], v[116:119]
    ds_read_b64_tr_b16 v[196:197], v218 offset:24576
    ds_read_b64_tr_b16 v[198:199], v218 offset:26624
    v_mfma_f32_16x16x32_bf16 v[120:123], v[200:203], a[36:39], v[120:123]
    s_mul_i32 s32, s64, 73728
    s_lshl_b32 s33, s3, 11
    s_add_u32 s32, s32, s33
    s_add_u32 s79, s32, 32047104
    s_waitcnt lgkmcnt(8)
    v_mfma_f32_16x16x32_bf16 v[124:127], v[200:203], a[40:43], v[124:127]
    buffer_store_dwordx4 v[20:23], v17, s[52:55], s79 offen sc1
    buffer_store_dwordx4 v[24:27], v17, s[52:55], s79 offen offset:1024 sc1
    v_mfma_f32_16x16x32_bf16 v[128:131], v[200:203], a[44:47], v[128:131]
    buffer_load_dwordx4 v53, s[60:63], s40 offen offset:3072  lds
    s_waitcnt lgkmcnt(6)
    v_mfma_f32_16x16x32_bf16 v[100:103], v[204:207], a[48:51], v[100:103]
    ds_read_b64_tr_b16 v[200:201], v219 offset:32768
    v_mfma_f32_16x16x32_bf16 v[104:107], v[204:207], a[52:55], v[104:107]
    ds_read_b64_tr_b16 v[202:203], v219 offset:34816
    v_mfma_f32_16x16x32_bf16 v[108:111], v[204:207], a[56:59], v[108:111]
    s_add_u32 m0, s41, 4096
    v_mfma_f32_16x16x32_bf16 v[112:115], v[204:207], a[60:63], v[112:115]
    buffer_load_dwordx4 v54, s[60:63], s40 offen offset:0  lds
    s_waitcnt lgkmcnt(2)
    v_mfma_f32_16x16x32_bf16 v[116:119], v[196:199], a[48:51], v[116:119]
    ds_read_b64_tr_b16 v[204:205], v220 offset:32768
    v_mfma_f32_16x16x32_bf16 v[120:123], v[196:199], a[52:55], v[120:123]
    ds_read_b64_tr_b16 v[206:207], v220 offset:34816
    v_mfma_f32_16x16x32_bf16 v[124:127], v[196:199], a[56:59], v[124:127]
    buffer_load_dwordx4 v55, s[60:63], s44 offen offset:1024  lds
    v_mfma_f32_16x16x32_bf16 v[128:131], v[196:199], a[60:63], v[128:131]
    buffer_load_dwordx4 v56, s[60:63], s44 offen offset:2048  lds
    s_waitcnt lgkmcnt(2)
    v_mfma_f32_16x16x32_bf16 v[100:103], v[200:203], a[64:67], v[100:103]
    s_waitcnt vmcnt(18)
    s_barrier
    v_add_u32 v10, 0xfffee000, v10
    v_mfma_f32_16x16x32_bf16 v[104:107], v[200:203], a[68:71], v[104:107]
    v_add_u32 v216, 0xfffee000, v216
    v_add_u32 v217, 0xfffee000, v217
    v_add_u32 v218, 0xfffee000, v218
    v_mfma_f32_16x16x32_bf16 v[108:111], v[200:203], a[72:75], v[108:111]
    v_add_u32 v219, 0xfffee000, v219
    v_add_u32 v220, 0xfffee000, v220
    ds_read_b64_tr_b16 v[196:197], v10 offset:0
    v_mfma_f32_16x16x32_bf16 v[112:115], v[200:203], a[76:79], v[112:115]
    ds_read_b64_tr_b16 v[198:199], v10 offset:2048
    buffer_load_dwordx4 v57, s[60:63], s44 offen offset:3072  lds
    s_add_u32 m0, s41, 8192
    s_waitcnt lgkmcnt(2)
    v_mfma_f32_16x16x32_bf16 v[116:119], v[204:207], a[64:67], v[116:119]
    ds_read_b64_tr_b16 v[200:201], v216 offset:0
    v_mfma_f32_16x16x32_bf16 v[120:123], v[204:207], a[68:71], v[120:123]
    ds_read_b64_tr_b16 v[202:203], v216 offset:2048
    v_mfma_f32_16x16x32_bf16 v[124:127], v[204:207], a[72:75], v[124:127]
    buffer_load_dwordx4 v58, s[60:63], s44 offen offset:0  lds
    v_mfma_f32_16x16x32_bf16 v[128:131], v[204:207], a[76:79], v[128:131]
    s_waitcnt lgkmcnt(2)
    v_mfma_f32_16x16x32_bf16 v[68:71], v[196:199], v[132:135], 0
    ds_read_b64_tr_b16 v[204:205], v10 offset:8192
    ds_read_b64_tr_b16 v[206:207], v10 offset:10240
    v_mfma_f32_16x16x32_bf16 v[72:75], v[196:199], v[136:139], 0
    v_cvt_pk_bf16_f32 v20, v100, v101
    s_add_u32 s44, s38, 2
    s_and_b32 s44, s44, 3
    s_lshl_b32 s44, s44, 7
    v_mfma_f32_16x16x32_bf16 v[76:79], v[196:199], v[140:143], 0
    v_cvt_pk_bf16_f32 v21, v102, v103
    v_mfma_f32_16x16x32_bf16 v[80:83], v[196:199], v[144:147], 0
    s_waitcnt lgkmcnt(2)
    v_mfma_f32_16x16x32_bf16 v[84:87], v[200:203], v[132:135], 0
    ds_read_b64_tr_b16 v[196:197], v216 offset:8192
    ds_read_b64_tr_b16 v[198:199], v216 offset:10240
    v_mfma_f32_16x16x32_bf16 v[88:91], v[200:203], v[136:139], 0
    s_add_u32 s83, s82, 8192
    buffer_load_dwordx4 a[112:115], v17, s[52:55], s83 offen offset:0 sc1
    v_cvt_pk_bf16_f32 v22, v116, v117
    v_mfma_f32_16x16x32_bf16 v[92:95], v[200:203], v[140:143], 0
    s_add_u32 s44, s44, s39
    s_add_u32 s40, s44, s72
    s_add_u32 s44, s44, s73
    v_mfma_f32_16x16x32_bf16 v[96:99], v[200:203], v[144:147], 0
    s_waitcnt lgkmcnt(2)
    v_mfma_f32_16x16x32_bf16 v[68:71], v[204:207], v[148:151], v[68:71]
    ds_read_b64_tr_b16 v[200:201], v10 offset:16384
    ds_read_b64_tr_b16 v[202:203], v10 offset:18432
    v_mfma_f32_16x16x32_bf16 v[72:75], v[204:207], v[152:155], v[72:75]
    v_cvt_pk_bf16_f32 v23, v118, v119
    s_add_u32 m0, s41, 73728
    v_mfma_f32_16x16x32_bf16 v[76:79], v[204:207], v[156:159], v[76:79]
    v_cvt_pk_bf16_f32 v24, v104, v105
    v_mfma_f32_16x16x32_bf16 v[80:83], v[204:207], v[160:163], v[80:83]
    s_waitcnt lgkmcnt(2)
    v_mfma_f32_16x16x32_bf16 v[84:87], v[196:199], v[148:151], v[84:87]
    ds_read_b64_tr_b16 v[204:205], v216 offset:16384
    ds_read_b64_tr_b16 v[206:207], v216 offset:18432
    v_mfma_f32_16x16x32_bf16 v[88:91], v[196:199], v[152:155], v[88:91]
    buffer_load_dwordx4 a[116:119], v17, s[52:55], s83 offen offset:1024 sc1
    v_cvt_pk_bf16_f32 v25, v106, v107
    v_mfma_f32_16x16x32_bf16 v[92:95], v[196:199], v[156:159], v[92:95]
    buffer_load_dwordx4 v50, s[60:63], s40 offen offset:0  lds
    v_mfma_f32_16x16x32_bf16 v[96:99], v[196:199], v[160:163], v[96:99]
    s_waitcnt lgkmcnt(2)
    v_mfma_f32_16x16x32_bf16 v[68:71], v[200:203], v[164:167], v[68:71]
    ds_read_b64_tr_b16 v[196:197], v10 offset:24576
    ds_read_b64_tr_b16 v[198:199], v10 offset:26624
    v_mfma_f32_16x16x32_bf16 v[72:75], v[200:203], v[168:171], v[72:75]
    v_cvt_pk_bf16_f32 v26, v120, v121
    v_cvt_pk_bf16_f32 v27, v122, v123
    v_mfma_f32_16x16x32_bf16 v[76:79], v[200:203], v[172:175], v[76:79]
    buffer_load_dwordx4 a[120:123], v17, s[52:55], s83 offen offset:2048 sc1
    v_mfma_f32_16x16x32_bf16 v[80:83], v[200:203], v[176:179], v[80:83]
    s_waitcnt lgkmcnt(2)
    v_mfma_f32_16x16x32_bf16 v[84:87], v[204:207], v[164:167], v[84:87]
    ds_read_b64_tr_b16 v[200:201], v216 offset:24576
    ds_read_b64_tr_b16 v[202:203], v216 offset:26624
    v_mfma_f32_16x16x32_bf16 v[88:91], v[204:207], v[168:171], v[88:91]
    buffer_load_dwordx4 v51, s[60:63], s40 offen offset:1024  lds
    v_cvt_pk_bf16_f32 v32, v108, v109
    v_mfma_f32_16x16x32_bf16 v[92:95], v[204:207], v[172:175], v[92:95]
    buffer_load_dwordx4 v52, s[60:63], s40 offen offset:2048  lds
    v_mfma_f32_16x16x32_bf16 v[96:99], v[204:207], v[176:179], v[96:99]
    s_waitcnt lgkmcnt(2)
    v_mfma_f32_16x16x32_bf16 v[68:71], v[196:199], v[180:183], v[68:71]
    ds_read_b64_tr_b16 v[204:205], v217 offset:0
    ds_read_b64_tr_b16 v[206:207], v217 offset:2048
    v_mfma_f32_16x16x32_bf16 v[72:75], v[196:199], v[184:187], v[72:75]
    v_cvt_pk_bf16_f32 v33, v110, v111
    v_cvt_pk_bf16_f32 v34, v124, v125
    v_mfma_f32_16x16x32_bf16 v[76:79], v[196:199], v[188:191], v[76:79]
    buffer_load_dwordx4 a[124:127], v17, s[52:55], s83 offen offset:3072 sc1
    v_mfma_f32_16x16x32_bf16 v[80:83], v[196:199], v[192:195], v[80:83]
    s_waitcnt lgkmcnt(2)
    v_mfma_f32_16x16x32_bf16 v[84:87], v[200:203], v[180:183], v[84:87]
    s_waitcnt vmcnt(13)
    s_barrier
    v_mfma_f32_16x16x32_bf16 v[88:91], v[200:203], v[184:187], v[88:91]
    s_cmp_lg_u32 s3, 0
    s_cbranch_scc1 L_w0_23
    v_mov_b32 v19, 4
    s_mov_b64 exec, 1
    buffer_store_dword v19, v18, s[52:55], s65 offen offset:0 sc1
    s_mov_b64 exec, -1
L_w0_23:
    ds_read_b64_tr_b16 v[196:197], v218 offset:0
    v_mfma_f32_16x16x32_bf16 v[92:95], v[200:203], v[188:191], v[92:95]
    ds_read_b64_tr_b16 v[198:199], v218 offset:2048
    buffer_load_dwordx4 v53, s[60:63], s40 offen offset:3072  lds
    v_mfma_f32_16x16x32_bf16 v[96:99], v[200:203], v[192:195], v[96:99]
    v_cvt_pk_bf16_f32 v35, v126, v127
    s_waitcnt lgkmcnt(2)
    v_mfma_f32_16x16x32_bf16 v[68:71], v[204:207], a[0:3], v[68:71]
    ds_read_b64_tr_b16 v[200:201], v217 offset:8192
    ds_read_b64_tr_b16 v[202:203], v217 offset:10240
    v_mfma_f32_16x16x32_bf16 v[72:75], v[204:207], a[4:7], v[72:75]
    v_cvt_pk_bf16_f32 v36, v112, v113
    s_add_u32 m0, s41, 77824
    v_mfma_f32_16x16x32_bf16 v[76:79], v[204:207], a[8:11], v[76:79]
    v_cvt_pk_bf16_f32 v37, v114, v115
    v_mfma_f32_16x16x32_bf16 v[80:83], v[204:207], a[12:15], v[80:83]
    s_waitcnt lgkmcnt(2)
    v_mfma_f32_16x16x32_bf16 v[84:87], v[196:199], a[0:3], v[84:87]
    ds_read_b64_tr_b16 v[204:205], v218 offset:8192
    ds_read_b64_tr_b16 v[206:207], v218 offset:10240
    v_mfma_f32_16x16x32_bf16 v[88:91], v[196:199], a[4:7], v[88:91]
    s_add_u32 s83, s82, 12288
    buffer_load_dwordx4 a[128:131], v17, s[52:55], s83 offen offset:0 sc1
    v_cvt_pk_bf16_f32 v38, v128, v129
    v_mfma_f32_16x16x32_bf16 v[92:95], v[196:199], a[8:11], v[92:95]
    buffer_load_dwordx4 v54, s[60:63], s40 offen offset:0  lds
    v_mfma_f32_16x16x32_bf16 v[96:99], v[196:199], a[12:15], v[96:99]
    s_waitcnt lgkmcnt(2)
    v_mfma_f32_16x16x32_bf16 v[68:71], v[200:203], a[16:19], v[68:71]
    ds_read_b64_tr_b16 v[196:197], v217 offset:16384
    ds_read_b64_tr_b16 v[198:199], v217 offset:18432
    v_mfma_f32_16x16x32_bf16 v[72:75], v[200:203], a[20:23], v[72:75]
    v_cvt_pk_bf16_f32 v39, v130, v131
    buffer_load_dwordx4 v55, s[60:63], s44 offen offset:1024  lds
    v_mfma_f32_16x16x32_bf16 v[76:79], v[200:203], a[24:27], v[76:79]
    s_lshl_b32 s32, s26, 1
    s_and_b32 s33, s27, 1
    s_add_u32 s32, s32, s33
    s_lshl_b32 s32, s32, 1
    s_add_u32 s32, s32, s43
    s_mul_i32 s32, s32, 299008
    v_mfma_f32_16x16x32_bf16 v[80:83], v[200:203], a[28:31], v[80:83]
    s_waitcnt lgkmcnt(2)
    v_mfma_f32_16x16x32_bf16 v[84:87], v[204:207], a[16:19], v[84:87]
    ds_read_b64_tr_b16 v[200:201], v218 offset:16384
    ds_read_b64_tr_b16 v[202:203], v218 offset:18432
    v_mfma_f32_16x16x32_bf16 v[88:91], v[204:207], a[20:23], v[88:91]
    buffer_load_dwordx4 a[132:135], v17, s[52:55], s83 offen offset:1024 sc1
    s_mul_i32 s33, s42, 9216
    s_add_u32 s32, s32, s33
    s_add_u32 s32, s32, 8388608
    s_lshr_b32 s84, s27, 1
    s_lshl_b32 s33, s43, 2
    s_sub_u32 s84, s84, s33
    v_mfma_f32_16x16x32_bf16 v[92:95], v[204:207], a[24:27], v[92:95]
    buffer_load_dwordx4 v56, s[60:63], s44 offen offset:2048  lds
    v_mfma_f32_16x16x32_bf16 v[96:99], v[204:207], a[28:31], v[96:99]
    s_waitcnt lgkmcnt(2)
    v_mfma_f32_16x16x32_bf16 v[68:71], v[196:199], a[32:35], v[68:71]
    ds_read_b64_tr_b16 v[204:205], v217 offset:24576
    ds_read_b64_tr_b16 v[206:207], v217 offset:26624
    v_mfma_f32_16x16x32_bf16 v[72:75], v[196:199], a[36:39], v[72:75]
    s_sub_u32 s33, s84, 0
    s_and_b32 s33, s33, 7
    s_lshl_b32 s33, s33, 10
    s_add_u32 s33, s33, s32
    s_add_u32 s33, s33, 0
    s_cmp_eq_u32 s84, 0
    s_cselect_b32 s33, 0xf0000000, s33
    v_add_u32 v28, s33, v17
    s_sub_u32 s33, s84, 1
    s_and_b32 s33, s33, 7
    s_lshl_b32 s33, s33, 10
    s_add_u32 s33, s33, s32
    s_add_u32 s33, s33, 74752
    s_cmp_eq_u32 s84, 1
    s_cselect_b32 s33, 0xf0000000, s33
    v_add_u32 v29, s33, v17
    v_mfma_f32_16x16x32_bf16 v[76:79], v[196:199], a[40:43], v[76:79]
    buffer_load_dwordx4 a[136:139], v17, s[52:55], s83 offen offset:2048 sc1
    v_mfma_f32_16x16x32_bf16 v[80:83], v[196:199], a[44:47], v[80:83]
    s_waitcnt lgkmcnt(2)
    v_mfma_f32_16x16x32_bf16 v[84:87], v[200:203], a[32:35], v[84:87]
    ds_read_b64_tr_b16 v[196:197], v218 offset:24576
    ds_read_b64_tr_b16 v[198:199], v218 offset:26624
    v_mfma_f32_16x16x32_bf16 v[88:91], v[200:203], a[36:39], v[88:91]
    buffer_load_dwordx4 v57, s[60:63], s44 offen offset:3072  lds
    s_sub_u32 s33, s84, 2
    s_and_b32 s33, s33, 7
    s_lshl_b32 s33, s33, 10
    s_add_u32 s33, s33, s32
    s_add_u32 s33, s33, 149504
    s_cmp_eq_u32 s84, 2
    s_cselect_b32 s33, 0xf0000000, s33
    v_add_u32 v30, s33, v17
    v_mfma_f32_16x16x32_bf16 v[92:95], v[200:203], a[40:43], v[92:95]
    s_add_u32 m0, s41, 81920
    v_mfma_f32_16x16x32_bf16 v[96:99], v[200:203], a[44:47], v[96:99]
    s_waitcnt lgkmcnt(2)
    v_mfma_f32_16x16x32_bf16 v[68:71], v[204:207], a[48:51], v[68:71]
    ds_read_b64_tr_b16 v[200:201], v219 offset:32768
    ds_read_b64_tr_b16 v[202:203], v219 offset:34816
    v_mfma_f32_16x16x32_bf16 v[72:75], v[204:207], a[52:55], v[72:75]
    s_sub_u32 s33, s84, 3
    s_and_b32 s33, s33, 7
    s_lshl_b32 s33, s33, 10
    s_add_u32 s33, s33, s32
    s_add_u32 s33, s33, 224256
    s_cmp_eq_u32 s84, 3
    s_cselect_b32 s33, 0xf0000000, s33
    v_add_u32 v31, s33, v17
    s_lshl_b32 s33, s42, 10
    s_add_u32 s33, s33, 152576
    v_add_u32 v14, s33, v17
    v_mfma_f32_16x16x32_bf16 v[76:79], v[204:207], a[56:59], v[76:79]
    buffer_load_dwordx4 a[140:143], v17, s[52:55], s83 offen offset:3072 sc1
    v_mfma_f32_16x16x32_bf16 v[80:83], v[204:207], a[60:63], v[80:83]
    s_waitcnt lgkmcnt(2)
    v_mfma_f32_16x16x32_bf16 v[84:87], v[196:199], a[48:51], v[84:87]
    buffer_load_dword v9, v215, s[52:55], 0 offen sc1
    ds_read_b64_tr_b16 v[204:205], v220 offset:32768
    v_mfma_f32_16x16x32_bf16 v[88:91], v[196:199], a[52:55], v[88:91]
    ds_read_b64_tr_b16 v[206:207], v220 offset:34816
    buffer_load_dwordx4 v58, s[60:63], s44 offen offset:0  lds
    v_mfma_f32_16x16x32_bf16 v[92:95], v[196:199], a[56:59], v[92:95]
    s_lshl_b32 s32, s26, 4
    s_lshl_b32 s33, s43, 3
    s_add_u32 s32, s32, s33
    s_add_u32 s32, s32, s42
    s_mul_i32 s32, s32, 17
    s_add_u32 s32, s32, s27
    s_lshl_b32 s32, s32, 10
    s_add_u32 s80, s32, 27525120
    v_mfma_f32_16x16x32_bf16 v[96:99], v[196:199], a[60:63], v[96:99]
    s_waitcnt lgkmcnt(2)
    v_mfma_f32_16x16x32_bf16 v[68:71], v[200:203], a[64:67], v[68:71]
    s_waitcnt vmcnt(18)
    s_barrier
    v_add_u32 v10, 0xffff7000, v10
    v_mfma_f32_16x16x32_bf16 v[72:75], v[200:203], a[68:71], v[72:75]
    v_add_u32 v216, 0xffff7000, v216
    v_add_u32 v217, 0xffff7000, v217
    v_add_u32 v218, 0xffff7000, v218
    v_mfma_f32_16x16x32_bf16 v[76:79], v[200:203], a[72:75], v[76:79]
    v_add_u32 v219, 0xffff7000, v219
    v_add_u32 v220, 0xffff7000, v220
    ds_read_b64_tr_b16 v[196:197], v10 offset:0
    v_mfma_f32_16x16x32_bf16 v[80:83], v[200:203], a[76:79], v[80:83]
    ds_read_b64_tr_b16 v[198:199], v10 offset:2048
    s_waitcnt lgkmcnt(2)
    v_mfma_f32_16x16x32_bf16 v[84:87], v[204:207], a[64:67], v[84:87]
    ds_read_b64_tr_b16 v[200:201], v216 offset:0
    v_mfma_f32_16x16x32_bf16 v[88:91], v[204:207], a[68:71], v[88:91]
    ds_read_b64_tr_b16 v[202:203], v216 offset:2048
    v_mfma_f32_16x16x32_bf16 v[92:95], v[204:207], a[72:75], v[92:95]
    v_mfma_f32_16x16x32_bf16 v[96:99], v[204:207], a[76:79], v[96:99]
    s_waitcnt lgkmcnt(2)
    v_mfma_f32_16x16x32_bf16 v[100:103], v[196:199], v[132:135], 0
    ds_read_b64_tr_b16 v[204:205], v10 offset:8192
    v_mfma_f32_16x16x32_bf16 v[104:107], v[196:199], v[136:139], 0
    ds_read_b64_tr_b16 v[206:207], v10 offset:10240
    v_mfma_f32_16x16x32_bf16 v[108:111], v[196:199], v[140:143], 0
    s_add_u32 s44, s38, 0
    s_and_b32 s44, s44, 3
    s_lshl_b32 s44, s44, 7
    v_mfma_f32_16x16x32_bf16 v[112:115], v[196:199], v[144:147], 0
    s_waitcnt lgkmcnt(2)
    v_mfma_f32_16x16x32_bf16 v[116:119], v[200:203], v[132:135], 0
    ds_read_b64_tr_b16 v[196:197], v216 offset:8192
    v_mfma_f32_16x16x32_bf16 v[120:123], v[200:203], v[136:139], 0
    ds_read_b64_tr_b16 v[198:199], v216 offset:10240
    v_mfma_f32_16x16x32_bf16 v[124:127], v[200:203], v[140:143], 0
    s_add_u32 s44, s44, s39
    s_add_u32 s40, s44, s74
    s_add_u32 s44, s44, s75
    v_mfma_f32_16x16x32_bf16 v[128:131], v[200:203], v[144:147], 0
    s_waitcnt lgkmcnt(2)
    v_mfma_f32_16x16x32_bf16 v[100:103], v[204:207], v[148:151], v[100:103]
    ds_read_b64_tr_b16 v[200:201], v10 offset:16384
    v_mfma_f32_16x16x32_bf16 v[104:107], v[204:207], v[152:155], v[104:107]
    ds_read_b64_tr_b16 v[202:203], v10 offset:18432
    v_mfma_f32_16x16x32_bf16 v[108:111], v[204:207], v[156:159], v[108:111]
    s_add_u32 m0, s41, 110592
    v_mfma_f32_16x16x32_bf16 v[112:115], v[204:207], v[160:163], v[112:115]
    s_waitcnt lgkmcnt(2)
    v_mfma_f32_16x16x32_bf16 v[116:119], v[196:199], v[148:151], v[116:119]
    ds_read_b64_tr_b16 v[204:205], v216 offset:16384
    v_mfma_f32_16x16x32_bf16 v[120:123], v[196:199], v[152:155], v[120:123]
    ds_read_b64_tr_b16 v[206:207], v216 offset:18432
    v_mfma_f32_16x16x32_bf16 v[124:127], v[196:199], v[156:159], v[124:127]
    buffer_load_dwordx4 v50, s[60:63], s40 offen offset:0  lds
    v_mfma_f32_16x16x32_bf16 v[128:131], v[196:199], v[160:163], v[128:131]
    s_waitcnt lgkmcnt(2)
    v_mfma_f32_16x16x32_bf16 v[100:103], v[200:203], v[164:167], v[100:103]
    ds_read_b64_tr_b16 v[196:197], v10 offset:24576
    v_mfma_f32_16x16x32_bf16 v[104:107], v[200:203], v[168:171], v[104:107]
    ds_read_b64_tr_b16 v[198:199], v10 offset:26624
    v_mfma_f32_16x16x32_bf16 v[108:111], v[200:203], v[172:175], v[108:111]
    buffer_load_dwordx4 v51, s[60:63], s40 offen offset:1024  lds
    v_mfma_f32_16x16x32_bf16 v[112:115], v[200:203], v[176:179], v[112:115]
    s_waitcnt lgkmcnt(2)
    v_mfma_f32_16x16x32_bf16 v[116:119], v[204:207], v[164:167], v[116:119]
    ds_read_b64_tr_b16 v[200:201], v216 offset:24576
    v_mfma_f32_16x16x32_bf16 v[120:123], v[204:207], v[168:171], v[120:123]
    ds_read_b64_tr_b16 v[202:203], v216 offset:26624
    v_mfma_f32_16x16x32_bf16 v[124:127], v[204:207], v[172:175], v[124:127]
    buffer_load_dwordx4 v52, s[60:63], s40 offen offset:2048  lds
    v_mfma_f32_16x16x32_bf16 v[128:131], v[204:207], v[176:179], v[128:131]
    s_waitcnt lgkmcnt(2)
    v_mfma_f32_16x16x32_bf16 v[100:103], v[196:199], v[180:183], v[100:103]
    s_waitcnt vmcnt(4)
    v_cmp_gt_u32 vcc, 4, v9
    s_cbranch_vccz L_pollx_25
    s_mov_b32 s35, 0
L_poll_24:
    s_add_u32 s35, s35, 1
    s_cmp_gt_u32 s35, 400000
    s_cbranch_scc1 L_pollx_25
    buffer_load_dword v9, v215, s[52:55], 0 offen sc1
    s_waitcnt vmcnt(0)
    v_cmp_gt_u32 vcc, 4, v9
    s_cbranch_vccnz L_poll_24
L_pollx_25:
    ds_read_b64_tr_b16 v[204:205], v217 offset:0
    v_mfma_f32_16x16x32_bf16 v[104:107], v[196:199], v[184:187], v[104:107]
    ds_read_b64_tr_b16 v[206:207], v217 offset:2048
    s_add_u32 s83, s82, 16384
    buffer_load_dwordx4 a[144:147], v17, s[52:55], s83 offen offset:0 sc1
    v_mfma_f32_16x16x32_bf16 v[108:111], v[196:199], v[188:191], v[108:111]
    buffer_load_dwordx4 v53, s[60:63], s40 offen offset:3072  lds
    v_mfma_f32_16x16x32_bf16 v[112:115], v[196:199], v[192:195], v[112:115]
    s_waitcnt lgkmcnt(2)
    v_mfma_f32_16x16x32_bf16 v[116:119], v[200:203], v[180:183], v[116:119]
    ds_read_b64_tr_b16 v[196:197], v218 offset:0
    v_mfma_f32_16x16x32_bf16 v[120:123], v[200:203], v[184:187], v[120:123]
    ds_read_b64_tr_b16 v[198:199], v218 offset:2048
    v_mfma_f32_16x16x32_bf16 v[124:127], v[200:203], v[188:191], v[124:127]
    buffer_load_dwordx4 a[148:151], v17, s[52:55], s83 offen offset:1024 sc1
    v_mfma_f32_16x16x32_bf16 v[128:131], v[200:203], v[192:195], v[128:131]
    s_waitcnt lgkmcnt(2)
    v_mfma_f32_16x16x32_bf16 v[100:103], v[204:207], a[0:3], v[100:103]
    ds_read_b64_tr_b16 v[200:201], v217 offset:8192
    v_mfma_f32_16x16x32_bf16 v[104:107], v[204:207], a[4:7], v[104:107]
    ds_read_b64_tr_b16 v[202:203], v217 offset:10240
    v_mfma_f32_16x16x32_bf16 v[108:111], v[204:207], a[8:11], v[108:111]
    buffer_load_dwordx4 a[152:155], v17, s[52:55], s83 offen offset:2048 sc1
    v_mfma_f32_16x16x32_bf16 v[112:115], v[204:207], a[12:15], v[112:115]
    s_add_u32 m0, s41, 114688
    s_waitcnt lgkmcnt(2)
    v_mfma_f32_16x16x32_bf16 v[116:119], v[196:199], a[0:3], v[116:119]
    ds_read_b64_tr_b16 v[204:205], v218 offset:8192
    v_mfma_f32_16x16x32_bf16 v[120:123], v[196:199], a[4:7], v[120:123]
    ds_read_b64_tr_b16 v[206:207], v218 offset:10240
    v_mfma_f32_16x16x32_bf16 v[124:127], v[196:199], a[8:11], v[124:127]
    buffer_load_dwordx4 a[156:159], v17, s[52:55], s83 offen offset:3072 sc1
    v_mfma_f32_16x16x32_bf16 v[128:131], v[196:199], a[12:15], v[128:131]
    buffer_load_dwordx4 v54, s[60:63], s40 offen offset:0  lds
    s_waitcnt lgkmcnt(2)
    v_mfma_f32_16x16x32_bf16 v[100:103], v[200:203], a[16:19], v[100:103]
    ds_read_b64_tr_b16 v[196:197], v217 offset:16384
    v_mfma_f32_16x16x32_bf16 v[104:107], v[200:203], a[20:23], v[104:107]
    ds_read_b64_tr_b16 v[198:199], v217 offset:18432
    v_mfma_f32_16x16x32_bf16 v[108:111], v[200:203], a[24:27], v[108:111]
    buffer_load_dwordx4 v55, s[60:63], s44 offen offset:1024  lds
    v_mfma_f32_16x16x32_bf16 v[112:115], v[200:203], a[28:31], v[112:115]
    s_waitcnt lgkmcnt(2)
    v_mfma_f32_16x16x32_bf16 v[116:119], v[204:207], a[16:19], v[116:119]
    ds_read_b64_tr_b16 v[200:201], v218 offset:16384
    v_mfma_f32_16x16x32_bf16 v[120:123], v[204:207], a[20:23], v[120:123]
    ds_read_b64_tr_b16 v[202:203], v218 offset:18432
    v_mfma_f32_16x16x32_bf16 v[124:127], v[204:207], a[24:27], v[124:127]
    s_add_u32 s83, s82, 20480
    buffer_load_dwordx4 a[160:163], v17, s[52:55], s83 offen offset:0 sc1
    v_mfma_f32_16x16x32_bf16 v[128:131], v[204:207], a[28:31], v[128:131]
    buffer_load_dwordx4 v56, s[60:63], s44 offen offset:2048  lds
    s_waitcnt lgkmcnt(2)
    v_mfma_f32_16x16x32_bf16 v[100:103], v[196:199], a[32:35], v[100:103]
    ds_read_b64_tr_b16 v[204:205], v217 offset:24576
    v_mfma_f32_16x16x32_bf16 v[104:107], v[196:199], a[36:39], v[104:107]
    ds_read_b64_tr_b16 v[206:207], v217 offset:26624
    v_mfma_f32_16x16x32_bf16 v[108:111], v[196:199], a[40:43], v[108:111]
    buffer_load_dwordx4 a[164:167], v17, s[52:55], s83 offen offset:1024 sc1
    v_mfma_f32_16x16x32_bf16 v[112:115], v[196:199], a[44:47], v[112:115]
    buffer_load_dwordx4 v57, s[60:63], s44 offen offset:3072  lds
    s_waitcnt lgkmcnt(2)
    v_mfma_f32_16x16x32_bf16 v[116:119], v[200:203], a[32:35], v[116:119]
    ds_read_b64_tr_b16 v[196:197], v218 offset:24576
    v_mfma_f32_16x16x32_bf16 v[120:123], v[200:203], a[36:39], v[120:123]
    ds_read_b64_tr_b16 v[198:199], v218 offset:26624
    v_mfma_f32_16x16x32_bf16 v[124:127], v[200:203], a[40:43], v[124:127]
    buffer_load_dwordx4 a[168:171], v17, s[52:55], s83 offen offset:2048 sc1
    v_mfma_f32_16x16x32_bf16 v[128:131], v[200:203], a[44:47], v[128:131]
    s_add_u32 m0, s41, 118784
    s_waitcnt lgkmcnt(2)
    v_mfma_f32_16x16x32_bf16 v[100:103], v[204:207], a[48:51], v[100:103]
    ds_read_b64_tr_b16 v[200:201], v219 offset:32768
    v_mfma_f32_16x16x32_bf16 v[104:107], v[204:207], a[52:55], v[104:107]
    ds_read_b64_tr_b16 v[202:203], v219 offset:34816
    v_mfma_f32_16x16x32_bf16 v[108:111], v[204:207], a[56:59], v[108:111]
    buffer_load_dwordx4 a[172:175], v17, s[52:55], s83 offen offset:3072 sc1
    v_mfma_f32_16x16x32_bf16 v[112:115], v[204:207], a[60:63], v[112:115]
    buffer_load_dwordx4 v58, s[60:63], s44 offen offset:0  lds
    s_waitcnt lgkmcnt(2)
    v_mfma_f32_16x16x32_bf16 v[116:119], v[196:199], a[48:51], v[116:119]
    ds_read_b64_tr_b16 v[204:205], v220 offset:32768
    v_mfma_f32_16x16x32_bf16 v[120:123], v[196:199], a[52:55], v[120:123]
    ds_read_b64_tr_b16 v[206:207], v220 offset:34816
    v_mfma_f32_16x16x32_bf16 v[124:127], v[196:199], a[56:59], v[124:127]
    v_mfma_f32_16x16x32_bf16 v[128:131], v[196:199], a[60:63], v[128:131]
    s_waitcnt lgkmcnt(2)
    v_mfma_f32_16x16x32_bf16 v[100:103], v[200:203], a[64:67], v[100:103]
    s_waitcnt vmcnt(17)
    s_barrier
    v_add_u32 v10, 0x12000, v10
    v_mfma_f32_16x16x32_bf16 v[104:107], v[200:203], a[68:71], v[104:107]
    v_add_u32 v216, 0x12000, v216
    v_add_u32 v217, 0x12000, v217
    v_add_u32 v218, 0x12000, v218
    v_mfma_f32_16x16x32_bf16 v[108:111], v[200:203], a[72:75], v[108:111]
    v_add_u32 v219, 0x12000, v219
    v_add_u32 v220, 0x12000, v220
    ds_read_b64_tr_b16 v[196:197], v10 offset:0
    v_mfma_f32_16x16x32_bf16 v[112:115], v[200:203], a[76:79], v[112:115]
    ds_read_b64_tr_b16 v[198:199], v10 offset:2048
    s_waitcnt lgkmcnt(2)
    v_mfma_f32_16x16x32_bf16 v[116:119], v[204:207], a[64:67], v[116:119]
    ds_read_b64_tr_b16 v[200:201], v216 offset:0
    v_mfma_f32_16x16x32_bf16 v[120:123], v[204:207], a[68:71], v[120:123]
    ds_read_b64_tr_b16 v[202:203], v216 offset:2048
    v_mfma_f32_16x16x32_bf16 v[124:127], v[204:207], a[72:75], v[124:127]
    v_mfma_f32_16x16x32_bf16 v[128:131], v[204:207], a[76:79], v[128:131]
    s_waitcnt lgkmcnt(2)
    v_mfma_f32_16x16x32_bf16 v[40:43], v[196:199], v[132:135], 0
    ds_read_b64_tr_b16 v[204:205], v10 offset:8192
    v_mfma_f32_16x16x32_bf16 v[44:47], v[196:199], v[136:139], 0
    ds_read_b64_tr_b16 v[206:207], v10 offset:10240
    v_mfma_f32_16x16x32_bf16 v[60:63], v[196:199], v[140:143], 0
    s_add_u32 s44, s38, 1
    s_and_b32 s44, s44, 3
    s_lshl_b32 s44, s44, 7
    v_mfma_f32_16x16x32_bf16 v[64:67], v[196:199], v[144:147], 0
    s_add_u32 s83, s82, 24576
    buffer_load_dwordx4 a[176:179], v17, s[52:55], s83 offen offset:0 sc1
    s_waitcnt lgkmcnt(2)
    v_mfma_f32_16x16x32_bf16 v[208:211], v[200:203], v[132:135], 0
    ds_read_b64_tr_b16 v[196:197], v216 offset:8192
    v_mfma_f32_16x16x32_bf16 v[224:227], v[200:203], v[136:139], 0
    ds_read_b64_tr_b16 v[198:199], v216 offset:10240
    v_mfma_f32_16x16x32_bf16 v[228:231], v[200:203], v[140:143], 0
    s_add_u32 s44, s44, s39
    s_add_u32 s40, s44, s74
    s_add_u32 s44, s44, s75
    v_mfma_f32_16x16x32_bf16 v[232:235], v[200:203], v[144:147], 0
    s_waitcnt lgkmcnt(2)
    v_mfma_f32_16x16x32_bf16 v[40:43], v[204:207], v[148:151], v[40:43]
    ds_read_b64_tr_b16 v[200:201], v10 offset:16384
    v_mfma_f32_16x16x32_bf16 v[44:47], v[204:207], v[152:155], v[44:47]
    ds_read_b64_tr_b16 v[202:203], v10 offset:18432
    v_mfma_f32_16x16x32_bf16 v[60:63], v[204:207], v[156:159], v[60:63]
    s_add_u32 m0, s41, 36864
    v_mfma_f32_16x16x32_bf16 v[64:67], v[204:207], v[160:163], v[64:67]
    buffer_load_dwordx4 a[180:183], v17, s[52:55], s83 offen offset:1024 sc1
    s_waitcnt lgkmcnt(2)
    v_mfma_f32_16x16x32_bf16 v[208:211], v[196:199], v[148:151], v[208:211]
    ds_read_b64_tr_b16 v[204:205], v216 offset:16384
    v_mfma_f32_16x16x32_bf16 v[224:227], v[196:199], v[152:155], v[224:227]
    ds_read_b64_tr_b16 v[206:207], v216 offset:18432
    v_mfma_f32_16x16x32_bf16 v[228:231], v[196:199], v[156:159], v[228:231]
    buffer_load_dwordx4 v50, s[60:63], s40 offen offset:0  lds
    v_mfma_f32_16x16x32_bf16 v[232:235], v[196:199], v[160:163], v[232:235]
    s_waitcnt lgkmcnt(2)
    v_mfma_f32_16x16x32_bf16 v[40:43], v[200:203], v[164:167], v[40:43]
    ds_read_b64_tr_b16 v[196:197], v10 offset:24576
    v_mfma_f32_16x16x32_bf16 v[44:47], v[200:203], v[168:171], v[44:47]
    ds_read_b64_tr_b16 v[198:199], v10 offset:26624
    v_mfma_f32_16x16x32_bf16 v[60:63], v[200:203], v[172:175], v[60:63]
    buffer_load_dwordx4 a[184:187], v17, s[52:55], s83 offen offset:2048 sc1
    v_mfma_f32_16x16x32_bf16 v[64:67], v[200:203], v[176:179], v[64:67]
    s_waitcnt lgkmcnt(2)
    v_mfma_f32_16x16x32_bf16 v[208:211], v[204:207], v[164:167], v[208:211]
    ds_read_b64_tr_b16 v[200:201], v216 offset:24576
    v_mfma_f32_16x16x32_bf16 v[224:227], v[204:207], v[168:171], v[224:227]
    ds_read_b64_tr_b16 v[202:203], v216 offset:26624
    v_mfma_f32_16x16x32_bf16 v[228:231], v[204:207], v[172:175], v[228:231]
    buffer_load_dwordx4 v51, s[60:63], s40 offen offset:1024  lds
    v_mfma_f32_16x16x32_bf16 v[232:235], v[204:207], v[176:179], v[232:235]
    buffer_load_dwordx4 v52, s[60:63], s40 offen offset:2048  lds
    s_waitcnt lgkmcnt(2)
    v_mfma_f32_16x16x32_bf16 v[40:43], v[196:199], v[180:183], v[40:43]
    ds_read_b64_tr_b16 v[204:205], v217 offset:0
    v_mfma_f32_16x16x32_bf16 v[44:47], v[196:199], v[184:187], v[44:47]
    ds_read_b64_tr_b16 v[206:207], v217 offset:2048
    v_mfma_f32_16x16x32_bf16 v[60:63], v[196:199], v[188:191], v[60:63]
    buffer_load_dwordx4 a[188:191], v17, s[52:55], s83 offen offset:3072 sc1
    v_mfma_f32_16x16x32_bf16 v[64:67], v[196:199], v[192:195], v[64:67]
    s_waitcnt lgkmcnt(2)
    v_mfma_f32_16x16x32_bf16 v[208:211], v[200:203], v[180:183], v[208:211]
    ds_read_b64_tr_b16 v[196:197], v218 offset:0
    v_mfma_f32_16x16x32_bf16 v[224:227], v[200:203], v[184:187], v[224:227]
    ds_read_b64_tr_b16 v[198:199], v218 offset:2048
    v_mfma_f32_16x16x32_bf16 v[228:231], v[200:203], v[188:191], v[228:231]
    buffer_load_dwordx4 v53, s[60:63], s40 offen offset:3072  lds
    v_mfma_f32_16x16x32_bf16 v[232:235], v[200:203], v[192:195], v[232:235]
    s_waitcnt lgkmcnt(2)
    v_mfma_f32_16x16x32_bf16 v[40:43], v[204:207], a[0:3], v[40:43]
    ds_read_b64_tr_b16 v[200:201], v217 offset:8192
    v_mfma_f32_16x16x32_bf16 v[44:47], v[204:207], a[4:7], v[44:47]
    ds_read_b64_tr_b16 v[202:203], v217 offset:10240
    v_mfma_f32_16x16x32_bf16 v[60:63], v[204:207], a[8:11], v[60:63]
    s_add_u32 m0, s41, 40960
    v_mfma_f32_16x16x32_bf16 v[64:67], v[204:207], a[12:15], v[64:67]
    s_add_u32 s83, s82, 28672
    buffer_load_dwordx4 a[192:195], v17, s[52:55], s83 offen offset:0 sc1
    s_waitcnt lgkmcnt(2)
    v_mfma_f32_16x16x32_bf16 v[208:211], v[196:199], a[0:3], v[208:211]
    ds_read_b64_tr_b16 v[204:205], v218 offset:8192
    v_mfma_f32_16x16x32_bf16 v[224:227], v[196:199], a[4:7], v[224:227]
    ds_read_b64_tr_b16 v[206:207], v218 offset:10240
    v_mfma_f32_16x16x32_bf16 v[228:231], v[196:199], a[8:11], v[228:231]
    buffer_load_dwordx4 v54, s[60:63], s40 offen offset:0  lds
    v_mfma_f32_16x16x32_bf16 v[232:235], v[196:199], a[12:15], v[232:235]
    s_waitcnt lgkmcnt(2)
    v_mfma_f32_16x16x32_bf16 v[40:43], v[200:203], a[16:19], v[40:43]
    ds_read_b64_tr_b16 v[196:197], v217 offset:16384
    v_mfma_f32_16x16x32_bf16 v[44:47], v[200:203], a[20:23], v[44:47]
    ds_read_b64_tr_b16 v[198:199], v217 offset:18432
    v_mfma_f32_16x16x32_bf16 v[60:63], v[200:203], a[24:27], v[60:63]
    buffer_load_dwordx4 v55, s[60:63], s44 offen offset:1024  lds
    v_mfma_f32_16x16x32_bf16 v[64:67], v[200:203], a[28:31], v[64:67]
    buffer_load_dwordx4 a[196:199], v17, s[52:55], s83 offen offset:1024 sc1
    s_waitcnt lgkmcnt(2)
    v_mfma_f32_16x16x32_bf16 v[208:211], v[204:207], a[16:19], v[208:211]
    ds_read_b64_tr_b16 v[200:201], v218 offset:16384
    v_mfma_f32_16x16x32_bf16 v[224:227], v[204:207], a[20:23], v[224:227]
    ds_read_b64_tr_b16 v[202:203], v218 offset:18432
    v_mfma_f32_16x16x32_bf16 v[228:231], v[204:207], a[24:27], v[228:231]
    buffer_load_dwordx4 v56, s[60:63], s44 offen offset:2048  lds
    v_mfma_f32_16x16x32_bf16 v[232:235], v[204:207], a[28:31], v[232:235]
    s_waitcnt lgkmcnt(2)
    v_mfma_f32_16x16x32_bf16 v[40:43], v[196:199], a[32:35], v[40:43]
    ds_read_b64_tr_b16 v[204:205], v217 offset:24576
    v_mfma_f32_16x16x32_bf16 v[44:47], v[196:199], a[36:39], v[44:47]
    ds_read_b64_tr_b16 v[206:207], v217 offset:26624
    v_mfma_f32_16x16x32_bf16 v[60:63], v[196:199], a[40:43], v[60:63]
    buffer_load_dwordx4 a[200:203], v17, s[52:55], s83 offen offset:2048 sc1
    v_mfma_f32_16x16x32_bf16 v[64:67], v[196:199], a[44:47], v[64:67]
    s_waitcnt lgkmcnt(2)
    v_mfma_f32_16x16x32_bf16 v[208:211], v[200:203], a[32:35], v[208:211]
    ds_read_b64_tr_b16 v[196:197], v218 offset:24576
    v_mfma_f32_16x16x32_bf16 v[224:227], v[200:203], a[36:39], v[224:227]
    ds_read_b64_tr_b16 v[198:199], v218 offset:26624
    v_mfma_f32_16x16x32_bf16 v[228:231], v[200:203], a[40:43], v[228:231]
    buffer_load_dwordx4 v57, s[60:63], s44 offen offset:3072  lds
    v_mfma_f32_16x16x32_bf16 v[232:235], v[200:203], a[44:47], v[232:235]
    s_add_u32 m0, s41, 45056
    s_waitcnt lgkmcnt(2)
    v_mfma_f32_16x16x32_bf16 v[40:43], v[204:207], a[48:51], v[40:43]
    ds_read_b64_tr_b16 v[200:201], v219 offset:32768
    v_mfma_f32_16x16x32_bf16 v[44:47], v[204:207], a[52:55], v[44:47]
    ds_read_b64_tr_b16 v[202:203], v219 offset:34816
    v_mfma_f32_16x16x32_bf16 v[60:63], v[204:207], a[56:59], v[60:63]
    buffer_load_dwordx4 a[204:207], v17, s[52:55], s83 offen offset:3072 sc1
    v_mfma_f32_16x16x32_bf16 v[64:67], v[204:207], a[60:63], v[64:67]
    s_waitcnt lgkmcnt(2)
    v_mfma_f32_16x16x32_bf16 v[208:211], v[196:199], a[48:51], v[208:211]
    ds_read_b64_tr_b16 v[204:205], v220 offset:32768
    v_mfma_f32_16x16x32_bf16 v[224:227], v[196:199], a[52:55], v[224:227]
    ds_read_b64_tr_b16 v[206:207], v220 offset:34816
    v_mfma_f32_16x16x32_bf16 v[228:231], v[196:199], a[56:59], v[228:231]
    buffer_load_dwordx4 v58, s[60:63], s44 offen offset:0  lds
    v_mfma_f32_16x16x32_bf16 v[232:235], v[196:199], a[60:63], v[232:235]
    s_waitcnt lgkmcnt(2)
    v_mfma_f32_16x16x32_bf16 v[40:43], v[200:203], a[64:67], v[40:43]
    s_waitcnt vmcnt(17)
    s_barrier
    v_add_u32 v10, 0x9000, v10
    v_mfma_f32_16x16x32_bf16 v[44:47], v[200:203], a[68:71], v[44:47]
    v_add_u32 v216, 0x9000, v216
    v_add_u32 v217, 0x9000, v217
    v_add_u32 v218, 0x9000, v218
    v_mfma_f32_16x16x32_bf16 v[60:63], v[200:203], a[72:75], v[60:63]
    v_add_u32 v219, 0x9000, v219
    v_add_u32 v220, 0x9000, v220
    ds_read_b64_tr_b16 v[196:197], v219 offset:0
    v_mfma_f32_16x16x32_bf16 v[64:67], v[200:203], a[76:79], v[64:67]
    ds_read_b64_tr_b16 v[198:199], v219 offset:2048
    s_waitcnt lgkmcnt(2)
    v_mfma_f32_16x16x32_bf16 v[208:211], v[204:207], a[64:67], v[208:211]
    ds_read_b64_tr_b16 v[200:201], v220 offset:0
    v_mfma_f32_16x16x32_bf16 v[224:227], v[204:207], a[68:71], v[224:227]
    ds_read_b64_tr_b16 v[202:203], v220 offset:2048
    v_mfma_f32_16x16x32_bf16 v[228:231], v[204:207], a[72:75], v[228:231]
    v_mfma_f32_16x16x32_bf16 v[232:235], v[204:207], a[76:79], v[232:235]
    s_waitcnt lgkmcnt(2)
    v_mfma_f32_16x16x32_bf16 v[68:71], v[196:199], a[80:83], v[68:71]
    ds_read_b64_tr_b16 v[204:205], v219 offset:4096
    v_mfma_f32_16x16x32_bf16 v[72:75], v[196:199], a[84:87], v[72:75]
    ds_read_b64_tr_b16 v[206:207], v219 offset:6144
    v_mfma_f32_16x16x32_bf16 v[76:79], v[196:199], a[88:91], v[76:79]
    s_xor_b32 s83, s64, 1
    s_mul_i32 s83, s83, 73728
    s_lshl_b32 s34, s43, 12
    s_add_u32 s83, s83, s34
    s_add_u32 s83, s83, 32047104
    buffer_load_dwordx4 a[208:211], v17, s[52:55], s83 offen offset:0 sc1
    v_mfma_f32_16x16x32_bf16 v[80:83], v[196:199], a[92:95], v[80:83]
    s_waitcnt lgkmcnt(2)
    v_mfma_f32_16x16x32_bf16 v[84:87], v[200:203], a[80:83], v[84:87]
    ds_read_b64_tr_b16 v[196:197], v220 offset:4096
    v_mfma_f32_16x16x32_bf16 v[88:91], v[200:203], a[84:87], v[88:91]
    ds_read_b64_tr_b16 v[198:199], v220 offset:6144
    v_mfma_f32_16x16x32_bf16 v[92:95], v[200:203], a[88:91], v[92:95]
    buffer_load_dwordx4 a[212:215], v17, s[52:55], s83 offen offset:1024 sc1
    v_mfma_f32_16x16x32_bf16 v[96:99], v[200:203], a[92:95], v[96:99]
    s_waitcnt lgkmcnt(2)
    v_mfma_f32_16x16x32_bf16 v[68:71], v[204:207], a[96:99], v[68:71]
    ds_read_b64_tr_b16 v[200:201], v219 offset:8192
    v_mfma_f32_16x16x32_bf16 v[72:75], v[204:207], a[100:103], v[72:75]
    ds_read_b64_tr_b16 v[202:203], v219 offset:10240
    v_mfma_f32_16x16x32_bf16 v[76:79], v[204:207], a[104:107], v[76:79]
    buffer_load_dwordx4 a[216:219], v17, s[52:55], s83 offen offset:2048 sc1
    v_mfma_f32_16x16x32_bf16 v[80:83], v[204:207], a[108:111], v[80:83]
    s_waitcnt lgkmcnt(2)
    v_mfma_f32_16x16x32_bf16 v[84:87], v[196:199], a[96:99], v[84:87]
    ds_read_b64_tr_b16 v[204:205], v220 offset:8192
    v_mfma_f32_16x16x32_bf16 v[88:91], v[196:199], a[100:103], v[88:91]
    ds_read_b64_tr_b16 v[206:207], v220 offset:10240
    v_mfma_f32_16x16x32_bf16 v[92:95], v[196:199], a[104:107], v[92:95]
    buffer_load_dwordx4 a[220:223], v17, s[52:55], s83 offen offset:3072 sc1
    v_mfma_f32_16x16x32_bf16 v[96:99], v[196:199], a[108:111], v[96:99]
    s_waitcnt lgkmcnt(2)
    v_mfma_f32_16x16x32_bf16 v[68:71], v[200:203], a[112:115], v[68:71]
    ds_read_b64_tr_b16 v[196:197], v219 offset:12288
    v_mfma_f32_16x16x32_bf16 v[72:75], v[200:203], a[116:119], v[72:75]
    ds_read_b64_tr_b16 v[198:199], v219 offset:14336
    v_mfma_f32_16x16x32_bf16 v[76:79], v[200:203], a[120:123], v[76:79]
    s_add_u32 s44, s38, 2
    s_and_b32 s44, s44, 3
    s_lshl_b32 s44, s44, 7
    v_mfma_f32_16x16x32_bf16 v[80:83], v[200:203], a[124:127], v[80:83]
    s_add_u32 s44, s44, s39
    s_add_u32 s40, s44, s74
    s_add_u32 s44, s44, s75
    s_waitcnt lgkmcnt(2)
    v_mfma_f32_16x16x32_bf16 v[84:87], v[204:207], a[112:115], v[84:87]
    ds_read_b64_tr_b16 v[200:201], v220 offset:12288
    v_mfma_f32_16x16x32_bf16 v[88:91], v[204:207], a[116:119], v[88:91]
    ds_read_b64_tr_b16 v[202:203], v220 offset:14336
    v_mfma_f32_16x16x32_bf16 v[92:95], v[204:207], a[120:123], v[92:95]
    s_add_u32 s79, s80, 0
    buffer_store_dwordx4 v[20:23], v17, s[52:55], s79 offen sc1
    v_mfma_f32_16x16x32_bf16 v[96:99], v[204:207], a[124:127], v[96:99]
    s_waitcnt lgkmcnt(2)
    v_mfma_f32_16x16x32_bf16 v[68:71], v[196:199], a[128:131], v[68:71]
    ds_read_b64_tr_b16 v[204:205], v219 offset:16384
    v_mfma_f32_16x16x32_bf16 v[72:75], v[196:199], a[132:135], v[72:75]
    ds_read_b64_tr_b16 v[206:207], v219 offset:18432
    v_mfma_f32_16x16x32_bf16 v[76:79], v[196:199], a[136:139], v[76:79]
    s_add_u32 m0, s41, 0
    v_mfma_f32_16x16x32_bf16 v[80:83], v[196:199], a[140:143], v[80:83]
    buffer_load_dwordx4 v50, s[60:63], s40 offen offset:0  lds
    s_waitcnt lgkmcnt(2)
    v_mfma_f32_16x16x32_bf16 v[84:87], v[200:203], a[128:131], v[84:87]
    ds_read_b64_tr_b16 v[196:197], v220 offset:16384
    v_mfma_f32_16x16x32_bf16 v[88:91], v[200:203], a[132:135], v[88:91]
    ds_read_b64_tr_b16 v[198:199], v220 offset:18432
    v_mfma_f32_16x16x32_bf16 v[92:95], v[200:203], a[136:139], v[92:95]
    buffer_load_dwordx4 v51, s[60:63], s40 offen offset:1024  lds
    v_mfma_f32_16x16x32_bf16 v[96:99], v[200:203], a[140:143], v[96:99]
    s_waitcnt lgkmcnt(2)
    v_mfma_f32_16x16x32_bf16 v[68:71], v[204:207], a[144:147], v[68:71]
    ds_read_b64_tr_b16 v[200:201], v219 offset:20480
    v_mfma_f32_16x16x32_bf16 v[72:75], v[204:207], a[148:151], v[72:75]
    ds_read_b64_tr_b16 v[202:203], v219 offset:22528
    v_mfma_f32_16x16x32_bf16 v[76:79], v[204:207], a[152:155], v[76:79]
    s_add_u32 s79, s80, 34816
    buffer_store_dwordx4 v[24:27], v17, s[52:55], s79 offen sc1
    v_mfma_f32_16x16x32_bf16 v[80:83], v[204:207], a[156:159], v[80:83]
    buffer_load_dwordx4 v52, s[60:63], s40 offen offset:2048  lds
    s_waitcnt lgkmcnt(2)
    v_mfma_f32_16x16x32_bf16 v[84:87], v[196:199], a[144:147], v[84:87]
    ds_read_b64_tr_b16 v[204:205], v220 offset:20480
    v_mfma_f32_16x16x32_bf16 v[88:91], v[196:199], a[148:151], v[88:91]
    ds_read_b64_tr_b16 v[206:207], v220 offset:22528
    v_mfma_f32_16x16x32_bf16 v[92:95], v[196:199], a[152:155], v[92:95]
    buffer_load_dwordx4 v53, s[60:63], s40 offen offset:3072  lds
    v_mfma_f32_16x16x32_bf16 v[96:99], v[196:199], a[156:159], v[96:99]
    s_waitcnt lgkmcnt(2)
    v_mfma_f32_16x16x32_bf16 v[68:71], v[200:203], a[160:163], v[68:71]
    ds_read_b64_tr_b16 v[196:197], v219 offset:24576
    v_mfma_f32_16x16x32_bf16 v[72:75], v[200:203], a[164:167], v[72:75]
    ds_read_b64_tr_b16 v[198:199], v219 offset:26624
    v_mfma_f32_16x16x32_bf16 v[76:79], v[200:203], a[168:171], v[76:79]
    s_add_u32 m0, s41, 4096
    v_mfma_f32_16x16x32_bf16 v[80:83], v[200:203], a[172:175], v[80:83]
    buffer_load_dwordx4 v54, s[60:63], s40 offen offset:0  lds
    s_waitcnt lgkmcnt(2)
    v_mfma_f32_16x16x32_bf16 v[84:87], v[204:207], a[160:163], v[84:87]
    ds_read_b64_tr_b16 v[200:201], v220 offset:24576
    v_mfma_f32_16x16x32_bf16 v[88:91], v[204:207], a[164:167], v[88:91]
    ds_read_b64_tr_b16 v[202:203], v220 offset:26624
    v_mfma_f32_16x16x32_bf16 v[92:95], v[204:207], a[168:171], v[92:95]
    s_add_u32 s79, s80, 69632
    buffer_store_dwordx4 v[32:35], v17, s[52:55], s79 offen sc1
    v_mfma_f32_16x16x32_bf16 v[96:99], v[204:207], a[172:175], v[96:99]
    s_waitcnt lgkmcnt(2)
    s_waitcnt vmcnt(22)
    v_mfma_f32_16x16x32_bf16 v[68:71], v[196:199], a[176:179], v[68:71]
    ds_read_b64_tr_b16 v[204:205], v219 offset:28672
    v_mfma_f32_16x16x32_bf16 v[72:75], v[196:199], a[180:183], v[72:75]
    ds_read_b64_tr_b16 v[206:207], v219 offset:30720
    v_mfma_f32_16x16x32_bf16 v[76:79], v[196:199], a[184:187], v[76:79]
    buffer_load_dwordx4 v55, s[60:63], s44 offen offset:1024  lds
    v_mfma_f32_16x16x32_bf16 v[80:83], v[196:199], a[188:191], v[80:83]
    buffer_load_dwordx4 v56, s[60:63], s44 offen offset:2048  lds
    s_waitcnt lgkmcnt(2)
    v_mfma_f32_16x16x32_bf16 v[84:87], v[200:203], a[176:179], v[84:87]
    ds_read_b64_tr_b16 v[196:197], v220 offset:28672
    v_mfma_f32_16x16x32_bf16 v[88:91], v[200:203], a[180:183], v[88:91]
    ds_read_b64_tr_b16 v[198:199], v220 offset:30720
    v_mfma_f32_16x16x32_bf16 v[92:95], v[200:203], a[184:187], v[92:95]
    buffer_load_dwordx4 v57, s[60:63], s44 offen offset:3072  lds
    v_mfma_f32_16x16x32_bf16 v[96:99], v[200:203], a[188:191], v[96:99]
    s_waitcnt lgkmcnt(2)
    s_waitcnt vmcnt(16)
    v_mfma_f32_16x16x32_bf16 v[68:71], v[204:207], a[192:195], v[68:71]
    ds_read_b64_tr_b16 v[200:201], v219 offset:32768
    v_mfma_f32_16x16x32_bf16 v[72:75], v[204:207], a[196:199], v[72:75]
    ds_read_b64_tr_b16 v[202:203], v219 offset:34816
    v_mfma_f32_16x16x32_bf16 v[76:79], v[204:207], a[200:203], v[76:79]
    s_add_u32 s79, s80, 104448
    buffer_store_dwordx4 v[36:39], v17, s[52:55], s79 offen sc1
    v_mfma_f32_16x16x32_bf16 v[80:83], v[204:207], a[204:207], v[80:83]
    s_add_u32 m0, s41, 8192
    s_waitcnt lgkmcnt(2)
    v_mfma_f32_16x16x32_bf16 v[84:87], v[196:199], a[192:195], v[84:87]
    ds_read_b64_tr_b16 v[204:205], v220 offset:32768
    v_mfma_f32_16x16x32_bf16 v[88:91], v[196:199], a[196:199], v[88:91]
    ds_read_b64_tr_b16 v[206:207], v220 offset:34816
    v_mfma_f32_16x16x32_bf16 v[92:95], v[196:199], a[200:203], v[92:95]
    buffer_load_dwordx4 v58, s[60:63], s44 offen offset:0  lds
    v_mfma_f32_16x16x32_bf16 v[96:99], v[196:199], a[204:207], v[96:99]
    s_waitcnt lgkmcnt(2)
    s_waitcnt vmcnt(13)
    v_mfma_f32_16x16x32_bf16 v[68:71], v[200:203], a[208:211], v[68:71]
    s_barrier
    v_add_u32 v10, 0xfffee000, v10
    v_mfma_f32_16x16x32_bf16 v[72:75], v[200:203], a[212:215], v[72:75]
    v_add_u32 v216, 0xfffee000, v216
    v_add_u32 v217, 0xfffee000, v217
    v_add_u32 v218, 0xfffee000, v218
    v_mfma_f32_16x16x32_bf16 v[76:79], v[200:203], a[216:219], v[76:79]
    v_add_u32 v219, 0xfffee000, v219
    v_add_u32 v220, 0xfffee000, v220
    ds_read_b64_tr_b16 v[196:197], v219 offset:0
    v_mfma_f32_16x16x32_bf16 v[80:83], v[200:203], a[220:223], v[80:83]
    ds_read_b64_tr_b16 v[198:199], v219 offset:2048
    s_waitcnt lgkmcnt(2)
    v_mfma_f32_16x16x32_bf16 v[84:87], v[204:207], a[208:211], v[84:87]
    ds_read_b64_tr_b16 v[200:201], v220 offset:0
    v_mfma_f32_16x16x32_bf16 v[88:91], v[204:207], a[212:215], v[88:91]
    ds_read_b64_tr_b16 v[202:203], v220 offset:2048
    v_mfma_f32_16x16x32_bf16 v[92:95], v[204:207], a[216:219], v[92:95]
    v_mfma_f32_16x16x32_bf16 v[96:99], v[204:207], a[220:223], v[96:99]
    s_waitcnt lgkmcnt(2)
    v_mfma_f32_16x16x32_bf16 v[100:103], v[196:199], a[80:83], v[100:103]
    ds_read_b64_tr_b16 v[204:205], v219 offset:4096
    ds_read_b64_tr_b16 v[206:207], v219 offset:6144
    v_mfma_f32_16x16x32_bf16 v[104:107], v[196:199], a[84:87], v[104:107]
    s_mov_b32 s79, 0
    s_add_u32 s44, s38, 3
    s_and_b32 s44, s44, 3
    s_lshl_b32 s44, s44, 7
    v_mfma_f32_16x16x32_bf16 v[108:111], v[196:199], a[88:91], v[108:111]
    v_cvt_pk_bf16_f32 v68, v68, v69
    v_mfma_f32_16x16x32_bf16 v[112:115], v[196:199], a[92:95], v[112:115]
    s_waitcnt lgkmcnt(2)
    v_mfma_f32_16x16x32_bf16 v[116:119], v[200:203], a[80:83], v[116:119]
    ds_read_b64_tr_b16 v[196:197], v220 offset:4096
    ds_read_b64_tr_b16 v[198:199], v220 offset:6144
    v_mfma_f32_16x16x32_bf16 v[120:123], v[200:203], a[84:87], v[120:123]
    v_cvt_pk_bf16_f32 v69, v70, v71
    s_mov_b32 s68, s18
    s_mov_b32 s69, s19
    s_mov_b32 s70, 1152
    s_mov_b32 s71, 0x20000
    v_mfma_f32_16x16x32_bf16 v[124:127], v[200:203], a[88:91], v[124:127]
    s_add_u32 s44, s44, s39
    s_add_u32 s40, s44, s72
    s_add_u32 s44, s44, s73
    v_mfma_f32_16x16x32_bf16 v[128:131], v[200:203], a[92:95], v[128:131]
    s_waitcnt lgkmcnt(2)
    v_mfma_f32_16x16x32_bf16 v[100:103], v[204:207], a[96:99], v[100:103]
    ds_read_b64_tr_b16 v[200:201], v219 offset:8192
    ds_read_b64_tr_b16 v[202:203], v219 offset:10240
    v_mfma_f32_16x16x32_bf16 v[104:107], v[204:207], a[100:103], v[104:107]
    v_cvt_pk_bf16_f32 v70, v84, v85
    s_add_u32 m0, s41, 73728
    v_mfma_f32_16x16x32_bf16 v[108:111], v[204:207], a[104:107], v[108:111]
    v_cvt_pk_bf16_f32 v71, v86, v87
    v_mfma_f32_16x16x32_bf16 v[112:115], v[204:207], a[108:111], v[112:115]
    s_waitcnt lgkmcnt(2)
    v_mfma_f32_16x16x32_bf16 v[116:119], v[196:199], a[96:99], v[116:119]
    ds_read_b64_tr_b16 v[204:205], v220 offset:8192
    v_mfma_f32_16x16x32_bf16 v[120:123], v[196:199], a[100:103], v[120:123]
    ds_read_b64_tr_b16 v[206:207], v220 offset:10240
    v_mfma_f32_16x16x32_bf16 v[124:127], v[196:199], a[104:107], v[124:127]
    buffer_store_dwordx4 v[68:71], v28, s[52:55], s79 offen sc1
    v_mfma_f32_16x16x32_bf16 v[128:131], v[196:199], a[108:111], v[128:131]
    buffer_load_dwordx4 v50, s[60:63], s40 offen offset:0  lds
    s_waitcnt lgkmcnt(2)
    v_mfma_f32_16x16x32_bf16 v[100:103], v[200:203], a[112:115], v[100:103]
    ds_read_b64_tr_b16 v[196:197], v219 offset:12288
    ds_read_b64_tr_b16 v[198:199], v219 offset:14336
    v_mfma_f32_16x16x32_bf16 v[104:107], v[200:203], a[116:119], v[104:107]
    s_cmp_lg_u32 s84, 0
    s_cbranch_scc1 L_only_26
    ds_write_b128 v14, v[68:71] offset:0
L_only_26:
    v_cvt_pk_bf16_f32 v72, v72, v73
    v_mfma_f32_16x16x32_bf16 v[108:111], v[200:203], a[120:123], v[108:111]
    s_mov_b32 s88, s20
    s_mov_b32 s89, s21
    s_mov_b32 s90, 2359296
    s_mov_b32 s91, 0x20000
    v_mfma_f32_16x16x32_bf16 v[112:115], v[200:203], a[124:127], v[112:115]
    s_waitcnt lgkmcnt(2)
    v_mfma_f32_16x16x32_bf16 v[116:119], v[204:207], a[112:115], v[116:119]
    ds_read_b64_tr_b16 v[200:201], v220 offset:12288
    ds_read_b64_tr_b16 v[202:203], v220 offset:14336
    v_mfma_f32_16x16x32_bf16 v[120:123], v[204:207], a[116:119], v[120:123]
    buffer_load_dwordx4 v51, s[60:63], s40 offen offset:1024  lds
    v_cvt_pk_bf16_f32 v73, v74, v75
    v_mfma_f32_16x16x32_bf16 v[124:127], v[204:207], a[120:123], v[124:127]
    v_cvt_pk_bf16_f32 v74, v88, v89
    v_mfma_f32_16x16x32_bf16 v[128:131], v[204:207], a[124:127], v[128:131]
    s_waitcnt lgkmcnt(2)
    v_mfma_f32_16x16x32_bf16 v[100:103], v[196:199], a[128:131], v[100:103]
    ds_read_b64_tr_b16 v[204:205], v219 offset:16384
    ds_read_b64_tr_b16 v[206:207], v219 offset:18432
    v_mfma_f32_16x16x32_bf16 v[104:107], v[196:199], a[132:135], v[104:107]
    buffer_load_dwordx4 v52, s[60:63], s40 offen offset:2048  lds
    v_cvt_pk_bf16_f32 v75, v90, v91
    v_mfma_f32_16x16x32_bf16 v[108:111], v[196:199], a[136:139], v[108:111]
    buffer_store_dwordx4 v[72:75], v29, s[52:55], s79 offen sc1
    v_mfma_f32_16x16x32_bf16 v[112:115], v[196:199], a[140:143], v[112:115]
    s_waitcnt lgkmcnt(2)
    v_mfma_f32_16x16x32_bf16 v[116:119], v[200:203], a[128:131], v[116:119]
    ds_read_b64_tr_b16 v[196:197], v220 offset:16384
    v_mfma_f32_16x16x32_bf16 v[120:123], v[200:203], a[132:135], v[120:123]
    ds_read_b64_tr_b16 v[198:199], v220 offset:18432
    v_mfma_f32_16x16x32_bf16 v[124:127], v[200:203], a[136:139], v[124:127]
    buffer_load_dwordx4 v53, s[60:63], s40 offen offset:3072  lds
    v_mfma_f32_16x16x32_bf16 v[128:131], v[200:203], a[140:143], v[128:131]
    s_cmp_lg_u32 s84, 1
    s_cbranch_scc1 L_only_27
    ds_write_b128 v14, v[72:75] offset:0
L_only_27:
    s_waitcnt lgkmcnt(2)
    v_mfma_f32_16x16x32_bf16 v[100:103], v[204:207], a[144:147], v[100:103]
    ds_read_b64_tr_b16 v[200:201], v219 offset:20480
    ds_read_b64_tr_b16 v[202:203], v219 offset:22528
    v_mfma_f32_16x16x32_bf16 v[104:107], v[204:207], a[148:151], v[104:107]
    s_lshr_b32 s32, s27, 1
    s_lshl_b32 s34, s32, 6
    s_add_u32 s34, s34, 152064
    v_lshl_add_u32 v20, v2, 2, s34
    s_add_u32 m0, s41, 77824
    v_mfma_f32_16x16x32_bf16 v[108:111], v[204:207], a[152:155], v[108:111]
    v_cvt_pk_bf16_f32 v76, v76, v77
    v_mfma_f32_16x16x32_bf16 v[112:115], v[204:207], a[156:159], v[112:115]
    s_waitcnt lgkmcnt(2)
    v_mfma_f32_16x16x32_bf16 v[116:119], v[196:199], a[144:147], v[116:119]
    ds_read_b64_tr_b16 v[204:205], v220 offset:20480
    ds_read_b64_tr_b16 v[206:207], v220 offset:22528
    v_mfma_f32_16x16x32_bf16 v[120:123], v[196:199], a[148:151], v[120:123]
    v_cvt_pk_bf16_f32 v77, v78, v79
    buffer_load_dwordx4 v54, s[60:63], s40 offen offset:0  lds
    v_mfma_f32_16x16x32_bf16 v[124:127], v[196:199], a[152:155], v[124:127]
    v_cvt_pk_bf16_f32 v78, v92, v93
    v_mfma_f32_16x16x32_bf16 v[128:131], v[196:199], a[156:159], v[128:131]
    s_waitcnt lgkmcnt(2)
    v_mfma_f32_16x16x32_bf16 v[100:103], v[200:203], a[160:163], v[100:103]
    ds_read_b64_tr_b16 v[196:197], v219 offset:24576
    ds_read_b64_tr_b16 v[198:199], v219 offset:26624
    v_mfma_f32_16x16x32_bf16 v[104:107], v[200:203], a[164:167], v[104:107]
    v_cvt_pk_bf16_f32 v79, v94, v95
    buffer_load_dwordx4 v55, s[60:63], s44 offen offset:1024  lds
    v_mfma_f32_16x16x32_bf16 v[108:111], v[200:203], a[168:171], v[108:111]
    buffer_store_dwordx4 v[76:79], v30, s[52:55], s79 offen sc1
    v_mfma_f32_16x16x32_bf16 v[112:115], v[200:203], a[172:175], v[112:115]
    s_waitcnt lgkmcnt(2)
    v_mfma_f32_16x16x32_bf16 v[116:119], v[204:207], a[160:163], v[116:119]
    ds_read_b64_tr_b16 v[200:201], v220 offset:24576
    v_mfma_f32_16x16x32_bf16 v[120:123], v[204:207], a[164:167], v[120:123]
    ds_read_b64_tr_b16 v[202:203], v220 offset:26624
    v_mfma_f32_16x16x32_bf16 v[124:127], v[204:207], a[168:171], v[124:127]
    ds_read_b32 v20, v20
    v_mfma_f32_16x16x32_bf16 v[128:131], v[204:207], a[172:175], v[128:131]
    s_cmp_lg_u32 s84, 2
    s_cbranch_scc1 L_only_28
    ds_write_b128 v14, v[76:79] offset:0
L_only_28:
    s_waitcnt lgkmcnt(3)
    v_mfma_f32_16x16x32_bf16 v[100:103], v[196:199], a[176:179], v[100:103]
    ds_read_b64_tr_b16 v[204:205], v219 offset:28672
    ds_read_b64_tr_b16 v[206:207], v219 offset:30720
    v_mfma_f32_16x16x32_bf16 v[104:107], v[196:199], a[180:183], v[104:107]
    buffer_load_dwordx4 v56, s[60:63], s44 offen offset:2048  lds
    v_cvt_pk_bf16_f32 v80, v80, v81
    v_mfma_f32_16x16x32_bf16 v[108:111], v[196:199], a[184:187], v[108:111]
    v_cvt_pk_bf16_f32 v81, v82, v83
    v_mfma_f32_16x16x32_bf16 v[112:115], v[196:199], a[188:191], v[112:115]
    s_waitcnt lgkmcnt(3)
    v_mfma_f32_16x16x32_bf16 v[116:119], v[200:203], a[176:179], v[116:119]
    ds_read_b64_tr_b16 v[196:197], v220 offset:28672
    ds_read_b64_tr_b16 v[198:199], v220 offset:30720
    v_mfma_f32_16x16x32_bf16 v[120:123], v[200:203], a[180:183], v[120:123]
    buffer_load_dwordx4 v57, s[60:63], s44 offen offset:3072  lds
    v_cvt_pk_bf16_f32 v82, v96, v97
    v_mfma_f32_16x16x32_bf16 v[124:127], v[200:203], a[184:187], v[124:127]
    s_add_u32 m0, s41, 81920
    v_mfma_f32_16x16x32_bf16 v[128:131], v[200:203], a[188:191], v[128:131]
    s_waitcnt lgkmcnt(2)
    v_mfma_f32_16x16x32_bf16 v[100:103], v[204:207], a[192:195], v[100:103]
    ds_read_b64_tr_b16 v[200:201], v219 offset:32768
    ds_read_b64_tr_b16 v[202:203], v219 offset:34816
    v_mfma_f32_16x16x32_bf16 v[104:107], v[204:207], a[196:199], v[104:107]
    v_cvt_pk_bf16_f32 v83, v98, v99
    s_lshr_b32 s32, s27, 1
    s_lshl_b32 s34, s26, 3
    s_add_u32 s34, s34, s32
    s_mul_i32 s34, s34, 18432
    s_add_u32 s85, s34, 4194304
    v_mfma_f32_16x16x32_bf16 v[108:111], v[204:207], a[200:203], v[108:111]
    buffer_store_dwordx4 v[80:83], v31, s[52:55], s79 offen sc1
    v_mfma_f32_16x16x32_bf16 v[112:115], v[204:207], a[204:207], v[112:115]
    s_waitcnt lgkmcnt(2)
    v_mfma_f32_16x16x32_bf16 v[116:119], v[196:199], a[192:195], v[116:119]
    ds_read_b64_tr_b16 v[204:205], v220 offset:32768
    v_mfma_f32_16x16x32_bf16 v[120:123], v[196:199], a[196:199], v[120:123]
    ds_read_b64_tr_b16 v[206:207], v220 offset:34816
    v_mfma_f32_16x16x32_bf16 v[124:127], v[196:199], a[200:203], v[124:127]
    buffer_load_dwordx4 v58, s[60:63], s44 offen offset:0  lds
    v_mfma_f32_16x16x32_bf16 v[128:131], v[196:199], a[204:207], v[128:131]
    s_cmp_lg_u32 s84, 3
    s_cbranch_scc1 L_only_29
    ds_write_b128 v14, v[80:83] offset:0
L_only_29:
    s_waitcnt lgkmcnt(2)
    v_mfma_f32_16x16x32_bf16 v[100:103], v[200:203], a[208:211], v[100:103]
    s_waitcnt vmcnt(13)
    s_barrier
    v_add_u32 v10, 0xffff7000, v10
    v_mfma_f32_16x16x32_bf16 v[104:107], v[200:203], a[212:215], v[104:107]
    v_add_u32 v216, 0xffff7000, v216
    v_add_u32 v217, 0xffff7000, v217
    v_add_u32 v218, 0xffff7000, v218
    v_mfma_f32_16x16x32_bf16 v[108:111], v[200:203], a[216:219], v[108:111]
    v_add_u32 v219, 0xffff7000, v219
    v_add_u32 v220, 0xffff7000, v220
    ds_read_b64_tr_b16 v[196:197], v219 offset:0
    v_mfma_f32_16x16x32_bf16 v[112:115], v[200:203], a[220:223], v[112:115]
    ds_read_b64_tr_b16 v[198:199], v219 offset:2048
    s_waitcnt lgkmcnt(2)
    v_mfma_f32_16x16x32_bf16 v[116:119], v[204:207], a[208:211], v[116:119]
    ds_read_b64_tr_b16 v[200:201], v220 offset:0
    v_mfma_f32_16x16x32_bf16 v[120:123], v[204:207], a[212:215], v[120:123]
    ds_read_b64_tr_b16 v[202:203], v220 offset:2048
    v_mfma_f32_16x16x32_bf16 v[124:127], v[204:207], a[216:219], v[124:127]
    v_mfma_f32_16x16x32_bf16 v[128:131], v[204:207], a[220:223], v[128:131]
    s_waitcnt lgkmcnt(2)
    v_mfma_f32_16x16x32_bf16 v[40:43], v[196:199], a[80:83], v[40:43]
    ds_read_b64_tr_b16 v[204:205], v219 offset:4096
    ds_read_b64_tr_b16 v[206:207], v219 offset:6144
    v_mfma_f32_16x16x32_bf16 v[44:47], v[196:199], a[84:87], v[44:47]
    s_mov_b32 s79, 18432
    s_add_u32 s44, s38, 3
    s_and_b32 s44, s44, 3
    s_lshl_b32 s44, s44, 7
    v_mfma_f32_16x16x32_bf16 v[60:63], v[196:199], a[88:91], v[60:63]
    v_cvt_pk_bf16_f32 v100, v100, v101
    v_mfma_f32_16x16x32_bf16 v[64:67], v[196:199], a[92:95], v[64:67]
    s_waitcnt lgkmcnt(2)
    v_mfma_f32_16x16x32_bf16 v[208:211], v[200:203], a[80:83], v[208:211]
    ds_read_b64_tr_b16 v[196:197], v220 offset:4096
    ds_read_b64_tr_b16 v[198:199], v220 offset:6144
    v_mfma_f32_16x16x32_bf16 v[224:227], v[200:203], a[84:87], v[224:227]
    v_cvt_pk_bf16_f32 v101, v102, v103
    v_lshlrev_b32 v15, 4, v2
    v_lshl_add_u32 v15, v11, 8, v15
    v_mfma_f32_16x16x32_bf16 v[228:231], v[200:203], a[88:91], v[228:231]
    s_add_u32 s44, s44, s39
    s_add_u32 s40, s44, s74
    s_add_u32 s44, s44, s75
    v_mfma_f32_16x16x32_bf16 v[232:235], v[200:203], a[92:95], v[232:235]
    s_waitcnt lgkmcnt(2)
    v_mfma_f32_16x16x32_bf16 v[40:43], v[204:207], a[96:99], v[40:43]
    ds_read_b64_tr_b16 v[200:201], v219 offset:8192
    ds_read_b64_tr_b16 v[202:203], v219 offset:10240
    v_mfma_f32_16x16x32_bf16 v[44:47], v[204:207], a[100:103], v[44:47]
    v_cvt_pk_bf16_f32 v102, v116, v117
    s_add_u32 m0, s41, 110592
    v_mfma_f32_16x16x32_bf16 v[60:63], v[204:207], a[104:107], v[60:63]
    v_cvt_pk_bf16_f32 v103, v118, v119
    v_mfma_f32_16x16x32_bf16 v[64:67], v[204:207], a[108:111], v[64:67]
    s_waitcnt lgkmcnt(2)
    v_mfma_f32_16x16x32_bf16 v[208:211], v[196:199], a[96:99], v[208:211]
    ds_read_b64_tr_b16 v[204:205], v220 offset:8192
    v_mfma_f32_16x16x32_bf16 v[224:227], v[196:199], a[100:103], v[224:227]
    ds_read_b64_tr_b16 v[206:207], v220 offset:10240
    v_mfma_f32_16x16x32_bf16 v[228:231], v[196:199], a[104:107], v[228:231]
    buffer_store_dwordx4 v[100:103], v28, s[52:55], s79 offen sc1
    v_mfma_f32_16x16x32_bf16 v[232:235], v[196:199], a[108:111], v[232:235]
    buffer_load_dwordx4 v50, s[60:63], s40 offen offset:0  lds
    s_waitcnt lgkmcnt(2)
    v_mfma_f32_16x16x32_bf16 v[40:43], v[200:203], a[112:115], v[40:43]
    ds_read_b64_tr_b16 v[196:197], v219 offset:12288
    ds_read_b64_tr_b16 v[198:199], v219 offset:14336
    v_mfma_f32_16x16x32_bf16 v[44:47], v[200:203], a[116:119], v[44:47]
    s_cmp_lg_u32 s84, 0
    s_cbranch_scc1 L_only_30
    ds_write_b128 v14, v[100:103] offset:2048
L_only_30:
    v_cvt_pk_bf16_f32 v104, v104, v105
    v_mfma_f32_16x16x32_bf16 v[60:63], v[200:203], a[120:123], v[60:63]
    v_lshlrev_b32 v16, 4, v11
    v_mfma_f32_16x16x32_bf16 v[64:67], v[200:203], a[124:127], v[64:67]
    s_waitcnt lgkmcnt(2)
    v_mfma_f32_16x16x32_bf16 v[208:211], v[204:207], a[112:115], v[208:211]
    ds_read_b64_tr_b16 v[200:201], v220 offset:12288
    ds_read_b64_tr_b16 v[202:203], v220 offset:14336
    v_mfma_f32_16x16x32_bf16 v[224:227], v[204:207], a[116:119], v[224:227]
    buffer_load_dwordx4 v51, s[60:63], s40 offen offset:1024  lds
    v_cvt_pk_bf16_f32 v105, v106, v107
    v_mfma_f32_16x16x32_bf16 v[228:231], v[204:207], a[120:123], v[228:231]
    v_cvt_pk_bf16_f32 v106, v120, v121
    v_mfma_f32_16x16x32_bf16 v[232:235], v[204:207], a[124:127], v[232:235]
    s_waitcnt lgkmcnt(2)
    v_mfma_f32_16x16x32_bf16 v[40:43], v[196:199], a[128:131], v[40:43]
    ds_read_b64_tr_b16 v[204:205], v219 offset:16384
    ds_read_b64_tr_b16 v[206:207], v219 offset:18432
    v_mfma_f32_16x16x32_bf16 v[44:47], v[196:199], a[132:135], v[44:47]
    buffer_load_dwordx4 v52, s[60:63], s40 offen offset:2048  lds
    v_cvt_pk_bf16_f32 v107, v122, v123
    v_mfma_f32_16x16x32_bf16 v[60:63], v[196:199], a[136:139], v[60:63]
    buffer_store_dwordx4 v[104:107], v29, s[52:55], s79 offen sc1
    v_mfma_f32_16x16x32_bf16 v[64:67], v[196:199], a[140:143], v[64:67]
    s_waitcnt lgkmcnt(2)
    v_mfma_f32_16x16x32_bf16 v[208:211], v[200:203], a[128:131], v[208:211]
    ds_read_b64_tr_b16 v[196:197], v220 offset:16384
    v_mfma_f32_16x16x32_bf16 v[224:227], v[200:203], a[132:135], v[224:227]
    ds_read_b64_tr_b16 v[198:199], v220 offset:18432
    v_mfma_f32_16x16x32_bf16 v[228:231], v[200:203], a[136:139], v[228:231]
    buffer_load_dwordx4 v53, s[60:63], s40 offen offset:3072  lds
    v_mfma_f32_16x16x32_bf16 v[232:235], v[200:203], a[140:143], v[232:235]
    s_cmp_lg_u32 s84, 1
    s_cbranch_scc1 L_only_31
    ds_write_b128 v14, v[104:107] offset:2048
L_only_31:
    s_waitcnt lgkmcnt(2)
    v_mfma_f32_16x16x32_bf16 v[40:43], v[204:207], a[144:147], v[40:43]
    ds_read_b64_tr_b16 v[200:201], v219 offset:20480
    ds_read_b64_tr_b16 v[202:203], v219 offset:22528
    v_mfma_f32_16x16x32_bf16 v[44:47], v[204:207], a[148:151], v[44:47]
    s_lshl_b32 s32, s3, 10
    s_add_u32 s32, s32, 152576
    v_add_u32 v22, s32, v17
    s_add_u32 m0, s41, 114688
    v_mfma_f32_16x16x32_bf16 v[60:63], v[204:207], a[152:155], v[60:63]
    v_cvt_pk_bf16_f32 v108, v108, v109
    v_mfma_f32_16x16x32_bf16 v[64:67], v[204:207], a[156:159], v[64:67]
    s_waitcnt lgkmcnt(2)
    v_mfma_f32_16x16x32_bf16 v[208:211], v[196:199], a[144:147], v[208:211]
    ds_read_b64_tr_b16 v[204:205], v220 offset:20480
    ds_read_b64_tr_b16 v[206:207], v220 offset:22528
    v_mfma_f32_16x16x32_bf16 v[224:227], v[196:199], a[148:151], v[224:227]
    v_cvt_pk_bf16_f32 v109, v110, v111
    buffer_load_dwordx4 v54, s[60:63], s40 offen offset:0  lds
    v_mfma_f32_16x16x32_bf16 v[228:231], v[196:199], a[152:155], v[228:231]
    v_cvt_pk_bf16_f32 v110, v124, v125
    v_mfma_f32_16x16x32_bf16 v[232:235], v[196:199], a[156:159], v[232:235]
    s_waitcnt lgkmcnt(2)
    v_mfma_f32_16x16x32_bf16 v[40:43], v[200:203], a[160:163], v[40:43]
    ds_read_b64_tr_b16 v[196:197], v219 offset:24576
    ds_read_b64_tr_b16 v[198:199], v219 offset:26624
    v_mfma_f32_16x16x32_bf16 v[44:47], v[200:203], a[164:167], v[44:47]
    v_cvt_pk_bf16_f32 v111, v126, v127
    buffer_load_dwordx4 v55, s[60:63], s44 offen offset:1024  lds
    v_mfma_f32_16x16x32_bf16 v[60:63], v[200:203], a[168:171], v[60:63]
    buffer_store_dwordx4 v[108:111], v30, s[52:55], s79 offen sc1
    v_mfma_f32_16x16x32_bf16 v[64:67], v[200:203], a[172:175], v[64:67]
    s_waitcnt lgkmcnt(2)
    v_mfma_f32_16x16x32_bf16 v[208:211], v[204:207], a[160:163], v[208:211]
    ds_read_b64_tr_b16 v[200:201], v220 offset:24576
    v_mfma_f32_16x16x32_bf16 v[224:227], v[204:207], a[164:167], v[224:227]
    ds_read_b64_tr_b16 v[202:203], v220 offset:26624
    v_mfma_f32_16x16x32_bf16 v[228:231], v[204:207], a[168:171], v[228:231]
    s_lshr_b32 s32, s27, 1
    s_lshr_b32 s34, s26, 1
    s_lshl_b32 s34, s34, 3
    s_add_u32 s34, s34, s32
    s_lshl_b32 s34, s34, 5
    s_add_u32 s34, s34, s30
    s_mul_i32 s34, s34, 1152
    v_mul_u32_u24 v8, 2304, v2
    v_add3_u32 v8, v8, v16, s34
    v_mfma_f32_16x16x32_bf16 v[232:235], v[204:207], a[172:175], v[232:235]
    s_cmp_lg_u32 s84, 2
    s_cbranch_scc1 L_only_32
    ds_write_b128 v14, v[108:111] offset:2048
L_only_32:
    s_waitcnt lgkmcnt(2)
    v_mfma_f32_16x16x32_bf16 v[40:43], v[196:199], a[176:179], v[40:43]
    ds_read_b64_tr_b16 v[204:205], v219 offset:28672
    ds_read_b64_tr_b16 v[206:207], v219 offset:30720
    v_mfma_f32_16x16x32_bf16 v[44:47], v[196:199], a[180:183], v[44:47]
    buffer_load_dwordx4 v56, s[60:63], s44 offen offset:2048  lds
    v_cvt_pk_bf16_f32 v112, v112, v113
    v_mfma_f32_16x16x32_bf16 v[60:63], v[196:199], a[184:187], v[60:63]
    v_cvt_pk_bf16_f32 v113, v114, v115
    v_mfma_f32_16x16x32_bf16 v[64:67], v[196:199], a[188:191], v[64:67]
    s_waitcnt lgkmcnt(2)
    v_mfma_f32_16x16x32_bf16 v[208:211], v[200:203], a[176:179], v[208:211]
    ds_read_b64_tr_b16 v[196:197], v220 offset:28672
    ds_read_b64_tr_b16 v[198:199], v220 offset:30720
    v_mfma_f32_16x16x32_bf16 v[224:227], v[200:203], a[180:183], v[224:227]
    buffer_load_dwordx4 v57, s[60:63], s44 offen offset:3072  lds
    v_cvt_pk_bf16_f32 v114, v128, v129
    v_mfma_f32_16x16x32_bf16 v[228:231], v[200:203], a[184:187], v[228:231]
    s_add_u32 m0, s41, 118784
    v_mfma_f32_16x16x32_bf16 v[232:235], v[200:203], a[188:191], v[232:235]
    s_waitcnt lgkmcnt(2)
    v_mfma_f32_16x16x32_bf16 v[40:43], v[204:207], a[192:195], v[40:43]
    ds_read_b64_tr_b16 v[200:201], v219 offset:32768
    ds_read_b64_tr_b16 v[202:203], v219 offset:34816
    v_mfma_f32_16x16x32_bf16 v[44:47], v[204:207], a[196:199], v[44:47]
    v_cvt_pk_bf16_f32 v115, v130, v131
    s_lshl_b32 s32, s26, 1
    s_and_b32 s33, s27, 1
    s_add_u32 s32, s32, s33
    s_lshl_b32 s32, s32, 3
    s_lshr_b32 s33, s27, 1
    s_add_u32 s32, s32, s33
    s_mul_i32 s32, s32, 74752
    s_mul_i32 s33, s3, 9216
    s_add_u32 s32, s32, s33
    s_add_u32 s67, s32, 8388608
    v_mfma_f32_16x16x32_bf16 v[60:63], v[204:207], a[200:203], v[60:63]
    buffer_store_dwordx4 v[112:115], v31, s[52:55], s79 offen sc1
    v_mfma_f32_16x16x32_bf16 v[64:67], v[204:207], a[204:207], v[64:67]
    s_waitcnt lgkmcnt(2)
    v_mfma_f32_16x16x32_bf16 v[208:211], v[196:199], a[192:195], v[208:211]
    ds_read_b64_tr_b16 v[204:205], v220 offset:32768
    v_mfma_f32_16x16x32_bf16 v[224:227], v[196:199], a[196:199], v[224:227]
    ds_read_b64_tr_b16 v[206:207], v220 offset:34816
    v_mfma_f32_16x16x32_bf16 v[228:231], v[196:199], a[200:203], v[228:231]
    buffer_load_dwordx4 v58, s[60:63], s44 offen offset:0  lds
    v_mfma_f32_16x16x32_bf16 v[232:235], v[196:199], a[204:207], v[232:235]
    s_cmp_lg_u32 s84, 3
    s_cbranch_scc1 L_only_33
    ds_write_b128 v14, v[112:115] offset:2048
L_only_33:
    s_waitcnt lgkmcnt(2)
    v_mfma_f32_16x16x32_bf16 v[40:43], v[200:203], a[208:211], v[40:43]
    s_waitcnt vmcnt(13)
    s_barrier
    v_add_u32 v10, 0x12000, v10
    v_mfma_f32_16x16x32_bf16 v[44:47], v[200:203], a[212:215], v[44:47]
    v_add_u32 v216, 0x12000, v216
    v_add_u32 v217, 0x12000, v217
    v_add_u32 v218, 0x12000, v218
    v_mfma_f32_16x16x32_bf16 v[60:63], v[200:203], a[216:219], v[60:63]
    v_add_u32 v219, 0x12000, v219
    v_add_u32 v220, 0x12000, v220
    ds_read_b64_tr_b16 v[196:197], v10 offset:0
    v_mfma_f32_16x16x32_bf16 v[64:67], v[200:203], a[220:223], v[64:67]
    ds_read_b64_tr_b16 v[198:199], v10 offset:2048
    s_waitcnt lgkmcnt(2)
    v_mfma_f32_16x16x32_bf16 v[208:211], v[204:207], a[208:211], v[208:211]
    ds_read_b64_tr_b16 v[200:201], v216 offset:0
    v_mfma_f32_16x16x32_bf16 v[224:227], v[204:207], a[212:215], v[224:227]
    ds_read_b64_tr_b16 v[202:203], v216 offset:2048
    v_mfma_f32_16x16x32_bf16 v[228:231], v[204:207], a[216:219], v[228:231]
    v_mfma_f32_16x16x32_bf16 v[232:235], v[204:207], a[220:223], v[232:235]
    s_waitcnt lgkmcnt(2)
    v_mfma_f32_16x16x32_bf16 v[68:71], v[196:199], v[132:135], 0
    ds_read_b64_tr_b16 v[204:205], v10 offset:8192
    v_mfma_f32_16x16x32_bf16 v[72:75], v[196:199], v[136:139], 0
    ds_read_b64_tr_b16 v[206:207], v10 offset:10240
    v_mfma_f32_16x16x32_bf16 v[76:79], v[196:199], v[140:143], 0
    s_mov_b32 s79, 36864
    v_mfma_f32_16x16x32_bf16 v[80:83], v[196:199], v[144:147], 0
    v_cvt_pk_bf16_f32 v40, v40, v41
    s_waitcnt lgkmcnt(2)
    v_mfma_f32_16x16x32_bf16 v[84:87], v[200:203], v[132:135], 0
    ds_read_b64_tr_b16 v[196:197], v216 offset:8192
    v_mfma_f32_16x16x32_bf16 v[88:91], v[200:203], v[136:139], 0
    ds_read_b64_tr_b16 v[198:199], v216 offset:10240
    v_mfma_f32_16x16x32_bf16 v[92:95], v[200:203], v[140:143], 0
    v_cvt_pk_bf16_f32 v41, v42, v43
    v_mfma_f32_16x16x32_bf16 v[96:99], v[200:203], v[144:147], 0
    s_mul_i32 s32, s64, 17408
    s_lshl_b32 s33, s42, 13
    s_add_u32 s32, s32, s33
    s_add_u32 s32, s32, 27525120
    s_cmp_lt_u32 s3, 2
    s_cselect_b32 s66, s67, s32
    s_waitcnt lgkmcnt(2)
    v_mfma_f32_16x16x32_bf16 v[68:71], v[204:207], v[148:151], v[68:71]
    ds_read_b64_tr_b16 v[200:201], v10 offset:16384
    v_mfma_f32_16x16x32_bf16 v[72:75], v[204:207], v[152:155], v[72:75]
    ds_read_b64_tr_b16 v[202:203], v10 offset:18432
    v_mfma_f32_16x16x32_bf16 v[76:79], v[204:207], v[156:159], v[76:79]
    v_cvt_pk_bf16_f32 v42, v208, v209
    v_mfma_f32_16x16x32_bf16 v[80:83], v[204:207], v[160:163], v[80:83]
    v_cvt_pk_bf16_f32 v43, v210, v211
    s_waitcnt lgkmcnt(2)
    v_mfma_f32_16x16x32_bf16 v[84:87], v[196:199], v[148:151], v[84:87]
    ds_read_b64_tr_b16 v[204:205], v216 offset:16384
    v_mfma_f32_16x16x32_bf16 v[88:91], v[196:199], v[152:155], v[88:91]
    ds_read_b64_tr_b16 v[206:207], v216 offset:18432
    v_mfma_f32_16x16x32_bf16 v[92:95], v[196:199], v[156:159], v[92:95]
    buffer_store_dwordx4 v[40:43], v28, s[52:55], s79 offen sc1
    v_mfma_f32_16x16x32_bf16 v[96:99], v[196:199], v[160:163], v[96:99]
    s_cmp_lg_u32 s84, 0
    s_cbranch_scc1 L_only_34
    ds_write_b128 v14, v[40:43] offset:4096
L_only_34:
    s_waitcnt lgkmcnt(2)
    v_mfma_f32_16x16x32_bf16 v[68:71], v[200:203], v[164:167], v[68:71]
    ds_read_b64_tr_b16 v[196:197], v10 offset:24576
    v_mfma_f32_16x16x32_bf16 v[72:75], v[200:203], v[168:171], v[72:75]
    ds_read_b64_tr_b16 v[198:199], v10 offset:26624
    v_mfma_f32_16x16x32_bf16 v[76:79], v[200:203], v[172:175], v[76:79]
    v_cvt_pk_bf16_f32 v44, v44, v45
    v_mfma_f32_16x16x32_bf16 v[80:83], v[200:203], v[176:179], v[80:83]
    v_cvt_pk_bf16_f32 v45, v46, v47
    s_waitcnt lgkmcnt(2)
    v_mfma_f32_16x16x32_bf16 v[84:87], v[204:207], v[164:167], v[84:87]
    ds_read_b64_tr_b16 v[200:201], v216 offset:24576
    v_mfma_f32_16x16x32_bf16 v[88:91], v[204:207], v[168:171], v[88:91]
    ds_read_b64_tr_b16 v[202:203], v216 offset:26624
    v_mfma_f32_16x16x32_bf16 v[92:95], v[204:207], v[172:175], v[92:95]
    s_add_u32 s45, s38, 0
    s_and_b32 s45, s45, 3
    s_lshl_b32 s45, s45, 7
    s_lshl_b32 s32, s42, 6
    s_add_u32 s45, s45, s32
    s_add_u32 s45, s45, s39
    s_and_b32 s32, s27, 1
    s_lshl_b32 s32, s32, 6
    s_add_u32 s32, s32, 512
    s_cmp_lt_u32 s3, 2
    s_cselect_b32 s45, s45, s32
    v_mfma_f32_16x16x32_bf16 v[96:99], v[204:207], v[176:179], v[96:99]
    s_waitcnt lgkmcnt(2)
    v_mfma_f32_16x16x32_bf16 v[68:71], v[196:199], v[180:183], v[68:71]
    ds_read_b64_tr_b16 v[204:205], v217 offset:0
    v_mfma_f32_16x16x32_bf16 v[72:75], v[196:199], v[184:187], v[72:75]
    ds_read_b64_tr_b16 v[206:207], v217 offset:2048
    v_mfma_f32_16x16x32_bf16 v[76:79], v[196:199], v[188:191], v[76:79]
    v_cvt_pk_bf16_f32 v46, v224, v225
    v_mfma_f32_16x16x32_bf16 v[80:83], v[196:199], v[192:195], v[80:83]
    v_cvt_pk_bf16_f32 v47, v226, v227
    s_waitcnt lgkmcnt(2)
    v_mfma_f32_16x16x32_bf16 v[84:87], v[200:203], v[180:183], v[84:87]
    ds_read_b64_tr_b16 v[196:197], v218 offset:0
    v_mfma_f32_16x16x32_bf16 v[88:91], v[200:203], v[184:187], v[88:91]
    ds_read_b64_tr_b16 v[198:199], v218 offset:2048
    v_mfma_f32_16x16x32_bf16 v[92:95], v[200:203], v[188:191], v[92:95]
    buffer_store_dwordx4 v[44:47], v29, s[52:55], s79 offen sc1
    v_mfma_f32_16x16x32_bf16 v[96:99], v[200:203], v[192:195], v[96:99]
    s_cmp_lg_u32 s84, 1
    s_cbranch_scc1 L_only_35
    ds_write_b128 v14, v[44:47] offset:4096
L_only_35:
    s_waitcnt lgkmcnt(2)
    v_mfma_f32_16x16x32_bf16 v[68:71], v[204:207], a[0:3], v[68:71]
    ds_read_b64_tr_b16 v[200:201], v217 offset:8192
    v_mfma_f32_16x16x32_bf16 v[72:75], v[204:207], a[4:7], v[72:75]
    ds_read_b64_tr_b16 v[202:203], v217 offset:10240
    v_mfma_f32_16x16x32_bf16 v[76:79], v[204:207], a[8:11], v[76:79]
    v_cvt_pk_bf16_f32 v60, v60, v61
    v_mfma_f32_16x16x32_bf16 v[80:83], v[204:207], a[12:15], v[80:83]
    v_cvt_pk_bf16_f32 v61, v62, v63
    s_waitcnt lgkmcnt(2)
    v_mfma_f32_16x16x32_bf16 v[84:87], v[196:199], a[0:3], v[84:87]
    ds_read_b64_tr_b16 v[204:205], v218 offset:8192
    v_mfma_f32_16x16x32_bf16 v[88:91], v[196:199], a[4:7], v[88:91]
    ds_read_b64_tr_b16 v[206:207], v218 offset:10240
    v_mfma_f32_16x16x32_bf16 v[92:95], v[196:199], a[8:11], v[92:95]
    v_cvt_pk_bf16_f32 v62, v228, v229
    v_mfma_f32_16x16x32_bf16 v[96:99], v[196:199], a[12:15], v[96:99]
    s_add_u32 s46, s43, s38
    s_add_u32 s46, s46, 1
    s_and_b32 s46, s46, 3
    s_lshl_b32 s46, s46, 7
    s_lshl_b32 s32, s42, 6
    s_add_u32 s46, s46, s32
    s_add_u32 s46, s46, s39
    s_waitcnt lgkmcnt(2)
    v_mfma_f32_16x16x32_bf16 v[68:71], v[200:203], a[16:19], v[68:71]
    ds_read_b64_tr_b16 v[196:197], v217 offset:16384
    v_mfma_f32_16x16x32_bf16 v[72:75], v[200:203], a[20:23], v[72:75]
    ds_read_b64_tr_b16 v[198:199], v217 offset:18432
    v_mfma_f32_16x16x32_bf16 v[76:79], v[200:203], a[24:27], v[76:79]
    v_cvt_pk_bf16_f32 v63, v230, v231
    v_mfma_f32_16x16x32_bf16 v[80:83], v[200:203], a[28:31], v[80:83]
    s_waitcnt lgkmcnt(2)
    v_mfma_f32_16x16x32_bf16 v[84:87], v[204:207], a[16:19], v[84:87]
    ds_read_b64_tr_b16 v[200:201], v218 offset:16384
    v_mfma_f32_16x16x32_bf16 v[88:91], v[204:207], a[20:23], v[88:91]
    ds_read_b64_tr_b16 v[202:203], v218 offset:18432
    v_mfma_f32_16x16x32_bf16 v[92:95], v[204:207], a[24:27], v[92:95]
    buffer_store_dwordx4 v[60:63], v30, s[52:55], s79 offen sc1
    v_mfma_f32_16x16x32_bf16 v[96:99], v[204:207], a[28:31], v[96:99]
    s_cmp_lg_u32 s84, 2
    s_cbranch_scc1 L_only_36
    ds_write_b128 v14, v[60:63] offset:4096
L_only_36:
    s_waitcnt lgkmcnt(2)
    v_mfma_f32_16x16x32_bf16 v[68:71], v[196:199], a[32:35], v[68:71]
    ds_read_b64_tr_b16 v[204:205], v217 offset:24576
    v_mfma_f32_16x16x32_bf16 v[72:75], v[196:199], a[36:39], v[72:75]
    ds_read_b64_tr_b16 v[206:207], v217 offset:26624
    v_mfma_f32_16x16x32_bf16 v[76:79], v[196:199], a[40:43], v[76:79]
    v_cvt_pk_bf16_f32 v64, v64, v65
    v_mfma_f32_16x16x32_bf16 v[80:83], v[196:199], a[44:47], v[80:83]
    v_cvt_pk_bf16_f32 v65, v66, v67
    s_waitcnt lgkmcnt(2)
    v_mfma_f32_16x16x32_bf16 v[84:87], v[200:203], a[32:35], v[84:87]
    ds_read_b64_tr_b16 v[196:197], v218 offset:24576
    v_mfma_f32_16x16x32_bf16 v[88:91], v[200:203], a[36:39], v[88:91]
    ds_read_b64_tr_b16 v[198:199], v218 offset:26624
    v_mfma_f32_16x16x32_bf16 v[92:95], v[200:203], a[40:43], v[92:95]
    v_cvt_pk_bf16_f32 v66, v232, v233
    v_mfma_f32_16x16x32_bf16 v[96:99], v[200:203], a[44:47], v[96:99]
    s_add_u32 s47, s38, 3
    s_and_b32 s47, s47, 3
    s_lshl_b32 s47, s47, 7
    s_lshl_b32 s32, s42, 6
    s_add_u32 s47, s47, s32
    s_add_u32 s47, s47, s39
    s_waitcnt lgkmcnt(2)
    v_mfma_f32_16x16x32_bf16 v[68:71], v[204:207], a[48:51], v[68:71]
    ds_read_b64_tr_b16 v[200:201], v219 offset:32768
    v_mfma_f32_16x16x32_bf16 v[72:75], v[204:207], a[52:55], v[72:75]
    ds_read_b64_tr_b16 v[202:203], v219 offset:34816
    v_mfma_f32_16x16x32_bf16 v[76:79], v[204:207], a[56:59], v[76:79]
    v_cvt_pk_bf16_f32 v67, v234, v235
    v_mfma_f32_16x16x32_bf16 v[80:83], v[204:207], a[60:63], v[80:83]
    buffer_store_dwordx4 v[64:67], v31, s[52:55], s79 offen sc1
    s_waitcnt lgkmcnt(2)
    v_mfma_f32_16x16x32_bf16 v[84:87], v[196:199], a[48:51], v[84:87]
    ds_read_b64_tr_b16 v[204:205], v220 offset:32768
    v_mfma_f32_16x16x32_bf16 v[88:91], v[196:199], a[52:55], v[88:91]
    ds_read_b64_tr_b16 v[206:207], v220 offset:34816
    v_mfma_f32_16x16x32_bf16 v[92:95], v[196:199], a[56:59], v[92:95]
    s_cmp_lg_u32 s84, 3
    s_cbranch_scc1 L_only_37
    ds_write_b128 v14, v[64:67] offset:4096
L_only_37:
    v_mfma_f32_16x16x32_bf16 v[96:99], v[196:199], a[60:63], v[96:99]
    s_waitcnt lgkmcnt(2)
    v_mfma_f32_16x16x32_bf16 v[68:71], v[200:203], a[64:67], v[68:71]
    s_waitcnt vmcnt(4)
    s_barrier
    v_add_u32 v10, 0x9000, v10
    v_mfma_f32_16x16x32_bf16 v[72:75], v[200:203], a[68:71], v[72:75]
    v_add_u32 v216, 0x9000, v216
    v_add_u32 v217, 0x9000, v217
    v_add_u32 v218, 0x9000, v218
    v_mfma_f32_16x16x32_bf16 v[76:79], v[200:203], a[72:75], v[76:79]
    v_add_u32 v219, 0x9000, v219
    v_add_u32 v220, 0x9000, v220
    ds_read_b64_tr_b16 v[196:197], v219 offset:0
    v_mfma_f32_16x16x32_bf16 v[80:83], v[200:203], a[76:79], v[80:83]
    ds_read_b64_tr_b16 v[198:199], v219 offset:2048
    s_waitcnt lgkmcnt(2)
    v_mfma_f32_16x16x32_bf16 v[84:87], v[204:207], a[64:67], v[84:87]
    ds_read_b64_tr_b16 v[200:201], v220 offset:0
    v_mfma_f32_16x16x32_bf16 v[88:91], v[204:207], a[68:71], v[88:91]
    ds_read_b64_tr_b16 v[202:203], v220 offset:2048
    v_mfma_f32_16x16x32_bf16 v[92:95], v[204:207], a[72:75], v[92:95]
    v_mfma_f32_16x16x32_bf16 v[96:99], v[204:207], a[76:79], v[96:99]
    s_waitcnt lgkmcnt(2)
    v_mfma_f32_16x16x32_bf16 v[68:71], v[196:199], a[80:83], v[68:71]
    ds_read_b64_tr_b16 v[204:205], v219 offset:4096
    v_mfma_f32_16x16x32_bf16 v[72:75], v[196:199], a[84:87], v[72:75]
    ds_read_b64_tr_b16 v[206:207], v219 offset:6144
    v_mfma_f32_16x16x32_bf16 v[76:79], v[196:199], a[88:91], v[76:79]
    s_lshl_b32 s86, s45, 4
    s_add_u32 s86, s86, s85
    buffer_load_dwordx4 v[24:27], v15, s[52:55], s86 offen sc1
    v_mfma_f32_16x16x32_bf16 v[80:83], v[196:199], a[92:95], v[80:83]
    s_waitcnt lgkmcnt(2)
    v_mfma_f32_16x16x32_bf16 v[84:87], v[200:203], a[80:83], v[84:87]
    ds_read_b64_tr_b16 v[196:197], v220 offset:4096
    v_mfma_f32_16x16x32_bf16 v[88:91], v[200:203], a[84:87], v[88:91]
    ds_read_b64_tr_b16 v[198:199], v220 offset:6144
    v_mfma_f32_16x16x32_bf16 v[92:95], v[200:203], a[88:91], v[92:95]
    v_mfma_f32_16x16x32_bf16 v[96:99], v[200:203], a[92:95], v[96:99]
    s_waitcnt lgkmcnt(2)
    v_mfma_f32_16x16x32_bf16 v[68:71], v[204:207], a[96:99], v[68:71]
    ds_read_b64_tr_b16 v[200:201], v219 offset:8192
    v_mfma_f32_16x16x32_bf16 v[72:75], v[204:207], a[100:103], v[72:75]
    ds_read_b64_tr_b16 v[202:203], v219 offset:10240
    v_mfma_f32_16x16x32_bf16 v[76:79], v[204:207], a[104:107], v[76:79]
    buffer_load_dwordx4 v[236:239], v16, s[68:71], s45 offen
    v_mfma_f32_16x16x32_bf16 v[80:83], v[204:207], a[108:111], v[80:83]
    s_waitcnt lgkmcnt(2)
    v_mfma_f32_16x16x32_bf16 v[84:87], v[196:199], a[96:99], v[84:87]
    ds_read_b64_tr_b16 v[204:205], v220 offset:8192
    v_mfma_f32_16x16x32_bf16 v[88:91], v[196:199], a[100:103], v[88:91]
    ds_read_b64_tr_b16 v[206:207], v220 offset:10240
    v_mfma_f32_16x16x32_bf16 v[92:95], v[196:199], a[104:107], v[92:95]
    v_mfma_f32_16x16x32_bf16 v[96:99], v[196:199], a[108:111], v[96:99]
    s_waitcnt lgkmcnt(2)
    v_mfma_f32_16x16x32_bf16 v[68:71], v[200:203], a[112:115], v[68:71]
    ds_read_b64_tr_b16 v[196:197], v219 offset:12288
    v_mfma_f32_16x16x32_bf16 v[72:75], v[200:203], a[116:119], v[72:75]
    ds_read_b64_tr_b16 v[198:199], v219 offset:14336
    v_mfma_f32_16x16x32_bf16 v[76:79], v[200:203], a[120:123], v[76:79]
    v_mfma_f32_16x16x32_bf16 v[80:83], v[200:203], a[124:127], v[80:83]
    s_waitcnt lgkmcnt(2)
    v_mfma_f32_16x16x32_bf16 v[84:87], v[204:207], a[112:115], v[84:87]
    s_waitcnt vmcnt(2)
    s_barrier
    v_mfma_f32_16x16x32_bf16 v[88:91], v[204:207], a[116:119], v[88:91]
    s_cmp_lg_u32 s3, 0
    s_cbranch_scc1 L_w0_38
    v_mov_b32 v19, 6
    s_mov_b64 exec, 1
    buffer_store_dword v19, v18, s[52:55], s65 offen offset:0 sc1
    s_mov_b64 exec, -1
L_w0_38:
    ds_read_b64_tr_b16 v[200:201], v220 offset:12288
    v_mfma_f32_16x16x32_bf16 v[92:95], v[204:207], a[120:123], v[92:95]
    ds_read_b64_tr_b16 v[202:203], v220 offset:14336
    s_lshl_b32 s86, s46, 4
    s_add_u32 s86, s86, s85
    buffer_load_dwordx4 v[32:35], v15, s[52:55], s86 offen sc1
    v_mfma_f32_16x16x32_bf16 v[96:99], v[204:207], a[124:127], v[96:99]
    s_waitcnt lgkmcnt(2)
    v_mfma_f32_16x16x32_bf16 v[68:71], v[196:199], a[128:131], v[68:71]
    ds_read_b64_tr_b16 v[204:205], v219 offset:16384
    v_mfma_f32_16x16x32_bf16 v[72:75], v[196:199], a[132:135], v[72:75]
    ds_read_b64_tr_b16 v[206:207], v219 offset:18432
    v_mfma_f32_16x16x32_bf16 v[76:79], v[196:199], a[136:139], v[76:79]
    v_mfma_f32_16x16x32_bf16 v[80:83], v[196:199], a[140:143], v[80:83]
    s_waitcnt lgkmcnt(2)
    v_mfma_f32_16x16x32_bf16 v[84:87], v[200:203], a[128:131], v[84:87]
    ds_read_b64_tr_b16 v[196:197], v220 offset:16384
    v_mfma_f32_16x16x32_bf16 v[88:91], v[200:203], a[132:135], v[88:91]
    ds_read_b64_tr_b16 v[198:199], v220 offset:18432
    v_mfma_f32_16x16x32_bf16 v[92:95], v[200:203], a[136:139], v[92:95]
    v_mfma_f32_16x16x32_bf16 v[96:99], v[200:203], a[140:143], v[96:99]
    s_waitcnt lgkmcnt(2)
    v_mfma_f32_16x16x32_bf16 v[68:71], v[204:207], a[144:147], v[68:71]
    ds_read_b64_tr_b16 v[200:201], v219 offset:20480
    v_mfma_f32_16x16x32_bf16 v[72:75], v[204:207], a[148:151], v[72:75]
    ds_read_b64_tr_b16 v[202:203], v219 offset:22528
    v_mfma_f32_16x16x32_bf16 v[76:79], v[204:207], a[152:155], v[76:79]
    buffer_load_dwordx4 v[240:243], v16, s[68:71], s46 offen
    v_mfma_f32_16x16x32_bf16 v[80:83], v[204:207], a[156:159], v[80:83]
    s_waitcnt lgkmcnt(2)
    v_mfma_f32_16x16x32_bf16 v[84:87], v[196:199], a[144:147], v[84:87]
    ds_read_b64_tr_b16 v[204:205], v220 offset:20480
    v_mfma_f32_16x16x32_bf16 v[88:91], v[196:199], a[148:151], v[88:91]
    ds_read_b64_tr_b16 v[206:207], v220 offset:22528
    v_mfma_f32_16x16x32_bf16 v[92:95], v[196:199], a[152:155], v[92:95]
    v_mfma_f32_16x16x32_bf16 v[96:99], v[196:199], a[156:159], v[96:99]
    s_waitcnt lgkmcnt(2)
    v_mfma_f32_16x16x32_bf16 v[68:71], v[200:203], a[160:163], v[68:71]
    ds_read_b64_tr_b16 v[196:197], v219 offset:24576
    v_mfma_f32_16x16x32_bf16 v[72:75], v[200:203], a[164:167], v[72:75]
    ds_read_b64_tr_b16 v[198:199], v219 offset:26624
    v_mfma_f32_16x16x32_bf16 v[76:79], v[200:203], a[168:171], v[76:79]
    s_lshl_b32 s86, s47, 4
    s_add_u32 s86, s86, s85
    buffer_load_dwordx4 v[36:39], v15, s[52:55], s86 offen sc1
    v_mfma_f32_16x16x32_bf16 v[80:83], v[200:203], a[172:175], v[80:83]
    s_waitcnt lgkmcnt(2)
    v_mfma_f32_16x16x32_bf16 v[84:87], v[204:207], a[160:163], v[84:87]
    ds_read_b64_tr_b16 v[200:201], v220 offset:24576
    v_mfma_f32_16x16x32_bf16 v[88:91], v[204:207], a[164:167], v[88:91]
    ds_read_b64_tr_b16 v[202:203], v220 offset:26624
    v_mfma_f32_16x16x32_bf16 v[92:95], v[204:207], a[168:171], v[92:95]
    v_mfma_f32_16x16x32_bf16 v[96:99], v[204:207], a[172:175], v[96:99]
    s_waitcnt lgkmcnt(2)
    v_mfma_f32_16x16x32_bf16 v[68:71], v[196:199], a[176:179], v[68:71]
    ds_read_b64_tr_b16 v[204:205], v219 offset:28672
    v_mfma_f32_16x16x32_bf16 v[72:75], v[196:199], a[180:183], v[72:75]
    ds_read_b64_tr_b16 v[206:207], v219 offset:30720
    v_mfma_f32_16x16x32_bf16 v[76:79], v[196:199], a[184:187], v[76:79]
    v_mfma_f32_16x16x32_bf16 v[80:83], v[196:199], a[188:191], v[80:83]
    s_waitcnt lgkmcnt(2)
    v_mfma_f32_16x16x32_bf16 v[84:87], v[200:203], a[176:179], v[84:87]
    ds_read_b64_tr_b16 v[196:197], v220 offset:28672
    v_mfma_f32_16x16x32_bf16 v[88:91], v[200:203], a[180:183], v[88:91]
    ds_read_b64_tr_b16 v[198:199], v220 offset:30720
    v_mfma_f32_16x16x32_bf16 v[92:95], v[200:203], a[184:187], v[92:95]
    buffer_load_dwordx4 v[244:247], v16, s[68:71], s47 offen
    v_mfma_f32_16x16x32_bf16 v[96:99], v[200:203], a[188:191], v[96:99]
    s_waitcnt lgkmcnt(2)
    v_mfma_f32_16x16x32_bf16 v[68:71], v[204:207], a[192:195], v[68:71]
    ds_read_b64_tr_b16 v[200:201], v219 offset:32768
    v_mfma_f32_16x16x32_bf16 v[72:75], v[204:207], a[196:199], v[72:75]
    ds_read_b64_tr_b16 v[202:203], v219 offset:34816
    v_mfma_f32_16x16x32_bf16 v[76:79], v[204:207], a[200:203], v[76:79]
    v_mfma_f32_16x16x32_bf16 v[80:83], v[204:207], a[204:207], v[80:83]
    s_waitcnt lgkmcnt(2)
    v_mfma_f32_16x16x32_bf16 v[84:87], v[196:199], a[192:195], v[84:87]
    buffer_load_dword v9, v48, s[52:55], 0 offen sc1
    v_mfma_f32_16x16x32_bf16 v[88:91], v[196:199], a[196:199], v[88:91]
    ds_read_b64_tr_b16 v[204:205], v220 offset:32768
    v_mfma_f32_16x16x32_bf16 v[92:95], v[196:199], a[200:203], v[92:95]
    ds_read_b64_tr_b16 v[206:207], v220 offset:34816
    v_mfma_f32_16x16x32_bf16 v[96:99], v[196:199], a[204:207], v[96:99]
    s_waitcnt lgkmcnt(2)
    v_mfma_f32_16x16x32_bf16 v[68:71], v[200:203], a[208:211], v[68:71]
    v_mfma_f32_16x16x32_bf16 v[72:75], v[200:203], a[212:215], v[72:75]
    v_mfma_f32_16x16x32_bf16 v[76:79], v[200:203], a[216:219], v[76:79]
    v_mfma_f32_16x16x32_bf16 v[80:83], v[200:203], a[220:223], v[80:83]
    s_waitcnt lgkmcnt(0)
    v_mfma_f32_16x16x32_bf16 v[84:87], v[204:207], a[208:211], v[84:87]
    v_mfma_f32_16x16x32_bf16 v[88:91], v[204:207], a[212:215], v[88:91]
    v_mfma_f32_16x16x32_bf16 v[92:95], v[204:207], a[216:219], v[92:95]
    v_mfma_f32_16x16x32_bf16 v[96:99], v[204:207], a[220:223], v[96:99]
    s_mov_b32 s79, 55296
    v_cvt_pk_bf16_f32 v68, v68, v69
    v_cvt_pk_bf16_f32 v69, v70, v71
    s_nop 1
    v_cvt_pk_bf16_f32 v70, v84, v85
    v_cvt_pk_bf16_f32 v71, v86, v87
    buffer_store_dwordx4 v[68:71], v28, s[52:55], s79 offen sc1
    s_cmp_lg_u32 s84, 0
    s_cbranch_scc1 L_only_39
    ds_write_b128 v14, v[68:71] offset:6144
L_only_39:
    v_cvt_pk_bf16_f32 v72, v72, v73
    v_cvt_pk_bf16_f32 v73, v74, v75
    v_cvt_pk_bf16_f32 v74, v88, v89
    v_cvt_pk_bf16_f32 v75, v90, v91
    buffer_store_dwordx4 v[72:75], v29, s[52:55], s79 offen sc1
    s_cmp_lg_u32 s84, 1
    s_cbranch_scc1 L_only_40
    ds_write_b128 v14, v[72:75] offset:6144
L_only_40:
    v_cvt_pk_bf16_f32 v76, v76, v77
    v_cvt_pk_bf16_f32 v77, v78, v79
    v_cvt_pk_bf16_f32 v78, v92, v93
    v_cvt_pk_bf16_f32 v79, v94, v95
    buffer_store_dwordx4 v[76:79], v30, s[52:55], s79 offen sc1
    s_cmp_lg_u32 s84, 2
    s_cbranch_scc1 L_only_41
    ds_write_b128 v14, v[76:79] offset:6144
L_only_41:
    v_cvt_pk_bf16_f32 v80, v80, v81
    v_cvt_pk_bf16_f32 v81, v82, v83
    v_cvt_pk_bf16_f32 v82, v96, v97
    v_cvt_pk_bf16_f32 v83, v98, v99
    buffer_store_dwordx4 v[80:83], v31, s[52:55], s79 offen sc1
    s_cmp_lg_u32 s84, 3
    s_cbranch_scc1 L_only_42
    ds_write_b128 v14, v[80:83] offset:6144
L_only_42:
    v_mov_b32 v30, 0x3f80
    v_mov_b32 v31, 0x3f800000
    s_waitcnt vmcnt(4)
    v_cmp_gt_u32 vcc, 6, v9
    s_cbranch_vccz L_pollx_44
    s_mov_b32 s35, 0
L_poll_43:
    s_add_u32 s35, s35, 1
    s_cmp_gt_u32 s35, 400000
    s_cbranch_scc1 L_pollx_44
    buffer_load_dword v9, v48, s[52:55], 0 offen sc1
    s_waitcnt vmcnt(0)
    v_cmp_gt_u32 vcc, 6, v9
    s_cbranch_vccnz L_poll_43
L_pollx_44:
    s_add_u32 s86, s66, 0
    s_cmp_ge_u32 s3, 2
    s_cbranch_scc1 L_mem_45
    ds_read_b128 v[132:135], v22 offset:0
    s_branch L_memx_46
L_mem_45:
    buffer_load_dwordx4 v[132:135], v17, s[52:55], s86 offen offset:0 sc1
L_memx_46:
    buffer_load_dwordx4 v[136:139], v17, s[52:55], s86 offen offset:1024 sc1
    buffer_load_dwordx4 v[140:143], v17, s[52:55], s86 offen offset:2048 sc1
    v_lshlrev_b32 v60, 16, v24
    v_and_b32 v61, 0xffff0000, v24
    v_lshlrev_b32 v62, 16, v25
    v_and_b32 v63, 0xffff0000, v25
    v_lshlrev_b32 v64, 16, v26
    v_and_b32 v65, 0xffff0000, v26
    v_lshlrev_b32 v66, 16, v27
    v_and_b32 v67, 0xffff0000, v27
    v_dot2c_f32_bf16 v60, v236, v30
    v_dot2c_f32_bf16 v61, v236, v31
    v_dot2c_f32_bf16 v62, v237, v30
    v_dot2c_f32_bf16 v63, v237, v31
    v_dot2c_f32_bf16 v64, v238, v30
    v_dot2c_f32_bf16 v65, v238, v31
    v_dot2c_f32_bf16 v66, v239, v30
    v_dot2c_f32_bf16 v67, v239, v31
    v_lshlrev_b32 v100, 16, v32
    v_and_b32 v101, 0xffff0000, v32
    v_lshlrev_b32 v102, 16, v33
    v_and_b32 v103, 0xffff0000, v33
    v_lshlrev_b32 v104, 16, v34
    v_and_b32 v105, 0xffff0000, v34
    v_lshlrev_b32 v106, 16, v35
    v_and_b32 v107, 0xffff0000, v35
    v_dot2c_f32_bf16 v100, v240, v30
    v_dot2c_f32_bf16 v101, v240, v31
    v_dot2c_f32_bf16 v102, v241, v30
    v_dot2c_f32_bf16 v103, v241, v31
    v_dot2c_f32_bf16 v104, v242, v30
    v_dot2c_f32_bf16 v105, v242, v31
    v_dot2c_f32_bf16 v106, v243, v30
    v_dot2c_f32_bf16 v107, v243, v31
    v_lshlrev_b32 v108, 16, v36
    v_and_b32 v109, 0xffff0000, v36
    v_lshlrev_b32 v110, 16, v37
    v_and_b32 v111, 0xffff0000, v37
    v_lshlrev_b32 v112, 16, v38
    v_and_b32 v113, 0xffff0000, v38
    v_lshlrev_b32 v114, 16, v39
    v_and_b32 v115, 0xffff0000, v39
    v_dot2c_f32_bf16 v108, v244, v30
    v_dot2c_f32_bf16 v109, v244, v31
    v_dot2c_f32_bf16 v110, v245, v30
    v_dot2c_f32_bf16 v111, v245, v31
    v_dot2c_f32_bf16 v112, v246, v30
    v_dot2c_f32_bf16 v113, v246, v31
    v_dot2c_f32_bf16 v114, v247, v30
    v_dot2c_f32_bf16 v115, v247, v31
    s_waitcnt lgkmcnt(0)
    s_waitcnt vmcnt(2)
    s_barrier
    s_cmp_lg_u32 s3, 0
    s_cbranch_scc1 L_w0_47
    v_mov_b32 v19, 7
    s_mov_b64 exec, 1
    buffer_store_dword v19, v18, s[52:55], s65 offen offset:0 sc1
    s_mov_b64 exec, -1
L_w0_47:
    buffer_load_dwordx4 v[144:147], v17, s[52:55], s86 offen offset:3072 sc1
    s_add_u32 s86, s66, 4096
    buffer_load_dwordx4 v[148:151], v17, s[52:55], s86 offen offset:0 sc1
    buffer_load_dwordx4 v[152:155], v17, s[52:55], s86 offen offset:1024 sc1
    buffer_load_dwordx4 v[156:159], v17, s[52:55], s86 offen offset:2048 sc1
    buffer_load_dwordx4 v[160:163], v17, s[52:55], s86 offen offset:3072 sc1
    s_add_u32 s86, s67, 18432
    ds_read_b128 v[164:167], v22 offset:2048
    buffer_load_dwordx4 v[168:171], v17, s[52:55], s86 offen offset:1024 sc1
    buffer_load_dwordx4 v[172:175], v17, s[52:55], s86 offen offset:2048 sc1
    buffer_load_dwordx4 v[176:179], v17, s[52:55], s86 offen offset:3072 sc1
    s_add_u32 s86, s67, 22528
    buffer_load_dwordx4 v[180:183], v17, s[52:55], s86 offen offset:0 sc1
    buffer_load_dwordx4 v[184:187], v17, s[52:55], s86 offen offset:1024 sc1
    buffer_load_dwordx4 v[188:191], v17, s[52:55], s86 offen offset:2048 sc1
    buffer_load_dwordx4 v[192:195], v17, s[52:55], s86 offen offset:3072 sc1
    buffer_load_dword v9, v48, s[52:55], 0 offen sc1
    s_waitcnt lgkmcnt(0)
    s_waitcnt vmcnt(15)
    v_lshlrev_b32 v40, 16, v132
    v_and_b32 v41, 0xffff0000, v132
    v_lshlrev_b32 v42, 16, v133
    v_and_b32 v43, 0xffff0000, v133
    v_lshlrev_b32 v44, 16, v134
    v_and_b32 v45, 0xffff0000, v134
    v_lshlrev_b32 v46, 16, v135
    v_and_b32 v47, 0xffff0000, v135
    s_waitcnt vmcnt(14)
    v_dot2c_f32_bf16 v40, v136, v30
    v_dot2c_f32_bf16 v41, v136, v31
    v_dot2c_f32_bf16 v42, v137, v30
    v_dot2c_f32_bf16 v43, v137, v31
    v_dot2c_f32_bf16 v44, v138, v30
    v_dot2c_f32_bf16 v45, v138, v31
    v_dot2c_f32_bf16 v46, v139, v30
    v_dot2c_f32_bf16 v47, v139, v31
    s_waitcnt vmcnt(13)
    v_dot2c_f32_bf16 v40, v140, v30
    v_dot2c_f32_bf16 v41, v140, v31
    v_dot2c_f32_bf16 v42, v141, v30
    v_dot2c_f32_bf16 v43, v141, v31
    v_dot2c_f32_bf16 v44, v142, v30
    v_dot2c_f32_bf16 v45, v142, v31
    v_dot2c_f32_bf16 v46, v143, v30
    v_dot2c_f32_bf16 v47, v143, v31
    s_waitcnt vmcnt(12)
    v_dot2c_f32_bf16 v40, v144, v30
    v_dot2c_f32_bf16 v41, v144, v31
    v_dot2c_f32_bf16 v42, v145, v30
    v_dot2c_f32_bf16 v43, v145, v31
    v_dot2c_f32_bf16 v44, v146, v30
    v_dot2c_f32_bf16 v45, v146, v31
    v_dot2c_f32_bf16 v46, v147, v30
    v_dot2c_f32_bf16 v47, v147, v31
    s_waitcnt vmcnt(11)
    v_dot2c_f32_bf16 v40, v148, v30
    v_dot2c_f32_bf16 v41, v148, v31
    v_dot2c_f32_bf16 v42, v149, v30
    v_dot2c_f32_bf16 v43, v149, v31
    v_dot2c_f32_bf16 v44, v150, v30
    v_dot2c_f32_bf16 v45, v150, v31
    v_dot2c_f32_bf16 v46, v151, v30
    v_dot2c_f32_bf16 v47, v151, v31
    s_waitcnt vmcnt(10)
    v_dot2c_f32_bf16 v40, v152, v30
    v_dot2c_f32_bf16 v41, v152, v31
    v_dot2c_f32_bf16 v42, v153, v30
    v_dot2c_f32_bf16 v43, v153, v31
    v_dot2c_f32_bf16 v44, v154, v30
    v_dot2c_f32_bf16 v45, v154, v31
    v_dot2c_f32_bf16 v46, v155, v30
    v_dot2c_f32_bf16 v47, v155, v31
    s_waitcnt vmcnt(9)
    v_dot2c_f32_bf16 v40, v156, v30
    v_dot2c_f32_bf16 v41, v156, v31
    v_dot2c_f32_bf16 v42, v157, v30
    v_dot2c_f32_bf16 v43, v157, v31
    v_dot2c_f32_bf16 v44, v158, v30
    v_dot2c_f32_bf16 v45, v158, v31
    v_dot2c_f32_bf16 v46, v159, v30
    v_dot2c_f32_bf16 v47, v159, v31
    s_waitcnt vmcnt(8)
    v_dot2c_f32_bf16 v40, v160, v30
    v_dot2c_f32_bf16 v41, v160, v31
    v_dot2c_f32_bf16 v42, v161, v30
    v_dot2c_f32_bf16 v43, v161, v31
    v_dot2c_f32_bf16 v44, v162, v30
    v_dot2c_f32_bf16 v45, v162, v31
    v_dot2c_f32_bf16 v46, v163, v30
    v_dot2c_f32_bf16 v47, v163, v31
    s_cmp_lg_u32 s3, 3
    s_cbranch_scc1 L_only_48
    ds_write_b128 v17, v[40:43] offset:32768
    ds_write_b128 v17, v[44:47] offset:33792
L_only_48:
    s_waitcnt lgkmcnt(0)
    s_barrier
    s_cmp_lg_u32 s3, 2
    s_cbranch_scc1 L_only_49
    ds_read_b128 v[52:55], v17 offset:32768
    ds_read_b128 v[56:59], v17 offset:33792
    s_waitcnt lgkmcnt(0)
    v_add_f32 v40, v40, v52
    v_add_f32 v41, v41, v53
    v_add_f32 v42, v42, v54
    v_add_f32 v43, v43, v55
    v_add_f32 v44, v44, v56
    v_add_f32 v45, v45, v57
    v_add_f32 v46, v46, v58
    v_add_f32 v47, v47, v59
L_only_49:
    s_cmp_eq_u32 s3, 3
    s_cbranch_scc1 L_no0_50
    v_permlane16_swap_b32 v40, v44
    v_permlane16_swap_b32 v41, v45
    v_permlane16_swap_b32 v42, v46
    v_permlane16_swap_b32 v43, v47
    v_fma_f32 v40, v40, v20, v60
    v_fma_f32 v41, v41, v20, v61
    v_fma_f32 v42, v42, v20, v62
    v_fma_f32 v43, v43, v20, v63
    v_fma_f32 v44, v44, v20, v64
    v_fma_f32 v45, v45, v20, v65
    v_fma_f32 v46, v46, v20, v66
    v_fma_f32 v47, v47, v20, v67
    v_cvt_pk_bf16_f32 v60, v40, v41
    v_cvt_pk_bf16_f32 v61, v42, v43
    v_cvt_pk_bf16_f32 v62, v44, v45
    v_cvt_pk_bf16_f32 v63, v46, v47
    buffer_store_dwordx4 v[60:63], v8, s[88:91], s45 offen
L_no0_50:
    s_cmp_ge_u32 s3, 2
    s_cbranch_scc1 L_no2_51
    s_waitcnt vmcnt(0)
    v_cmp_gt_u32 vcc, 7, v9
    s_cbranch_vccz L_pollx_53
    s_mov_b32 s35, 0
L_poll_52:
    s_add_u32 s35, s35, 1
    s_cmp_gt_u32 s35, 400000
    s_cbranch_scc1 L_pollx_53
    buffer_load_dword v9, v48, s[52:55], 0 offen sc1
    s_waitcnt vmcnt(0)
    v_cmp_gt_u32 vcc, 7, v9
    s_cbranch_vccnz L_poll_52
L_pollx_53:
    s_add_u32 s86, s67, 55296
    ds_read_b128 v[132:135], v22 offset:6144
    buffer_load_dwordx4 v[136:139], v17, s[52:55], s86 offen offset:1024 sc1
    buffer_load_dwordx4 v[140:143], v17, s[52:55], s86 offen offset:2048 sc1
    buffer_load_dwordx4 v[144:147], v17, s[52:55], s86 offen offset:3072 sc1
    s_add_u32 s86, s67, 59392
    buffer_load_dwordx4 v[148:151], v17, s[52:55], s86 offen offset:0 sc1
    buffer_load_dwordx4 v[152:155], v17, s[52:55], s86 offen offset:1024 sc1
    buffer_load_dwordx4 v[156:159], v17, s[52:55], s86 offen offset:2048 sc1
    buffer_load_dwordx4 v[160:163], v17, s[52:55], s86 offen offset:3072 sc1
L_no2_51:
    s_cmp_lt_u32 s3, 2
    s_cbranch_scc1 L_w01_54
    s_waitcnt vmcnt(0)
L_w01_54:
    s_waitcnt lgkmcnt(0)
    v_lshlrev_b32 v40, 16, v164
    v_and_b32 v41, 0xffff0000, v164
    v_lshlrev_b32 v42, 16, v165
    v_and_b32 v43, 0xffff0000, v165
    v_lshlrev_b32 v44, 16, v166
    v_and_b32 v45, 0xffff0000, v166
    v_lshlrev_b32 v46, 16, v167
    v_and_b32 v47, 0xffff0000, v167
    v_dot2c_f32_bf16 v40, v168, v30
    v_dot2c_f32_bf16 v41, v168, v31
    v_dot2c_f32_bf16 v42, v169, v30
    v_dot2c_f32_bf16 v43, v169, v31
    v_dot2c_f32_bf16 v44, v170, v30
    v_dot2c_f32_bf16 v45, v170, v31
    v_dot2c_f32_bf16 v46, v171, v30
    v_dot2c_f32_bf16 v47, v171, v31
    v_dot2c_f32_bf16 v40, v172, v30
    v_dot2c_f32_bf16 v41, v172, v31
    v_dot2c_f32_bf16 v42, v173, v30
    v_dot2c_f32_bf16 v43, v173, v31
    v_dot2c_f32_bf16 v44, v174, v30
    v_dot2c_f32_bf16 v45, v174, v31
    v_dot2c_f32_bf16 v46, v175, v30
    v_dot2c_f32_bf16 v47, v175, v31
    v_dot2c_f32_bf16 v40, v176, v30
    v_dot2c_f32_bf16 v41, v176, v31
    v_dot2c_f32_bf16 v42, v177, v30
    v_dot2c_f32_bf16 v43, v177, v31
    v_dot2c_f32_bf16 v44, v178, v30
    v_dot2c_f32_bf16 v45, v178, v31
    v_dot2c_f32_bf16 v46, v179, v30
    v_dot2c_f32_bf16 v47, v179, v31
    v_dot2c_f32_bf16 v40, v180, v30
    v_dot2c_f32_bf16 v41, v180, v31
    v_dot2c_f32_bf16 v42, v181, v30
    v_dot2c_f32_bf16 v43, v181, v31
    v_dot2c_f32_bf16 v44, v182, v30
    v_dot2c_f32_bf16 v45, v182, v31
    v_dot2c_f32_bf16 v46, v183, v30
    v_dot2c_f32_bf16 v47, v183, v31
    v_dot2c_f32_bf16 v40, v184, v30
    v_dot2c_f32_bf16 v41, v184, v31
    v_dot2c_f32_bf16 v42, v185, v30
    v_dot2c_f32_bf16 v43, v185, v31
    v_dot2c_f32_bf16 v44, v186, v30
    v_dot2c_f32_bf16 v45, v186, v31
    v_dot2c_f32_bf16 v46, v187, v30
    v_dot2c_f32_bf16 v47, v187, v31
    v_dot2c_f32_bf16 v40, v188, v30
    v_dot2c_f32_bf16 v41, v188, v31
    v_dot2c_f32_bf16 v42, v189, v30
    v_dot2c_f32_bf16 v43, v189, v31
    v_dot2c_f32_bf16 v44, v190, v30
    v_dot2c_f32_bf16 v45, v190, v31
    v_dot2c_f32_bf16 v46, v191, v30
    v_dot2c_f32_bf16 v47, v191, v31
    v_dot2c_f32_bf16 v40, v192, v30
    v_dot2c_f32_bf16 v41, v192, v31
    v_dot2c_f32_bf16 v42, v193, v30
    v_dot2c_f32_bf16 v43, v193, v31
    v_dot2c_f32_bf16 v44, v194, v30
    v_dot2c_f32_bf16 v45, v194, v31
    v_dot2c_f32_bf16 v46, v195, v30
    v_dot2c_f32_bf16 v47, v195, v31
    v_permlane16_swap_b32 v40, v44
    v_permlane16_swap_b32 v41, v45
    v_permlane16_swap_b32 v42, v46
    v_permlane16_swap_b32 v43, v47
    v_fma_f32 v40, v40, v20, v100
    v_fma_f32 v41, v41, v20, v101
    v_fma_f32 v42, v42, v20, v102
    v_fma_f32 v43, v43, v20, v103
    v_fma_f32 v44, v44, v20, v104
    v_fma_f32 v45, v45, v20, v105
    v_fma_f32 v46, v46, v20, v106
    v_fma_f32 v47, v47, v20, v107
    v_cvt_pk_bf16_f32 v100, v40, v41
    v_cvt_pk_bf16_f32 v101, v42, v43
    v_cvt_pk_bf16_f32 v102, v44, v45
    v_cvt_pk_bf16_f32 v103, v46, v47
    buffer_store_dwordx4 v[100:103], v8, s[88:91], s46 offen
    s_cmp_ge_u32 s3, 2
    s_cbranch_scc1 L_done
    s_waitcnt lgkmcnt(0)
    v_lshlrev_b32 v40, 16, v132
    v_and_b32 v41, 0xffff0000, v132
    v_lshlrev_b32 v42, 16, v133
    v_and_b32 v43, 0xffff0000, v133
    v_lshlrev_b32 v44, 16, v134
    v_and_b32 v45, 0xffff0000, v134
    v_lshlrev_b32 v46, 16, v135
    v_and_b32 v47, 0xffff0000, v135
    s_waitcnt vmcnt(7)
    v_dot2c_f32_bf16 v40, v136, v30
    v_dot2c_f32_bf16 v41, v136, v31
    v_dot2c_f32_bf16 v42, v137, v30
    v_dot2c_f32_bf16 v43, v137, v31
    v_dot2c_f32_bf16 v44, v138, v30
    v_dot2c_f32_bf16 v45, v138, v31
    v_dot2c_f32_bf16 v46, v139, v30
    v_dot2c_f32_bf16 v47, v139, v31
    s_waitcnt vmcnt(6)
    v_dot2c_f32_bf16 v40, v140, v30
    v_dot2c_f32_bf16 v41, v140, v31
    v_dot2c_f32_bf16 v42, v141, v30
    v_dot2c_f32_bf16 v43, v141, v31
    v_dot2c_f32_bf16 v44, v142, v30
    v_dot2c_f32_bf16 v45, v142, v31
    v_dot2c_f32_bf16 v46, v143, v30
    v_dot2c_f32_bf16 v47, v143, v31
    s_waitcnt vmcnt(5)
    v_dot2c_f32_bf16 v40, v144, v30
    v_dot2c_f32_bf16 v41, v144, v31
    v_dot2c_f32_bf16 v42, v145, v30
    v_dot2c_f32_bf16 v43, v145, v31
    v_dot2c_f32_bf16 v44, v146, v30
    v_dot2c_f32_bf16 v45, v146, v31
    v_dot2c_f32_bf16 v46, v147, v30
    v_dot2c_f32_bf16 v47, v147, v31
    s_waitcnt vmcnt(4)
    v_dot2c_f32_bf16 v40, v148, v30
    v_dot2c_f32_bf16 v41, v148, v31
    v_dot2c_f32_bf16 v42, v149, v30
    v_dot2c_f32_bf16 v43, v149, v31
    v_dot2c_f32_bf16 v44, v150, v30
    v_dot2c_f32_bf16 v45, v150, v31
    v_dot2c_f32_bf16 v46, v151, v30
    v_dot2c_f32_bf16 v47, v151, v31
    s_waitcnt vmcnt(3)
    v_dot2c_f32_bf16 v40, v152, v30
    v_dot2c_f32_bf16 v41, v152, v31
    v_dot2c_f32_bf16 v42, v153, v30
    v_dot2c_f32_bf16 v43, v153, v31
    v_dot2c_f32_bf16 v44, v154, v30
    v_dot2c_f32_bf16 v45, v154, v31
    v_dot2c_f32_bf16 v46, v155, v30
    v_dot2c_f32_bf16 v47, v155, v31
    s_waitcnt vmcnt(2)
    v_dot2c_f32_bf16 v40, v156, v30
    v_dot2c_f32_bf16 v41, v156, v31
    v_dot2c_f32_bf16 v42, v157, v30
    v_dot2c_f32_bf16 v43, v157, v31
    v_dot2c_f32_bf16 v44, v158, v30
    v_dot2c_f32_bf16 v45, v158, v31
    v_dot2c_f32_bf16 v46, v159, v30
    v_dot2c_f32_bf16 v47, v159, v31
    s_waitcnt vmcnt(1)
    v_dot2c_f32_bf16 v40, v160, v30
    v_dot2c_f32_bf16 v41, v160, v31
    v_dot2c_f32_bf16 v42, v161, v30
    v_dot2c_f32_bf16 v43, v161, v31
    v_dot2c_f32_bf16 v44, v162, v30
    v_dot2c_f32_bf16 v45, v162, v31
    v_dot2c_f32_bf16 v46, v163, v30
    v_dot2c_f32_bf16 v47, v163, v31
    v_permlane16_swap_b32 v40, v44
    v_permlane16_swap_b32 v41, v45
    v_permlane16_swap_b32 v42, v46
    v_permlane16_swap_b32 v43, v47
    v_fma_f32 v40, v40, v20, v108
    v_fma_f32 v41, v41, v20, v109
    v_fma_f32 v42, v42, v20, v110
    v_fma_f32 v43, v43, v20, v111
    v_fma_f32 v44, v44, v20, v112
    v_fma_f32 v45, v45, v20, v113
    v_fma_f32 v46, v46, v20, v114
    v_fma_f32 v47, v47, v20, v115
    v_cvt_pk_bf16_f32 v108, v40, v41
    v_cvt_pk_bf16_f32 v109, v42, v43
    v_cvt_pk_bf16_f32 v110, v44, v45
    v_cvt_pk_bf16_f32 v111, v46, v47
    buffer_store_dwordx4 v[108:111], v8, s[88:91], s47 offen
L_done:
L_end:
    s_endpgm
.section .rodata,"a"
.p2align 6
.amdhsa_kernel sequential_preLN__sliding_local_dilated__dense_activation_squared_relu__prompt_kernel
  .amdhsa_next_free_vgpr 512
  .amdhsa_next_free_sgpr 102
  .amdhsa_accum_offset 256
  .amdhsa_group_segment_fixed_size 0
  .amdhsa_kernarg_size 88
  .amdhsa_user_sgpr_count 2
  .amdhsa_user_sgpr_kernarg_segment_ptr 1
  .amdhsa_system_sgpr_workgroup_id_x 1
  .amdhsa_float_denorm_mode_32 3
.end_amdhsa_kernel
```
